```python
import torch

def _softmax(x, axis=-1):
    return torch.softmax(x, dim=axis)
def _gelu(x):
    return torch.nn.functional.gelu(x, approximate="tanh")
def _silu(x):
    return torch.nn.functional.silu(x)
def _sigmoid(x):
    return torch.sigmoid(x)
def _layernorm(x, axis=-1, eps=1e-5):
    m = x.mean(dim=axis, keepdim=True)
    v = x.var(dim=axis, keepdim=True, unbiased=False)
    return (x - m) / torch.sqrt(v + eps)
def _scatter_add(tgt, idx, src, axis=0):
    return tgt.clone().index_add_(axis, idx, src)
def _segment_sum(src, seg, n):
    out = torch.zeros((n,) + src.shape[1:], dtype=src.dtype)
    return out.index_add_(0, seg, src)
def _pad(x, pw):
    flat = tuple(v for pair in reversed(pw) for v in pair)
    return torch.nn.functional.pad(x, flat)

kernel_name = 'gated_mix__ssm_conv_s4d__dense_activation_mish__prompt'

def setup_inputs():

    _w = (lambda a: (lambda t: t.to(torch.bfloat16) if t.is_floating_point() else t)(torch.as_tensor(a)))
    def _A_setup():
        Bsz, L, D, N = 1, 2048, 576, 128
        return {
            "u": _w((lambda *s: torch.randn(*s, dtype=torch.bfloat16) * 0.05)(Bsz, L, D)),
            "log_A_real": _w((lambda *s: torch.randn(*s, dtype=torch.bfloat16) * 6.4)(D, N) * 0.5),
            "A_imag": _w((lambda *s: torch.randn(*s, dtype=torch.bfloat16) * 0.05)(D, N) * 3.14),
            "C_real": _w((lambda *s: torch.randn(*s, dtype=torch.bfloat16) * 0.1)(D, N) / N ** 0.5),
            "C_imag": _w((lambda *s: torch.randn(*s, dtype=torch.bfloat16) * 0.1)(D, N) / N ** 0.5),
            "log_dt": _w((lambda *s: torch.randn(*s, dtype=torch.bfloat16) * 0.05)(D) * 0.5 - 4.0),
            "D_skip": _w((lambda *s: torch.randn(*s, dtype=torch.bfloat16) * 0.05)(D)),
        }
    _A_in = _A_setup()

    def _B_setup():
        B, S, D, F = 1, 2048, 576, 4608
        return {
            "x": _w((lambda *s: torch.randn(*s, dtype=torch.bfloat16) * 0.05)(B, S, D)),
            "w1": _w((lambda *s: torch.randn(*s, dtype=torch.bfloat16) * 6.4)(D, F) * (D ** -0.5)),
            "b1": _w((lambda *s: torch.randn(*s, dtype=torch.bfloat16) * 0.05)(F)),
            "w2": _w((lambda *s: torch.randn(*s, dtype=torch.bfloat16) * 0.05)(F, D) * (F ** -0.5)),
        }
    _B_in = _B_setup()

    return {
        "A_u": _A_in["u"],
        "A_log_A_real": _A_in["log_A_real"],
        "A_A_imag": _A_in["A_imag"],
        "A_C_real": _A_in["C_real"],
        "A_C_imag": _A_in["C_imag"],
        "A_log_dt": _A_in["log_dt"],
        "A_D_skip": _A_in["D_skip"],
        "B_x": _B_in["x"],
        "B_w1": _B_in["w1"],
        "B_b1": _B_in["b1"],
        "B_w2": _B_in["w2"],
        "gate_w": _w((lambda *s: torch.randn(*s, dtype=torch.bfloat16) * 0.05)(576) * 16.0),
    }

def reference(A_u, A_log_A_real, A_A_imag, A_C_real, A_C_imag, A_log_dt, A_D_skip, B_x, B_w1, B_b1, B_w2, gate_w):
    def _A_ref(u, log_A_real, A_imag, C_real, C_imag, log_dt, D_skip):
        L = u.shape[1]
        dt = torch.exp(log_dt)
        A = -torch.exp(log_A_real) + 1j * A_imag
        C = (C_real + 1j * C_imag) * dt[:, None]
        pos = (lambda x, dt: x.to(dt))(torch.arange(L), log_dt.dtype)
        P = torch.exp((A * dt[:, None])[:, :, None] * pos[None, None, :])
        K = 2.0 * torch.einsum("dn,dnl->dl", C, P).real
        L2 = 2 * L
        u_t = (lambda x, *d: x.permute(*d))(u, 0, 2, 1)
        Kf = (lambda x, *a, **k: torch.fft.rfft(x.float(), *a, **k))(K, L2)
        Uf = (lambda x, *a, **k: torch.fft.rfft(x.float(), *a, **k))(u_t, L2)
        y = (lambda x, *a, **k: torch.fft.irfft(x, *a, **k).to(torch.bfloat16))(Uf * Kf[None, :, :], L2)[:, :, :L]
        y = (lambda x, *d: x.permute(*d))(y, 0, 2, 1)
        return y + u * D_skip[None, None, :]

    def _B_ref(x, w1, b1, w2):
        h = torch.einsum("bsd,df->bsf", x, w1) + b1
        sp = torch.log1p(torch.exp(-torch.abs(h))) + torch.where(h > 0, h, torch.zeros_like(h))
        act = h * torch.tanh(sp)
        return torch.einsum("bsf,fd->bsd", act, w2)

    x = A_u
    g = _sigmoid((x * gate_w).sum(-1, keepdims=True))
    a = _A_ref(x, A_log_A_real, A_A_imag, A_C_real, A_C_imag, A_log_dt, A_D_skip)
    b = _B_ref(x, B_w1, B_b1, B_w2)
    return g * a + (1 - g) * b
```

```asm
; @launch grid=(256,1,1) block=(256,1,1) lds=163840
.amdgcn_target "amdgcn-amd-amdhsa--gfx950"
.text
.globl gated_mix__ssm_conv_s4d__dense_activation_mish__prompt_kernel
.p2align 8
.type gated_mix__ssm_conv_s4d__dense_activation_mish__prompt_kernel,@function
gated_mix__ssm_conv_s4d__dense_activation_mish__prompt_kernel:

L_start:
    s_cmp_ge_u32 s2, 256
    s_cbranch_scc1 L_end
    s_lshr_b32 s39, s2, 3
    s_and_b32 s39, s39, 3
    s_cmp_eq_u32 s39, 3
    s_cbranch_scc1 L_conv
    s_load_dwordx2 s[4:5], s[0:1], 0
    s_load_dwordx2 s[8:9], s[0:1], 64
    s_load_dwordx2 s[20:21], s[0:1], 72
    s_load_dwordx2 s[12:13], s[0:1], 112
    s_load_dwordx2 s[16:17], s[0:1], 80
    s_load_dwordx2 s[28:29], s[0:1], 104
    s_load_dwordx2 s[24:25], s[0:1], 96
    v_lshrrev_b32 v2, 6, v0
    v_and_b32 v1, 63, v0
    s_and_b32 s3, s2, 7
    v_readfirstlane_b32 s36, v2
    s_lshr_b32 s38, s3, 1
    s_and_b32 s3, s3, 1
    s_lshl_b32 s3, s3, 3
    s_lshr_b32 s40, s2, 5
    s_add_u32 s37, s40, s3
    s_mul_i32 s41, s39, 3
    s_add_u32 s41, s41, s40
    s_cmp_ge_u32 s41, 9
    s_cselect_b32 s46, 9, 0
    s_sub_u32 s41, s41, s46
    s_mul_i32 s56, s41, 589824
    s_add_u32 s41, s41, 1
    s_cmp_eq_u32 s41, 9
    s_cselect_b32 s41, 0, s41
    s_mul_i32 s57, s41, 589824
    s_add_u32 s41, s41, 1
    s_cmp_eq_u32 s41, 9
    s_cselect_b32 s41, 0, s41
    s_mul_i32 s45, s38, 2304
    s_mul_i32 s44, s39, 768
    s_add_u32 s45, s45, s44
    s_lshl_b32 s51, s36, 11
    s_mul_i32 s50, s36, 20480
    v_lshrrev_b32 v128, 3, v1
    v_and_b32 v129, 7, v1
    s_lshl_b32 s43, s37, 7
    s_lshl_b32 s44, s36, 5
    s_add_u32 s43, s43, s44
    v_add_u32 v130, s43, v128
    v_mul_u32_u24 v130, 1152, v130
    v_lshrrev_b32 v131, 1, v128
    v_xor_b32 v131, v131, v129
    v_lshl_add_u32 v2, v131, 4, v130
    v_xor_b32 v3, 64, v2
    v_add_u32 v3, 8192, v3
    s_lshl_b32 s43, s36, 4
    v_add_u32 v130, s43, v128
    v_mul_u32_u24 v130, 9216, v130
    v_lshlrev_b32 v131, 1, v128
    v_and_b32 v131, 4, v131
    v_xor_b32 v131, v131, v129
    v_lshl_add_u32 v8, v131, 4, v130
    v_add_u32 v9, 72704, v8
    v_lshlrev_b32 v130, 1, v0
    s_mov_b32 s6, 0x240000
    s_mov_b32 s7, 0x00020000
    s_mov_b32 s10, 0x50dd00
    s_mov_b32 s11, 0x00020000
    s_mov_b32 s22, 0x2400
    s_mov_b32 s23, 0x00020000
    s_waitcnt lgkmcnt(0)
    s_add_u32 s8, s8, s45
    s_addc_u32 s9, s9, 0
    s_add_u32 m0, s50, 73728
    s_mul_hi_u32 s47, s56, 932068
    buffer_load_dwordx4 v2, s[4:7], s47 offen offset:0 lds
    buffer_load_dwordx4 v3, s[4:7], s47 offen offset:1024 lds
    s_add_u32 s47, s47, 16384
    buffer_load_dwordx4 v2, s[4:7], s47 offen offset:2048 lds
    buffer_load_dwordx4 v3, s[4:7], s47 offen offset:3072 lds
    s_add_u32 m0, s51, 0
    s_nop 0
    buffer_load_dwordx4 v8, s[8:11], s56 offen offset:0 lds
    buffer_load_dwordx4 v9, s[8:11], s56 offen offset:1024 lds
    buffer_load_ushort v128, v130, s[20:23], s45 offen
    buffer_load_ushort v129, v130, s[20:23], s45 offen offset:512
    s_add_u32 m0, s50, 77824
    s_mul_hi_u32 s47, s57, 932068
    buffer_load_dwordx4 v2, s[4:7], s47 offen offset:0 lds
    buffer_load_dwordx4 v3, s[4:7], s47 offen offset:1024 lds
    s_add_u32 s47, s47, 16384
    buffer_load_dwordx4 v2, s[4:7], s47 offen offset:2048 lds
    buffer_load_dwordx4 v3, s[4:7], s47 offen offset:3072 lds
    s_add_u32 m0, s51, 8192
    s_nop 0
    buffer_load_dwordx4 v8, s[8:11], s57 offen offset:0 lds
    buffer_load_dwordx4 v9, s[8:11], s57 offen offset:1024 lds
    s_mul_i32 s58, s41, 589824
    s_add_u32 s41, s41, 1
    s_cmp_eq_u32 s41, 9
    s_cselect_b32 s41, 0, s41
    s_mul_i32 s59, s41, 589824
    s_add_u32 s41, s41, 1
    s_cmp_eq_u32 s41, 9
    s_cselect_b32 s41, 0, s41
    s_mul_i32 s60, s41, 589824
    s_add_u32 s41, s41, 1
    s_cmp_eq_u32 s41, 9
    s_cselect_b32 s41, 0, s41
    s_mul_i32 s61, s41, 589824
    s_add_u32 s41, s41, 1
    s_cmp_eq_u32 s41, 9
    s_cselect_b32 s41, 0, s41
    s_mul_i32 s62, s41, 589824
    s_add_u32 s41, s41, 1
    s_cmp_eq_u32 s41, 9
    s_cselect_b32 s41, 0, s41
    s_mul_i32 s63, s41, 589824
    s_add_u32 s41, s41, 1
    s_cmp_eq_u32 s41, 9
    s_cselect_b32 s41, 0, s41
    s_mul_i32 s64, s41, 589824
    s_mov_b32 s49, 0x3fb8aa3b
    v_and_b32 v132, 31, v1
    v_lshrrev_b32 v133, 5, v1
    v_lshrrev_b32 v134, 1, v132
    v_and_b32 v134, 7, v134
    v_xor_b32 v134, v134, v133
    s_lshr_b32 s43, s36, 1
    s_mul_i32 s43, s43, 40960
    s_add_u32 s43, s43, 73728
    v_lshlrev_b32 v135, 7, v132
    v_add_u32 v135, s43, v135
    v_xor_b32 v136, 0, v134
    v_lshl_add_u32 v4, v136, 4, v135
    v_xor_b32 v136, 2, v134
    v_lshl_add_u32 v5, v136, 4, v135
    v_xor_b32 v136, 4, v134
    v_lshl_add_u32 v6, v136, 4, v135
    v_xor_b32 v136, 6, v134
    v_lshl_add_u32 v7, v136, 4, v135
    s_and_b32 s44, s36, 1
    s_lshl_b32 s43, s44, 7
    s_add_u32 s43, s43, 155648
    v_lshlrev_b32 v13, 4, v133
    v_add_u32 v13, s43, v13
    v_lshrrev_b32 v132, 2, v1
    v_and_b32 v132, 3, v132
    v_lshl_add_u32 v134, v133, 3, v132
    v_lshlrev_b32 v134, 7, v134
    v_lshrrev_b32 v135, 1, v132
    v_xor_b32 v135, s44, v135
    v_lshl_add_u32 v134, v135, 6, v134
    v_lshrrev_b32 v135, 4, v1
    v_and_b32 v135, 1, v135
    v_lshl_add_u32 v134, v135, 5, v134
    v_and_b32 v136, 3, v1
    v_lshl_add_u32 v10, v136, 3, v134
    v_add_u32 v11, 49152, v10
    v_add_u32 v12, 98304, v10
    s_add_u32 m0, s50, 81920
    s_mul_hi_u32 s47, s58, 932068
    buffer_load_dwordx4 v2, s[4:7], s47 offen offset:0 lds
    buffer_load_dwordx4 v3, s[4:7], s47 offen offset:1024 lds
    s_add_u32 s47, s47, 16384
    buffer_load_dwordx4 v2, s[4:7], s47 offen offset:2048 lds
    buffer_load_dwordx4 v3, s[4:7], s47 offen offset:3072 lds
    s_add_u32 m0, s51, 16384
    s_nop 0
    buffer_load_dwordx4 v8, s[8:11], s58 offen offset:0 lds
    buffer_load_dwordx4 v9, s[8:11], s58 offen offset:1024 lds
    s_waitcnt vmcnt(12)
    v_lshlrev_b32 v128, 16, v128
    v_lshlrev_b32 v129, 16, v129
    v_lshlrev_b32 v130, 2, v0
    v_add_u32 v130, 155648, v130
    ds_write_b32 v130, v128
    ds_write_b32 v130, v129 offset:1024
    s_lshl_b32 s43, s36, 2
    s_add_u32 s43, s43, 159744
    v_mov_b32 v14, s43
    v_mov_b32 v31, 0
    v_and_b32 v0, 3, v1
    v_lshlrev_b32 v0, 2, v0
    v_add_u32 v0, 159744, v0
    ds_write_b32 v14, v31
    s_waitcnt lgkmcnt(0)
    s_barrier
    ds_read_b128 v[96:99], v13 offset:0
    ds_read_b128 v[100:103], v13 offset:32
    ds_read_b128 v[104:107], v13 offset:64
    ds_read_b128 v[108:111], v13 offset:96
    ds_read_b64_tr_b16 v[112:113], v10 offset:0
    ds_read_b64_tr_b16 v[114:115], v10 offset:512
    ds_read_b128 a[0:3], v4 offset:0
    ds_read_b128 a[4:7], v5 offset:0
    ds_read_b128 a[8:11], v6 offset:0
    ds_read_b128 a[12:15], v7 offset:0
    ds_read_b128 a[208:211], v4 offset:20480
    ds_read_b128 a[212:215], v5 offset:20480
    ds_read_b128 a[216:219], v6 offset:20480
    ds_read_b128 a[220:223], v7 offset:20480
    ds_read_b64_tr_b16 v[116:117], v10 offset:2048
    ds_read_b64_tr_b16 v[118:119], v10 offset:2560
    ds_read_b64_tr_b16 v[120:121], v10 offset:4096
    ds_read_b64_tr_b16 v[122:123], v10 offset:4608
    ds_read_b64_tr_b16 v[124:125], v10 offset:6144
    ds_read_b64_tr_b16 v[126:127], v10 offset:6656
    s_waitcnt lgkmcnt(6)
    v_mfma_f32_32x32x16_bf16 v[32:47], v[112:115], a[0:3], v[96:111]
    s_waitcnt vmcnt(6)
    s_barrier
    s_waitcnt lgkmcnt(2)
    ds_read_b64_tr_b16 v[140:141], v10 offset:8192
    ds_read_b64_tr_b16 v[142:143], v10 offset:8704
    ds_read_b128 a[16:19], v4 offset:4096
    ds_read_b128 a[20:23], v5 offset:4096
    s_add_u32 m0, s50, 86016
    s_mul_hi_u32 s47, s59, 932068
    buffer_load_dwordx4 v2, s[4:7], s47 offen offset:0 lds
    v_mfma_f32_32x32x16_bf16 v[48:63], v[112:115], a[208:211], v[96:111]
    ds_read_b128 a[24:27], v6 offset:4096
    ds_read_b128 a[28:31], v7 offset:4096
    buffer_load_dwordx4 v3, s[4:7], s47 offen offset:1024 lds
    s_add_u32 s47, s47, 16384
    v_mfma_f32_32x32x16_bf16 v[32:47], v[116:119], a[4:7], v[32:47]
    ds_read_b64_tr_b16 v[112:113], v10 offset:10240
    ds_read_b64_tr_b16 v[114:115], v10 offset:10752
    ds_read_b128 a[224:227], v4 offset:24576
    ds_read_b128 a[228:231], v5 offset:24576
    buffer_load_dwordx4 v2, s[4:7], s47 offen offset:2048 lds
    v_mfma_f32_32x32x16_bf16 v[48:63], v[116:119], a[212:215], v[48:63]
    ds_read_b128 a[232:235], v6 offset:24576
    ds_read_b128 a[236:239], v7 offset:24576
    buffer_load_dwordx4 v3, s[4:7], s47 offen offset:3072 lds
    s_add_u32 m0, s51, 24576
    s_mov_b32 s14, 0x10000000
    s_mov_b32 s15, 0x00020000
    s_mov_b32 s18, 0x510000
    s_mov_b32 s19, 0x00020000
    v_mfma_f32_32x32x16_bf16 v[32:47], v[120:123], a[8:11], v[32:47]
    s_waitcnt lgkmcnt(0)
    ds_read_b64_tr_b16 v[116:117], v10 offset:12288
    ds_read_b64_tr_b16 v[118:119], v10 offset:12800
    buffer_load_dwordx4 v8, s[8:11], s59 offen offset:0 lds
    v_mfma_f32_32x32x16_bf16 v[48:63], v[120:123], a[216:219], v[48:63]
    buffer_load_dwordx4 v9, s[8:11], s59 offen offset:1024 lds
    s_add_u32 m0, s50, 90112
    s_mul_hi_u32 s47, s60, 932068
    s_mov_b32 s30, 0x100
    s_mov_b32 s31, 0x00020000
    s_mov_b32 s26, 0x240000
    s_mov_b32 s27, 0x00020000
    v_mfma_f32_32x32x16_bf16 v[32:47], v[124:127], a[12:15], v[32:47]
    ds_read_b64_tr_b16 v[120:121], v10 offset:14336
    ds_read_b64_tr_b16 v[122:123], v10 offset:14848
    buffer_load_dwordx4 v2, s[4:7], s47 offen offset:0 lds
    v_mfma_f32_32x32x16_bf16 v[48:63], v[124:127], a[220:223], v[48:63]
    buffer_load_dwordx4 v3, s[4:7], s47 offen offset:1024 lds
    s_add_u32 s47, s47, 16384
    v_lshlrev_b32 v17, 4, v1
    s_lshl_b32 s43, s37, 2
    s_add_u32 s43, s43, s38
    s_lshl_b32 s48, s43, 2
    v_mfma_f32_32x32x16_bf16 v[32:47], v[140:143], a[16:19], v[32:47]
    s_waitcnt vmcnt(8)
    s_barrier
    s_waitcnt lgkmcnt(2)
    ds_read_b64_tr_b16 v[124:125], v10 offset:16384
    ds_read_b64_tr_b16 v[126:127], v10 offset:16896
    ds_read_b128 a[32:35], v4 offset:8192
    ds_read_b128 a[36:39], v5 offset:8192
    buffer_load_dwordx4 v2, s[4:7], s47 offen offset:2048 lds
    v_mfma_f32_32x32x16_bf16 v[48:63], v[140:143], a[224:227], v[48:63]
    ds_read_b128 a[40:43], v6 offset:8192
    ds_read_b128 a[44:47], v7 offset:8192
    buffer_load_dwordx4 v3, s[4:7], s47 offen offset:3072 lds
    s_add_u32 m0, s51, 32768
    s_lshl_b32 s42, s43, 3
    s_add_u32 s42, s42, s39
    s_lshl_b32 s42, s42, 2
    s_add_u32 s42, s42, s36
    v_mfma_f32_32x32x16_bf16 v[32:47], v[112:115], a[20:23], v[32:47]
    ds_read_b64_tr_b16 v[140:141], v10 offset:18432
    ds_read_b64_tr_b16 v[142:143], v10 offset:18944
    ds_read_b128 a[240:243], v4 offset:28672
    ds_read_b128 a[244:247], v5 offset:28672
    buffer_load_dwordx4 v8, s[8:11], s60 offen offset:0 lds
    v_mfma_f32_32x32x16_bf16 v[48:63], v[112:115], a[228:231], v[48:63]
    ds_read_b128 a[248:251], v6 offset:28672
    ds_read_b128 a[252:255], v7 offset:28672
    buffer_load_dwordx4 v9, s[8:11], s60 offen offset:1024 lds
    s_add_u32 m0, s50, 73728
    s_mul_hi_u32 s47, s61, 932068
    s_lshl_b32 s42, s42, 2
    s_add_u32 s42, s42, 37748736
    s_add_u32 s48, s48, s36
    s_mul_i32 s48, s48, 73728
    v_mfma_f32_32x32x16_bf16 v[32:47], v[116:119], a[24:27], v[32:47]
    s_waitcnt lgkmcnt(0)
    ds_read_b64_tr_b16 v[112:113], v10 offset:20480
    ds_read_b64_tr_b16 v[114:115], v10 offset:20992
    buffer_load_dwordx4 v2, s[4:7], s47 offen offset:0 lds
    v_mfma_f32_32x32x16_bf16 v[48:63], v[116:119], a[232:235], v[48:63]
    buffer_load_dwordx4 v3, s[4:7], s47 offen offset:1024 lds
    s_add_u32 s47, s47, 16384
    s_mul_i32 s43, s39, 24576
    s_add_u32 s48, s48, s43
    s_add_u32 s43, s51, 147456
    v_add_u32 v15, s43, v17
    v_mfma_f32_32x32x16_bf16 v[32:47], v[120:123], a[28:31], v[32:47]
    ds_read_b64_tr_b16 v[116:117], v10 offset:22528
    ds_read_b64_tr_b16 v[118:119], v10 offset:23040
    buffer_load_dwordx4 v2, s[4:7], s47 offen offset:2048 lds
    v_mfma_f32_32x32x16_bf16 v[48:63], v[120:123], a[236:239], v[48:63]
    buffer_load_dwordx4 v3, s[4:7], s47 offen offset:3072 lds
    s_add_u32 m0, s51, 40960
    v_xor_b32 v16, 2048, v15
    v_lshrrev_b32 v133, 5, v1
    v_lshrrev_b32 v132, 2, v1
    v_and_b32 v132, 3, v132
    v_mfma_f32_32x32x16_bf16 v[32:47], v[124:127], a[32:35], v[32:47]
    s_waitcnt vmcnt(10)
    s_barrier
    s_waitcnt lgkmcnt(2)
    ds_read_b64_tr_b16 v[120:121], v10 offset:24576
    ds_read_b64_tr_b16 v[122:123], v10 offset:25088
    ds_read_b128 a[48:51], v4 offset:12288
    ds_read_b128 a[52:55], v5 offset:12288
    buffer_load_dwordx4 v8, s[8:11], s61 offen offset:0 lds
    v_mfma_f32_32x32x16_bf16 v[48:63], v[124:127], a[240:243], v[48:63]
    ds_read_b128 a[56:59], v6 offset:12288
    ds_read_b128 a[60:63], v7 offset:12288
    buffer_load_dwordx4 v9, s[8:11], s61 offen offset:1024 lds
    s_add_u32 m0, s50, 77824
    s_mul_hi_u32 s47, s62, 932068
    v_lshrrev_b32 v135, 4, v1
    v_and_b32 v135, 1, v135
    v_and_b32 v136, 3, v1
    v_lshl_add_u32 v133, v133, 2, v132
    v_mfma_f32_32x32x16_bf16 v[32:47], v[140:143], a[36:39], v[32:47]
    ds_read_b64_tr_b16 v[124:125], v10 offset:26624
    ds_read_b64_tr_b16 v[126:127], v10 offset:27136
    ds_read_b128 a[144:147], v4 offset:32768
    ds_read_b128 a[148:151], v5 offset:32768
    buffer_load_dwordx4 v2, s[4:7], s47 offen offset:0 lds
    v_mfma_f32_32x32x16_bf16 v[48:63], v[140:143], a[244:247], v[48:63]
    ds_read_b128 a[152:155], v6 offset:32768
    ds_read_b128 a[156:159], v7 offset:32768
    buffer_load_dwordx4 v3, s[4:7], s47 offen offset:1024 lds
    s_add_u32 s47, s47, 16384
    v_mul_u32_u24 v133, 384, v133
    v_lshl_add_u32 v133, v135, 5, v133
    v_lshl_add_u32 v133, v136, 3, v133
    v_lshrrev_b32 v132, 1, v132
    v_mfma_f32_32x32x16_bf16 v[32:47], v[112:115], a[40:43], v[32:47]
    s_waitcnt lgkmcnt(0)
    ds_read_b64_tr_b16 v[140:141], v10 offset:28672
    ds_read_b64_tr_b16 v[142:143], v10 offset:29184
    buffer_load_dwordx4 v2, s[4:7], s47 offen offset:2048 lds
    v_mfma_f32_32x32x16_bf16 v[48:63], v[112:115], a[248:251], v[48:63]
    buffer_load_dwordx4 v3, s[4:7], s47 offen offset:3072 lds
    s_add_u32 m0, s51, 49152
    v_lshlrev_b32 v132, 6, v132
    v_add_u32 v24, v133, v132
    v_sub_u32 v25, v133, v132
    v_add_u32 v26, 49152, v24
    v_mfma_f32_32x32x16_bf16 v[32:47], v[116:119], a[44:47], v[32:47]
    ds_read_b64_tr_b16 v[112:113], v10 offset:30720
    ds_read_b64_tr_b16 v[114:115], v10 offset:31232
    buffer_load_dwordx4 v8, s[8:11], s62 offen offset:0 lds
    v_mfma_f32_32x32x16_bf16 v[48:63], v[116:119], a[252:255], v[48:63]
    buffer_load_dwordx4 v9, s[8:11], s62 offen offset:1024 lds
    s_add_u32 m0, s50, 81920
    s_mul_hi_u32 s47, s63, 932068
    v_add_u32 v27, 49152, v25
    v_add_u32 v28, 98304, v24
    v_add_u32 v29, 98304, v25
    s_mul_i32 s3, s36, 6144
    v_mfma_f32_32x32x16_bf16 v[32:47], v[120:123], a[48:51], v[32:47]
    s_waitcnt vmcnt(12)
    s_barrier
    s_waitcnt lgkmcnt(2)
    ds_read_b64_tr_b16 v[116:117], v10 offset:32768
    ds_read_b64_tr_b16 v[118:119], v10 offset:33280
    ds_read_b128 a[64:67], v4 offset:16384
    ds_read_b128 a[68:71], v5 offset:16384
    buffer_load_dwordx4 v2, s[4:7], s47 offen offset:0 lds
    v_mfma_f32_32x32x16_bf16 v[48:63], v[120:123], a[144:147], v[48:63]
    ds_read_b128 a[72:75], v6 offset:16384
    ds_read_b128 a[76:79], v7 offset:16384
    buffer_load_dwordx4 v3, s[4:7], s47 offen offset:1024 lds
    s_add_u32 s47, s47, 16384
    s_mul_i32 s43, s39, 24576
    s_sub_u32 s43, s48, s43
    s_mul_i32 s44, s38, 1327104
    s_mul_i32 s45, s39, 384
    v_mfma_f32_32x32x16_bf16 v[32:47], v[124:127], a[52:55], v[32:47]
    ds_read_b64_tr_b16 v[120:121], v10 offset:34816
    ds_read_b64_tr_b16 v[122:123], v10 offset:35328
    ds_read_b128 a[160:163], v4 offset:36864
    ds_read_b128 a[164:167], v5 offset:36864
    buffer_load_dwordx4 v2, s[4:7], s47 offen offset:2048 lds
    v_mfma_f32_32x32x16_bf16 v[48:63], v[124:127], a[148:151], v[48:63]
    ds_read_b128 a[168:171], v6 offset:36864
    ds_read_b128 a[172:175], v7 offset:36864
    buffer_load_dwordx4 v3, s[4:7], s47 offen offset:3072 lds
    s_add_u32 m0, s51, 57344
    s_add_u32 s44, s44, s45
    s_add_u32 s45, s39, 0
    s_cmp_ge_u32 s45, 3
    s_cselect_b32 s46, 3, 0
    v_mfma_f32_32x32x16_bf16 v[32:47], v[140:143], a[56:59], v[32:47]
    s_waitcnt lgkmcnt(0)
    ds_read_b64_tr_b16 v[124:125], v10 offset:36864
    ds_read_b64_tr_b16 v[126:127], v10 offset:37376
    buffer_load_dwordx4 v8, s[8:11], s63 offen offset:0 lds
    v_mfma_f32_32x32x16_bf16 v[48:63], v[140:143], a[152:155], v[48:63]
    buffer_load_dwordx4 v9, s[8:11], s63 offen offset:1024 lds
    s_add_u32 m0, s50, 86016
    s_mul_hi_u32 s47, s64, 932068
    s_sub_u32 s45, s45, s46
    s_mul_i32 s46, s45, 442368
    s_add_u32 s66, s44, s46
    s_mul_i32 s46, s45, 24576
    v_mfma_f32_32x32x16_bf16 v[32:47], v[112:115], a[60:63], v[32:47]
    ds_read_b64_tr_b16 v[140:141], v10 offset:38912
    ds_read_b64_tr_b16 v[142:143], v10 offset:39424
    buffer_load_dwordx4 v2, s[4:7], s47 offen offset:0 lds
    v_mfma_f32_32x32x16_bf16 v[48:63], v[112:115], a[156:159], v[48:63]
    buffer_load_dwordx4 v3, s[4:7], s47 offen offset:1024 lds
    s_add_u32 s47, s47, 16384
    s_add_u32 s70, s43, s46
    s_add_u32 s45, s39, 1
    s_cmp_ge_u32 s45, 3
    s_cselect_b32 s46, 3, 0
    v_mfma_f32_32x32x16_bf16 v[32:47], v[116:119], a[64:67], v[32:47]
    s_waitcnt vmcnt(14)
    s_barrier
    s_waitcnt lgkmcnt(2)
    ds_read_b64_tr_b16 v[112:113], v10 offset:40960
    ds_read_b64_tr_b16 v[114:115], v10 offset:41472
    ds_read_b128 a[80:83], v4 offset:0
    ds_read_b128 a[84:87], v5 offset:0
    buffer_load_dwordx4 v2, s[4:7], s47 offen offset:2048 lds
    v_mfma_f32_32x32x16_bf16 v[48:63], v[116:119], a[160:163], v[48:63]
    ds_read_b128 a[88:91], v6 offset:0
    ds_read_b128 a[92:95], v7 offset:0
    buffer_load_dwordx4 v3, s[4:7], s47 offen offset:3072 lds
    s_add_u32 m0, s51, 65536
    s_sub_u32 s45, s45, s46
    s_mov_b32 s79, s45
    s_mul_i32 s46, s45, 442368
    s_add_u32 s67, s44, s46
    v_mfma_f32_32x32x16_bf16 v[32:47], v[120:123], a[68:71], v[32:47]
    ds_read_b64_tr_b16 v[116:117], v10 offset:43008
    ds_read_b64_tr_b16 v[118:119], v10 offset:43520
    ds_read_b128 a[176:179], v4 offset:20480
    ds_read_b128 a[180:183], v5 offset:20480
    buffer_load_dwordx4 v8, s[8:11], s64 offen offset:0 lds
    v_mfma_f32_32x32x16_bf16 v[48:63], v[120:123], a[164:167], v[48:63]
    ds_read_b128 a[184:187], v6 offset:20480
    ds_read_b128 a[188:191], v7 offset:20480
    buffer_load_dwordx4 v9, s[8:11], s64 offen offset:1024 lds
    s_add_u32 s8, s8, 128
    s_addc_u32 s9, s9, 0
    s_add_u32 m0, s51, 0
    s_mul_i32 s46, s45, 24576
    s_add_u32 s71, s43, s46
    s_add_u32 s45, s39, 2
    s_cmp_ge_u32 s45, 3
    s_cselect_b32 s46, 3, 0
    v_mfma_f32_32x32x16_bf16 v[32:47], v[124:127], a[72:75], v[32:47]
    s_waitcnt lgkmcnt(0)
    ds_read_b64_tr_b16 v[120:121], v10 offset:45056
    ds_read_b64_tr_b16 v[122:123], v10 offset:45568
    buffer_load_dwordx4 v8, s[8:11], s56 offen offset:0 lds
    v_mfma_f32_32x32x16_bf16 v[48:63], v[124:127], a[168:171], v[48:63]
    s_sub_u32 s45, s45, s46
    s_mov_b32 s80, s45
    s_mul_i32 s46, s45, 442368
    s_add_u32 s68, s44, s46
    v_mfma_f32_32x32x16_bf16 v[32:47], v[140:143], a[76:79], v[32:47]
    ds_read_b64_tr_b16 v[124:125], v10 offset:47104
    ds_read_b64_tr_b16 v[126:127], v10 offset:47616
    buffer_load_dwordx4 v9, s[8:11], s56 offen offset:1024 lds
    s_add_u32 m0, s51, 8192
    v_mfma_f32_32x32x16_bf16 v[48:63], v[140:143], a[172:175], v[48:63]
    s_mul_i32 s46, s45, 24576
    s_add_u32 s72, s43, s46
    s_mul_i32 s43, s36, 18432
    s_add_u32 s44, s38, 1
    v_mfma_f32_32x32x16_bf16 v[32:47], v[112:115], a[80:83], v[32:47]
    s_waitcnt vmcnt(14)
    s_barrier
    s_waitcnt lgkmcnt(2)
    ds_read_b64_tr_b16 v[140:141], v11 offset:0
    ds_read_b64_tr_b16 v[142:143], v11 offset:512
    ds_read_b128 a[96:99], v4 offset:4096
    ds_read_b128 a[100:103], v5 offset:4096
    buffer_load_dwordx4 v8, s[8:11], s57 offen offset:0 lds
    v_mfma_f32_32x32x16_bf16 v[48:63], v[112:115], a[176:179], v[48:63]
    ds_read_b128 a[104:107], v6 offset:4096
    ds_read_b128 a[108:111], v7 offset:4096
    s_and_b32 s44, s44, 3
    s_mul_i32 s44, s44, 6
    v_add_u32 v132, 0, v1
    v_mul_u32_u24 v133, 2731, v132
    v_mfma_f32_32x32x16_bf16 v[32:47], v[116:119], a[84:87], v[32:47]
    ds_read_b64_tr_b16 v[112:113], v11 offset:2048
    ds_read_b64_tr_b16 v[114:115], v11 offset:2560
    ds_read_b128 a[192:195], v4 offset:24576
    ds_read_b128 a[196:199], v5 offset:24576
    buffer_load_dwordx4 v9, s[8:11], s57 offen offset:1024 lds
    s_add_u32 m0, s51, 16384
    v_mfma_f32_32x32x16_bf16 v[48:63], v[116:119], a[180:183], v[48:63]
    ds_read_b128 a[200:203], v6 offset:24576
    ds_read_b128 a[204:207], v7 offset:24576
    v_lshrrev_b32 v133, 16, v133
    v_mul_u32_u24 v134, 24, v133
    v_sub_u32 v134, v132, v134
    v_lshlrev_b32 v135, 1, v133
    v_mfma_f32_32x32x16_bf16 v[32:47], v[120:123], a[88:91], v[32:47]
    s_waitcnt lgkmcnt(0)
    ds_read_b64_tr_b16 v[116:117], v11 offset:4096
    ds_read_b64_tr_b16 v[118:119], v11 offset:4608
    ds_read_b128 v[96:99], v13 offset:256
    ds_read_b128 v[100:103], v13 offset:288
    ds_read_b128 v[104:107], v13 offset:320
    ds_read_b128 v[108:111], v13 offset:352
    buffer_load_dwordx4 v8, s[8:11], s58 offen offset:0 lds
    v_mfma_f32_32x32x16_bf16 v[48:63], v[120:123], a[184:187], v[48:63]
    v_and_b32 v135, 4, v135
    v_xor_b32 v134, v134, v135
    v_add_u32 v134, s44, v134
    v_subrev_u32 v135, 24, v134
    v_mfma_f32_32x32x16_bf16 v[32:47], v[124:127], a[92:95], v[32:47]
    ds_read_b64_tr_b16 v[120:121], v11 offset:6144
    ds_read_b64_tr_b16 v[122:123], v11 offset:6656
    buffer_load_dwordx4 v9, s[8:11], s58 offen offset:1024 lds
    v_mfma_f32_32x32x16_bf16 v[48:63], v[124:127], a[188:191], v[48:63]
    v_min_u32 v134, v134, v135
    v_mul_u32_u24 v133, 1152, v133
    v_lshl_add_u32 v133, v134, 4, v133
    v_add_u32 v133, s43, v133
    v_mfma_f32_32x32x16_bf16 v[32:47], v[140:143], a[96:99], v[32:47]
    s_waitcnt vmcnt(6)
    s_barrier
    s_waitcnt lgkmcnt(6)
    ds_read_b64_tr_b16 v[124:125], v11 offset:8192
    ds_read_b64_tr_b16 v[126:127], v11 offset:8704
    ds_read_b128 a[112:115], v4 offset:8192
    ds_read_b128 a[116:119], v5 offset:8192
    ds_read_b128 a[120:123], v6 offset:8192
    ds_read_b128 a[124:127], v7 offset:8192
    s_add_u32 m0, s51, 24576
    v_mfma_f32_32x32x16_bf16 v[48:63], v[140:143], a[192:195], v[48:63]
    ds_read_b128 v[224:227], v4 offset:28672
    ds_read_b128 v[228:231], v5 offset:28672
    ds_read_b128 v[232:235], v6 offset:28672
    ds_read_b128 v[236:239], v7 offset:28672
    v_add_u32 v18, 0x0, v133
    v_add_u32 v21, 0x1800, v133
    v_add_u32 v132, 64, v1
    v_mul_u32_u24 v133, 2731, v132
    v_mfma_f32_32x32x16_bf16 v[32:47], v[112:115], a[100:103], v[32:47]
    ds_read_b64_tr_b16 v[140:141], v11 offset:10240
    ds_read_b64_tr_b16 v[142:143], v11 offset:10752
    ds_read_b128 a[128:131], v4 offset:12288
    ds_read_b128 a[132:135], v5 offset:12288
    buffer_load_dwordx4 v8, s[8:11], s59 offen offset:0 lds
    v_mfma_f32_32x32x16_bf16 v[48:63], v[112:115], a[196:199], v[48:63]
    ds_read_b128 a[136:139], v6 offset:12288
    ds_read_b128 a[140:143], v7 offset:12288
    v_lshrrev_b32 v133, 16, v133
    v_mul_u32_u24 v134, 24, v133
    v_sub_u32 v134, v132, v134
    v_lshlrev_b32 v135, 1, v133
    v_mfma_f32_32x32x16_bf16 v[32:47], v[116:119], a[104:107], v[32:47]
    s_waitcnt lgkmcnt(6)
    ds_read_b64_tr_b16 v[112:113], v11 offset:12288
    ds_read_b64_tr_b16 v[114:115], v11 offset:12800
    ds_read_b128 v[240:243], v4 offset:32768
    ds_read_b128 v[244:247], v5 offset:32768
    buffer_load_dwordx4 v9, s[8:11], s59 offen offset:1024 lds
    s_add_u32 m0, s51, 32768
    v_mfma_f32_32x32x16_bf16 v[48:63], v[116:119], a[200:203], v[48:63]
    ds_read_b128 v[248:251], v6 offset:32768
    ds_read_b128 v[252:255], v7 offset:32768
    v_and_b32 v135, 4, v135
    v_xor_b32 v134, v134, v135
    v_add_u32 v134, s44, v134
    v_subrev_u32 v135, 24, v134
    v_mfma_f32_32x32x16_bf16 v[32:47], v[120:123], a[108:111], v[32:47]
    ds_read_b64_tr_b16 v[116:117], v11 offset:14336
    ds_read_b64_tr_b16 v[118:119], v11 offset:14848
    buffer_load_dwordx4 v8, s[8:11], s60 offen offset:0 lds
    v_mfma_f32_32x32x16_bf16 v[48:63], v[120:123], a[204:207], v[48:63]
    v_min_u32 v134, v134, v135
    v_mul_u32_u24 v133, 1152, v133
    v_lshl_add_u32 v133, v134, 4, v133
    v_add_u32 v133, s43, v133
    v_mfma_f32_32x32x16_bf16 v[32:47], v[124:127], a[112:115], v[32:47]
    s_waitcnt lgkmcnt(2)
    s_barrier
    ds_read_b64_tr_b16 v[120:121], v11 offset:16384
    ds_read_b64_tr_b16 v[122:123], v11 offset:16896
    buffer_load_dwordx4 v9, s[8:11], s60 offen offset:1024 lds
    s_add_u32 m0, s51, 40960
    v_mfma_f32_32x32x16_bf16 v[48:63], v[124:127], v[224:227], v[48:63]
    buffer_load_dwordx4 v8, s[8:11], s61 offen offset:0 lds
    v_add_u32 v19, 0xfffffc00, v133
    v_add_u32 v22, 0x2400, v133
    v_add_u32 v132, 128, v1
    v_mul_u32_u24 v133, 2731, v132
    v_mfma_f32_32x32x16_bf16 v[32:47], v[140:143], a[116:119], v[32:47]
    ds_read_b64_tr_b16 v[124:125], v11 offset:18432
    ds_read_b64_tr_b16 v[126:127], v11 offset:18944
    buffer_load_dwordx4 v9, s[8:11], s61 offen offset:1024 lds
    s_add_u32 m0, s51, 73728
    v_mfma_f32_32x32x16_bf16 v[48:63], v[140:143], v[228:231], v[48:63]
    buffer_load_dwordx4 v8, s[8:11], s62 offen offset:0 lds
    v_lshrrev_b32 v133, 16, v133
    v_mul_u32_u24 v134, 24, v133
    v_sub_u32 v134, v132, v134
    v_lshlrev_b32 v135, 1, v133
    v_mfma_f32_32x32x16_bf16 v[32:47], v[112:115], a[120:123], v[32:47]
    s_waitcnt lgkmcnt(2)
    ds_read_b64_tr_b16 v[140:141], v11 offset:20480
    ds_read_b64_tr_b16 v[142:143], v11 offset:20992
    buffer_load_dwordx4 v9, s[8:11], s62 offen offset:1024 lds
    s_add_u32 m0, s51, 81920
    v_mfma_f32_32x32x16_bf16 v[48:63], v[112:115], v[232:235], v[48:63]
    buffer_load_dwordx4 v8, s[8:11], s63 offen offset:0 lds
    v_and_b32 v135, 4, v135
    v_xor_b32 v134, v134, v135
    v_add_u32 v134, s44, v134
    v_subrev_u32 v135, 24, v134
    v_mfma_f32_32x32x16_bf16 v[32:47], v[116:119], a[124:127], v[32:47]
    ds_read_b64_tr_b16 v[112:113], v11 offset:22528
    ds_read_b64_tr_b16 v[114:115], v11 offset:23040
    buffer_load_dwordx4 v9, s[8:11], s63 offen offset:1024 lds
    s_add_u32 m0, s51, 90112
    v_mfma_f32_32x32x16_bf16 v[48:63], v[116:119], v[236:239], v[48:63]
    buffer_load_dwordx4 v8, s[8:11], s64 offen offset:0 lds
    v_min_u32 v134, v134, v135
    v_mul_u32_u24 v133, 1152, v133
    v_lshl_add_u32 v133, v134, 4, v133
    v_add_u32 v133, s43, v133
    v_mfma_f32_32x32x16_bf16 v[32:47], v[120:123], a[128:131], v[32:47]
    s_waitcnt vmcnt(11)
    s_barrier
    s_waitcnt lgkmcnt(2)
    ds_read_b64_tr_b16 v[116:117], v10 offset:0
    ds_read_b64_tr_b16 v[118:119], v10 offset:512
    buffer_load_dwordx4 v9, s[8:11], s64 offen offset:1024 lds
    s_add_u32 s8, s8, 128
    s_addc_u32 s9, s9, 0
    s_add_u32 m0, s51, 98304
    v_mfma_f32_32x32x16_bf16 v[48:63], v[120:123], v[240:243], v[48:63]
    buffer_load_dwordx4 v8, s[8:11], s56 offen offset:0 lds
    v_add_u32 v20, 0xfffff800, v133
    v_add_u32 v23, 0x2000, v133
    s_mul_i32 s74, s37, 3
    s_add_u32 s74, s74, s39
    v_mfma_f32_32x32x16_bf16 v[32:47], v[124:127], a[132:135], v[32:47]
    ds_read_b64_tr_b16 v[120:121], v10 offset:2048
    ds_read_b64_tr_b16 v[122:123], v10 offset:2560
    buffer_load_dwordx4 v9, s[8:11], s56 offen offset:1024 lds
    s_add_u32 m0, s51, 106496
    v_mfma_f32_32x32x16_bf16 v[48:63], v[124:127], v[244:247], v[48:63]
    buffer_load_dwordx4 v8, s[8:11], s57 offen offset:0 lds
    s_lshl_b32 s82, s74, 2
    s_lshl_b32 s74, s74, 11
    s_add_u32 s74, s74, 38010880
    v_mfma_f32_32x32x16_bf16 v[32:47], v[140:143], a[136:139], v[32:47]
    s_waitcnt lgkmcnt(2)
    ds_read_b64_tr_b16 v[124:125], v10 offset:4096
    ds_read_b64_tr_b16 v[126:127], v10 offset:4608
    buffer_load_dwordx4 v9, s[8:11], s57 offen offset:1024 lds
    s_add_u32 m0, s51, 114688
    v_mfma_f32_32x32x16_bf16 v[48:63], v[140:143], v[248:251], v[48:63]
    buffer_load_dwordx4 v8, s[8:11], s58 offen offset:0 lds
    v_mfma_f32_32x32x16_bf16 v[64:79], v[112:115], a[140:143], v[32:47]
    ds_read_b64_tr_b16 v[140:141], v10 offset:6144
    ds_read_b64_tr_b16 v[142:143], v10 offset:6656
    buffer_load_dwordx4 v9, s[8:11], s58 offen offset:1024 lds
    s_add_u32 m0, s51, 122880
    v_mfma_f32_32x32x16_bf16 v[80:95], v[112:115], v[252:255], v[48:63]
    v_mfma_f32_32x32x16_bf16 v[32:47], v[116:119], a[0:3], v[96:111]
    s_waitcnt lgkmcnt(2)
    ds_read_b64_tr_b16 v[112:113], v10 offset:8192
    ds_read_b64_tr_b16 v[114:115], v10 offset:8704
    v_mfma_f32_32x32x16_bf16 v[48:63], v[116:119], a[208:211], v[96:111]
    v_mfma_f32_32x32x16_bf16 v[32:47], v[120:123], a[4:7], v[32:47]
    ds_read_b64_tr_b16 v[116:117], v10 offset:10240
    ds_read_b64_tr_b16 v[118:119], v10 offset:10752
    buffer_load_dwordx4 v8, s[8:11], s59 offen offset:0 lds
    v_mul_f32 v128, s49, v64
    v_mul_f32 v130, s49, v65
    v_mul_f32 v132, s49, v66
    v_mfma_f32_32x32x16_bf16 v[48:63], v[120:123], a[212:215], v[48:63]
    v_mul_f32 v134, s49, v67
    v_mul_f32 v136, s49, v68
    v_mul_f32 v138, s49, v69
    v_exp_f32 v128, v128
    v_exp_f32 v130, v130
    v_fma_f32 v129, v128, -0.5, -1.0
    v_exp_f32 v132, v132
    v_mfma_f32_32x32x16_bf16 v[32:47], v[124:127], a[8:11], v[32:47]
    s_waitcnt lgkmcnt(2)
    ds_read_b64_tr_b16 v[120:121], v10 offset:12288
    ds_read_b64_tr_b16 v[122:123], v10 offset:12800
    v_fma_f32 v131, v130, -0.5, -1.0
    v_fma_f32 v129, v128, v129, -1.0
    v_fma_f32 v131, v130, v131, -1.0
    v_mfma_f32_32x32x16_bf16 v[48:63], v[124:127], a[216:219], v[48:63]
    v_fma_f32 v133, v132, -0.5, -1.0
    v_fma_f32 v133, v132, v133, -1.0
    v_mul_f32 v128, s49, v70
    v_mul_f32 v130, s49, v71
    v_rcp_f32 v129, v129
    v_rcp_f32 v131, v131
    v_mfma_f32_32x32x16_bf16 v[32:47], v[140:143], a[12:15], v[32:47]
    ds_read_b64_tr_b16 v[124:125], v10 offset:14336
    ds_read_b64_tr_b16 v[126:127], v10 offset:14848
    buffer_load_dwordx4 v9, s[8:11], s59 offen offset:1024 lds
    s_add_u32 m0, s51, 131072
    v_fmac_f32 v64, v64, v129
    v_fmac_f32 v65, v65, v131
    v_mfma_f32_32x32x16_bf16 v[48:63], v[140:143], a[220:223], v[48:63]
    v_cvt_pk_bf16_f32 v208, v64, v65
    v_exp_f32 v134, v134
    v_mul_f32 v132, s49, v72
    v_rcp_f32 v133, v133
    v_mfma_f32_32x32x16_bf16 v[32:47], v[112:115], a[16:19], v[32:47]
    s_waitcnt lgkmcnt(2)
    ds_read_b64_tr_b16 v[140:141], v10 offset:16384
    ds_read_b64_tr_b16 v[142:143], v10 offset:16896
    v_fma_f32 v135, v134, -0.5, -1.0
    v_fma_f32 v135, v134, v135, -1.0
    v_fmac_f32 v66, v66, v133
    v_mfma_f32_32x32x16_bf16 v[48:63], v[112:115], a[224:227], v[48:63]
    v_mul_f32 v134, s49, v73
    v_rcp_f32 v135, v135
    v_exp_f32 v136, v136
    v_fmac_f32 v67, v67, v135
    v_mfma_f32_32x32x16_bf16 v[32:47], v[116:119], a[20:23], v[32:47]
    ds_read_b64_tr_b16 v[112:113], v10 offset:18432
    ds_read_b64_tr_b16 v[114:115], v10 offset:18944
    buffer_load_dwordx4 v8, s[8:11], s60 offen offset:0 lds
    v_cvt_pk_bf16_f32 v209, v66, v67
    v_fma_f32 v137, v136, -0.5, -1.0
    v_fma_f32 v137, v136, v137, -1.0
    v_mfma_f32_32x32x16_bf16 v[48:63], v[116:119], a[228:231], v[48:63]
    v_exp_f32 v138, v138
    v_rcp_f32 v137, v137
    v_exp_f32 v128, v128
    v_mfma_f32_32x32x16_bf16 v[32:47], v[120:123], a[24:27], v[32:47]
    s_waitcnt lgkmcnt(2)
    ds_read_b64_tr_b16 v[116:117], v10 offset:20480
    ds_read_b64_tr_b16 v[118:119], v10 offset:20992
    v_fma_f32 v139, v138, -0.5, -1.0
    v_fma_f32 v139, v138, v139, -1.0
    v_fmac_f32 v68, v68, v137
    v_mfma_f32_32x32x16_bf16 v[48:63], v[120:123], a[232:235], v[48:63]
    v_fma_f32 v129, v128, -0.5, -1.0
    v_fma_f32 v129, v128, v129, -1.0
    v_rcp_f32 v139, v139
    v_exp_f32 v130, v130
    v_mfma_f32_32x32x16_bf16 v[32:47], v[124:127], a[28:31], v[32:47]
    ds_read_b64_tr_b16 v[120:121], v10 offset:22528
    ds_read_b64_tr_b16 v[122:123], v10 offset:23040
    buffer_load_dwordx4 v9, s[8:11], s60 offen offset:1024 lds
    s_add_u32 m0, s51, 139264
    v_fmac_f32 v69, v69, v139
    v_cvt_pk_bf16_f32 v210, v68, v69
    v_mfma_f32_32x32x16_bf16 v[48:63], v[124:127], a[236:239], v[48:63]
    v_fma_f32 v131, v130, -0.5, -1.0
    v_fma_f32 v131, v130, v131, -1.0
    v_rcp_f32 v129, v129
    v_rcp_f32 v131, v131
    v_mfma_f32_32x32x16_bf16 v[32:47], v[140:143], a[32:35], v[32:47]
    s_waitcnt vmcnt(16)
    s_barrier
    s_waitcnt lgkmcnt(2)
    ds_read_b64_tr_b16 v[124:125], v10 offset:24576
    ds_read_b64_tr_b16 v[126:127], v10 offset:25088
    v_fmac_f32 v70, v70, v129
    v_mfma_f32_32x32x16_bf16 v[48:63], v[140:143], a[240:243], v[48:63]
    v_fmac_f32 v71, v71, v131
    v_cvt_pk_bf16_f32 v211, v70, v71
    v_exp_f32 v132, v132
    v_exp_f32 v134, v134
    v_mfma_f32_32x32x16_bf16 v[32:47], v[112:115], a[36:39], v[32:47]
    ds_read_b64_tr_b16 v[140:141], v10 offset:26624
    ds_read_b64_tr_b16 v[142:143], v10 offset:27136
    buffer_load_dwordx4 v8, s[8:11], s61 offen offset:0 lds
    v_fma_f32 v133, v132, -0.5, -1.0
    v_fma_f32 v135, v134, -0.5, -1.0
    v_fma_f32 v133, v132, v133, -1.0
    v_mfma_f32_32x32x16_bf16 v[48:63], v[112:115], a[244:247], v[48:63]
    v_fma_f32 v135, v134, v135, -1.0
    v_mul_f32 v136, s49, v74
    v_rcp_f32 v133, v133
    v_rcp_f32 v135, v135
    v_mfma_f32_32x32x16_bf16 v[32:47], v[116:119], a[40:43], v[32:47]
    s_waitcnt lgkmcnt(2)
    ds_read_b64_tr_b16 v[112:113], v10 offset:28672
    ds_read_b64_tr_b16 v[114:115], v10 offset:29184
    v_fmac_f32 v72, v72, v133
    v_fmac_f32 v73, v73, v135
    v_cvt_pk_bf16_f32 v212, v72, v73
    v_mfma_f32_32x32x16_bf16 v[48:63], v[116:119], a[248:251], v[48:63]
    v_mul_f32 v138, s49, v75
    v_mul_f32 v128, s49, v76
    v_exp_f32 v136, v136
    v_exp_f32 v138, v138
    v_mfma_f32_32x32x16_bf16 v[32:47], v[120:123], a[44:47], v[32:47]
    ds_read_b64_tr_b16 v[116:117], v10 offset:30720
    ds_read_b64_tr_b16 v[118:119], v10 offset:31232
    buffer_load_dwordx4 v9, s[8:11], s61 offen offset:1024 lds
    s_add_u32 m0, s51, 49152
    v_fma_f32 v137, v136, -0.5, -1.0
    v_fma_f32 v139, v138, -0.5, -1.0
    v_mfma_f32_32x32x16_bf16 v[48:63], v[120:123], a[252:255], v[48:63]
    v_fma_f32 v137, v136, v137, -1.0
    v_fma_f32 v139, v138, v139, -1.0
    v_rcp_f32 v137, v137
    v_rcp_f32 v139, v139
    v_mfma_f32_32x32x16_bf16 v[32:47], v[124:127], a[48:51], v[32:47]
    s_waitcnt lgkmcnt(2)
    ds_read_b64_tr_b16 v[120:121], v10 offset:32768
    ds_read_b64_tr_b16 v[122:123], v10 offset:33280
    v_fmac_f32 v74, v74, v137
    v_fmac_f32 v75, v75, v139
    v_cvt_pk_bf16_f32 v213, v74, v75
    v_mfma_f32_32x32x16_bf16 v[48:63], v[124:127], a[144:147], v[48:63]
    v_mul_f32 v130, s49, v77
    v_mul_f32 v132, s49, v78
    v_exp_f32 v128, v128
    v_exp_f32 v130, v130
    v_mfma_f32_32x32x16_bf16 v[32:47], v[140:143], a[52:55], v[32:47]
    ds_read_b64_tr_b16 v[124:125], v10 offset:34816
    ds_read_b64_tr_b16 v[126:127], v10 offset:35328
    buffer_load_dwordx4 v8, s[8:11], s62 offen offset:0 lds
    v_fma_f32 v129, v128, -0.5, -1.0
    v_fma_f32 v131, v130, -0.5, -1.0
    v_fma_f32 v129, v128, v129, -1.0
    v_mfma_f32_32x32x16_bf16 v[48:63], v[140:143], a[148:151], v[48:63]
    v_fma_f32 v131, v130, v131, -1.0
    v_mul_f32 v134, s49, v79
    v_rcp_f32 v129, v129
    v_rcp_f32 v131, v131
    v_mfma_f32_32x32x16_bf16 v[32:47], v[112:115], a[56:59], v[32:47]
    s_waitcnt lgkmcnt(2)
    ds_read_b64_tr_b16 v[140:141], v10 offset:36864
    ds_read_b64_tr_b16 v[142:143], v10 offset:37376
    v_fmac_f32 v76, v76, v129
    v_fmac_f32 v77, v77, v131
    v_cvt_pk_bf16_f32 v214, v76, v77
    v_mfma_f32_32x32x16_bf16 v[48:63], v[112:115], a[152:155], v[48:63]
    v_mul_f32 v136, s49, v80
    v_mul_f32 v138, s49, v81
    v_exp_f32 v132, v132
    v_exp_f32 v134, v134
    v_mfma_f32_32x32x16_bf16 v[32:47], v[116:119], a[60:63], v[32:47]
    ds_read_b64_tr_b16 v[112:113], v10 offset:38912
    ds_read_b64_tr_b16 v[114:115], v10 offset:39424
    buffer_load_dwordx4 v9, s[8:11], s62 offen offset:1024 lds
    s_add_u32 m0, s51, 57344
    v_fma_f32 v133, v132, -0.5, -1.0
    v_fma_f32 v135, v134, -0.5, -1.0
    v_mfma_f32_32x32x16_bf16 v[48:63], v[116:119], a[156:159], v[48:63]
    v_fma_f32 v133, v132, v133, -1.0
    v_fma_f32 v135, v134, v135, -1.0
    v_rcp_f32 v133, v133
    v_rcp_f32 v135, v135
    v_mfma_f32_32x32x16_bf16 v[32:47], v[120:123], a[64:67], v[32:47]
    s_waitcnt lgkmcnt(2)
    ds_read_b64_tr_b16 v[116:117], v10 offset:40960
    ds_read_b64_tr_b16 v[118:119], v10 offset:41472
    v_fmac_f32 v78, v78, v133
    v_fmac_f32 v79, v79, v135
    v_cvt_pk_bf16_f32 v215, v78, v79
    v_mfma_f32_32x32x16_bf16 v[48:63], v[120:123], a[160:163], v[48:63]
    v_mul_f32 v128, s49, v82
    v_mul_f32 v130, s49, v83
    v_exp_f32 v136, v136
    v_exp_f32 v138, v138
    v_mfma_f32_32x32x16_bf16 v[32:47], v[124:127], a[68:71], v[32:47]
    ds_read_b64_tr_b16 v[120:121], v10 offset:43008
    ds_read_b64_tr_b16 v[122:123], v10 offset:43520
    buffer_load_dwordx4 v8, s[8:11], s63 offen offset:0 lds
    v_fma_f32 v137, v136, -0.5, -1.0
    v_fma_f32 v139, v138, -0.5, -1.0
    v_fma_f32 v137, v136, v137, -1.0
    v_mfma_f32_32x32x16_bf16 v[48:63], v[124:127], a[164:167], v[48:63]
    v_fma_f32 v139, v138, v139, -1.0
    v_mul_f32 v132, s49, v84
    v_rcp_f32 v137, v137
    v_rcp_f32 v139, v139
    v_mfma_f32_32x32x16_bf16 v[32:47], v[140:143], a[72:75], v[32:47]
    s_waitcnt lgkmcnt(2)
    ds_read_b64_tr_b16 v[124:125], v10 offset:45056
    ds_read_b64_tr_b16 v[126:127], v10 offset:45568
    v_fmac_f32 v80, v80, v137
    v_fmac_f32 v81, v81, v139
    v_cvt_pk_bf16_f32 v216, v80, v81
    v_mfma_f32_32x32x16_bf16 v[48:63], v[140:143], a[168:171], v[48:63]
    v_mul_f32 v134, s49, v85
    v_mul_f32 v136, s49, v86
    v_exp_f32 v128, v128
    v_exp_f32 v130, v130
    v_mfma_f32_32x32x16_bf16 v[32:47], v[112:115], a[76:79], v[32:47]
    ds_read_b64_tr_b16 v[140:141], v10 offset:47104
    ds_read_b64_tr_b16 v[142:143], v10 offset:47616
    buffer_load_dwordx4 v9, s[8:11], s63 offen offset:1024 lds
    s_add_u32 m0, s51, 65536
    v_fma_f32 v129, v128, -0.5, -1.0
    v_fma_f32 v131, v130, -0.5, -1.0
    v_mfma_f32_32x32x16_bf16 v[48:63], v[112:115], a[172:175], v[48:63]
    v_fma_f32 v129, v128, v129, -1.0
    v_fma_f32 v131, v130, v131, -1.0
    v_rcp_f32 v129, v129
    v_rcp_f32 v131, v131
    v_mfma_f32_32x32x16_bf16 v[32:47], v[116:119], a[80:83], v[32:47]
    s_waitcnt vmcnt(16)
    s_barrier
    s_waitcnt lgkmcnt(2)
    ds_read_b64_tr_b16 v[112:113], v11 offset:24576
    ds_read_b64_tr_b16 v[114:115], v11 offset:25088
    v_fmac_f32 v82, v82, v129
    v_mfma_f32_32x32x16_bf16 v[48:63], v[116:119], a[176:179], v[48:63]
    v_fmac_f32 v83, v83, v131
    v_cvt_pk_bf16_f32 v217, v82, v83
    v_exp_f32 v132, v132
    v_exp_f32 v134, v134
    v_mfma_f32_32x32x16_bf16 v[32:47], v[120:123], a[84:87], v[32:47]
    ds_read_b64_tr_b16 v[116:117], v11 offset:26624
    ds_read_b64_tr_b16 v[118:119], v11 offset:27136
    buffer_load_dwordx4 v8, s[8:11], s64 offen offset:0 lds
    v_fma_f32 v133, v132, -0.5, -1.0
    v_fma_f32 v135, v134, -0.5, -1.0
    v_fma_f32 v133, v132, v133, -1.0
    v_mfma_f32_32x32x16_bf16 v[48:63], v[120:123], a[180:183], v[48:63]
    v_fma_f32 v135, v134, v135, -1.0
    v_mul_f32 v138, s49, v87
    v_rcp_f32 v133, v133
    v_rcp_f32 v135, v135
    v_mfma_f32_32x32x16_bf16 v[32:47], v[124:127], a[88:91], v[32:47]
    s_waitcnt lgkmcnt(2)
    ds_read_b64_tr_b16 v[120:121], v11 offset:28672
    ds_read_b64_tr_b16 v[122:123], v11 offset:29184
    ds_read_b128 v[96:99], v13 offset:512
    ds_read_b128 v[100:103], v13 offset:544
    ds_read_b128 v[104:107], v13 offset:576
    ds_read_b128 v[108:111], v13 offset:608
    v_mfma_f32_32x32x16_bf16 v[48:63], v[124:127], a[184:187], v[48:63]
    v_fmac_f32 v84, v84, v133
    v_fmac_f32 v85, v85, v135
    v_exp_f32 v136, v136
    v_exp_f32 v138, v138
    v_mfma_f32_32x32x16_bf16 v[32:47], v[140:143], a[92:95], v[32:47]
    ds_read_b64_tr_b16 v[124:125], v11 offset:30720
    ds_read_b64_tr_b16 v[126:127], v11 offset:31232
    buffer_load_dwordx4 v9, s[8:11], s64 offen offset:1024 lds
    s_add_u32 s8, s8, 128
    s_addc_u32 s9, s9, 0
    s_add_u32 m0, s51, 0
    v_mfma_f32_32x32x16_bf16 v[48:63], v[140:143], a[188:191], v[48:63]
    v_cvt_pk_bf16_f32 v218, v84, v85
    v_fma_f32 v137, v136, -0.5, -1.0
    v_fma_f32 v139, v138, -0.5, -1.0
    v_fma_f32 v137, v136, v137, -1.0
    v_rcp_f32 v137, v137
    v_mfma_f32_32x32x16_bf16 v[32:47], v[112:115], a[96:99], v[32:47]
    s_waitcnt lgkmcnt(6)
    ds_read_b64_tr_b16 v[140:141], v11 offset:32768
    ds_read_b64_tr_b16 v[142:143], v11 offset:33280
    v_fma_f32 v139, v138, v139, -1.0
    v_fmac_f32 v86, v86, v137
    v_mul_f32 v128, s49, v88
    v_mfma_f32_32x32x16_bf16 v[48:63], v[112:115], a[192:195], v[48:63]
    v_mul_f32 v130, s49, v89
    v_mul_f32 v132, s49, v90
    v_rcp_f32 v139, v139
    v_exp_f32 v128, v128
    v_mfma_f32_32x32x16_bf16 v[32:47], v[116:119], a[100:103], v[32:47]
    ds_read_b64_tr_b16 v[112:113], v11 offset:34816
    ds_read_b64_tr_b16 v[114:115], v11 offset:35328
    buffer_load_dwordx4 v8, s[8:11], s56 offen offset:0 lds
    v_fmac_f32 v87, v87, v139
    v_cvt_pk_bf16_f32 v219, v86, v87
    v_fma_f32 v129, v128, -0.5, -1.0
    v_mfma_f32_32x32x16_bf16 v[48:63], v[116:119], a[196:199], v[48:63]
    v_fma_f32 v129, v128, v129, -1.0
    v_mul_f32 v134, s49, v91
    v_exp_f32 v130, v130
    v_rcp_f32 v129, v129
    v_mfma_f32_32x32x16_bf16 v[32:47], v[120:123], a[104:107], v[32:47]
    s_waitcnt lgkmcnt(2)
    ds_read_b64_tr_b16 v[116:117], v11 offset:36864
    ds_read_b64_tr_b16 v[118:119], v11 offset:37376
    v_fma_f32 v131, v130, -0.5, -1.0
    v_fma_f32 v131, v130, v131, -1.0
    v_fmac_f32 v88, v88, v129
    v_mfma_f32_32x32x16_bf16 v[48:63], v[120:123], a[200:203], v[48:63]
    v_mul_f32 v136, s49, v92
    v_mul_f32 v138, s49, v93
    v_rcp_f32 v131, v131
    v_exp_f32 v132, v132
    v_mfma_f32_32x32x16_bf16 v[32:47], v[124:127], a[108:111], v[32:47]
    ds_read_b64_tr_b16 v[120:121], v11 offset:38912
    ds_read_b64_tr_b16 v[122:123], v11 offset:39424
    buffer_load_dwordx4 v9, s[8:11], s56 offen offset:1024 lds
    s_add_u32 m0, s51, 8192
    v_fmac_f32 v89, v89, v131
    v_cvt_pk_bf16_f32 v220, v88, v89
    v_mfma_f32_32x32x16_bf16 v[48:63], v[124:127], a[204:207], v[48:63]
    v_fma_f32 v133, v132, -0.5, -1.0
    v_fma_f32 v133, v132, v133, -1.0
    v_exp_f32 v134, v134
    v_rcp_f32 v133, v133
    v_mfma_f32_32x32x16_bf16 v[32:47], v[140:143], a[112:115], v[32:47]
    s_waitcnt lgkmcnt(2)
    ds_read_b64_tr_b16 v[124:125], v11 offset:40960
    ds_read_b64_tr_b16 v[126:127], v11 offset:41472
    v_fma_f32 v135, v134, -0.5, -1.0
    v_fma_f32 v135, v134, v135, -1.0
    v_fmac_f32 v90, v90, v133
    v_mfma_f32_32x32x16_bf16 v[48:63], v[140:143], v[224:227], v[48:63]
    v_mul_f32 v128, s49, v94
    v_mul_f32 v130, s49, v95
    v_rcp_f32 v135, v135
    v_exp_f32 v136, v136
    v_mfma_f32_32x32x16_bf16 v[32:47], v[112:115], a[116:119], v[32:47]
    ds_read_b64_tr_b16 v[140:141], v11 offset:43008
    ds_read_b64_tr_b16 v[142:143], v11 offset:43520
    buffer_load_dwordx4 v8, s[8:11], s57 offen offset:0 lds
    v_fmac_f32 v91, v91, v135
    v_cvt_pk_bf16_f32 v221, v90, v91
    v_fma_f32 v137, v136, -0.5, -1.0
    v_mfma_f32_32x32x16_bf16 v[48:63], v[112:115], v[228:231], v[48:63]
    v_fma_f32 v137, v136, v137, -1.0
    v_exp_f32 v138, v138
    v_rcp_f32 v137, v137
    v_fma_f32 v139, v138, -0.5, -1.0
    v_mfma_f32_32x32x16_bf16 v[32:47], v[116:119], a[120:123], v[32:47]
    s_waitcnt lgkmcnt(2)
    ds_read_b64_tr_b16 v[112:113], v11 offset:45056
    ds_read_b64_tr_b16 v[114:115], v11 offset:45568
    v_fma_f32 v139, v138, v139, -1.0
    v_fmac_f32 v92, v92, v137
    v_mfma_f32_32x32x16_bf16 v[48:63], v[116:119], v[232:235], v[48:63]
    v_rcp_f32 v139, v139
    v_exp_f32 v128, v128
    v_exp_f32 v130, v130
    v_mfma_f32_32x32x16_bf16 v[32:47], v[120:123], a[124:127], v[32:47]
    ds_read_b64_tr_b16 v[116:117], v11 offset:47104
    ds_read_b64_tr_b16 v[118:119], v11 offset:47616
    buffer_load_dwordx4 v9, s[8:11], s57 offen offset:1024 lds
    s_add_u32 m0, s51, 16384
    v_fmac_f32 v93, v93, v139
    v_cvt_pk_bf16_f32 v222, v92, v93
    v_mfma_f32_32x32x16_bf16 v[48:63], v[120:123], v[236:239], v[48:63]
    v_fma_f32 v129, v128, -0.5, -1.0
    v_fma_f32 v131, v130, -0.5, -1.0
    v_fma_f32 v129, v128, v129, -1.0
    v_fma_f32 v131, v130, v131, -1.0
    v_rcp_f32 v129, v129
    v_mfma_f32_32x32x16_bf16 v[32:47], v[124:127], a[128:131], v[32:47]
    s_waitcnt vmcnt(16)
    s_barrier
    s_waitcnt lgkmcnt(2)
    ds_read_b64_tr_b16 v[120:121], v12 offset:0
    ds_read_b64_tr_b16 v[122:123], v12 offset:512
    v_fmac_f32 v94, v94, v129
    v_mfma_f32_32x32x16_bf16 v[48:63], v[124:127], v[240:243], v[48:63]
    v_rcp_f32 v131, v131
    v_mfma_f32_32x32x16_bf16 v[32:47], v[140:143], a[132:135], v[32:47]
    ds_read_b64_tr_b16 v[124:125], v12 offset:2048
    ds_read_b64_tr_b16 v[126:127], v12 offset:2560
    buffer_load_dwordx4 v8, s[8:11], s58 offen offset:0 lds
    v_fmac_f32 v95, v95, v131
    v_cvt_pk_bf16_f32 v223, v94, v95
    v_mfma_f32_32x32x16_bf16 v[48:63], v[140:143], v[244:247], v[48:63]
    v_mfma_f32_32x32x16_bf16 v[32:47], v[112:115], a[136:139], v[32:47]
    s_waitcnt lgkmcnt(2)
    ds_read_b64_tr_b16 v[140:141], v12 offset:4096
    ds_read_b64_tr_b16 v[142:143], v12 offset:4608
    v_mfma_f32_32x32x16_bf16 v[48:63], v[112:115], v[248:251], v[48:63]
    v_mfma_f32_32x32x16_bf16 v[64:79], v[116:119], a[140:143], v[32:47]
    ds_read_b64_tr_b16 v[112:113], v12 offset:6144
    ds_read_b64_tr_b16 v[114:115], v12 offset:6656
    buffer_load_dwordx4 v9, s[8:11], s58 offen offset:1024 lds
    s_add_u32 m0, s51, 24576
    v_mfma_f32_32x32x16_bf16 v[80:95], v[116:119], v[252:255], v[48:63]
    s_bitcmp1_b32 s36, 0
    s_cbranch_scc1 L_ex_1
    ds_write_b128 v15, v[216:219] offset:0
    ds_write_b128 v15, v[220:223] offset:1024
    s_branch L_exe_2
L_ex_1:
    ds_write_b128 v15, v[208:211] offset:0
    ds_write_b128 v15, v[212:215] offset:1024
L_exe_2:
    v_mfma_f32_32x32x16_bf16 v[32:47], v[120:123], a[0:3], v[96:111]
    s_waitcnt lgkmcnt(4)
    ds_read_b64_tr_b16 v[116:117], v12 offset:8192
    ds_read_b64_tr_b16 v[118:119], v12 offset:8704
    v_mul_f32 v128, s49, v64
    v_mul_f32 v130, s49, v65
    v_mul_f32 v132, s49, v66
    v_mfma_f32_32x32x16_bf16 v[48:63], v[120:123], a[208:211], v[96:111]
    v_mul_f32 v134, s49, v67
    v_mul_f32 v136, s49, v68
    v_exp_f32 v128, v128
    v_exp_f32 v130, v130
    v_mfma_f32_32x32x16_bf16 v[32:47], v[124:127], a[4:7], v[32:47]
    ds_read_b64_tr_b16 v[120:121], v12 offset:10240
    ds_read_b64_tr_b16 v[122:123], v12 offset:10752
    buffer_load_dwordx4 v8, s[8:11], s59 offen offset:0 lds
    v_fma_f32 v129, v128, -0.5, -1.0
    v_fma_f32 v131, v130, -0.5, -1.0
    v_fma_f32 v129, v128, v129, -1.0
    v_mfma_f32_32x32x16_bf16 v[48:63], v[124:127], a[212:215], v[48:63]
    v_fma_f32 v131, v130, v131, -1.0
    v_mul_f32 v138, s49, v69
    v_rcp_f32 v129, v129
    v_rcp_f32 v131, v131
    v_mfma_f32_32x32x16_bf16 v[32:47], v[140:143], a[8:11], v[32:47]
    s_waitcnt lgkmcnt(2)
    ds_read_b64_tr_b16 v[124:125], v12 offset:12288
    ds_read_b64_tr_b16 v[126:127], v12 offset:12800
    v_fmac_f32 v64, v64, v129
    v_fmac_f32 v65, v65, v131
    v_cvt_pk_bf16_f32 v144, v64, v65
    v_mfma_f32_32x32x16_bf16 v[48:63], v[140:143], a[216:219], v[48:63]
    v_mul_f32 v128, s49, v70
    v_mul_f32 v130, s49, v71
    v_exp_f32 v132, v132
    v_exp_f32 v134, v134
    v_mfma_f32_32x32x16_bf16 v[32:47], v[112:115], a[12:15], v[32:47]
    ds_read_b64_tr_b16 v[140:141], v12 offset:14336
    ds_read_b64_tr_b16 v[142:143], v12 offset:14848
    buffer_load_dwordx4 v9, s[8:11], s59 offen offset:1024 lds
    s_add_u32 m0, s51, 32768
    v_fma_f32 v133, v132, -0.5, -1.0
    v_fma_f32 v135, v134, -0.5, -1.0
    v_mfma_f32_32x32x16_bf16 v[48:63], v[112:115], a[220:223], v[48:63]
    v_fma_f32 v133, v132, v133, -1.0
    v_fma_f32 v135, v134, v135, -1.0
    v_rcp_f32 v133, v133
    v_rcp_f32 v135, v135
    v_mfma_f32_32x32x16_bf16 v[32:47], v[116:119], a[16:19], v[32:47]
    s_waitcnt lgkmcnt(2)
    ds_read_b64_tr_b16 v[112:113], v12 offset:16384
    ds_read_b64_tr_b16 v[114:115], v12 offset:16896
    v_fmac_f32 v66, v66, v133
    v_fmac_f32 v67, v67, v135
    v_cvt_pk_bf16_f32 v145, v66, v67
    v_mfma_f32_32x32x16_bf16 v[48:63], v[116:119], a[224:227], v[48:63]
    v_mul_f32 v132, s49, v72
    v_mul_f32 v134, s49, v73
    v_exp_f32 v136, v136
    v_exp_f32 v138, v138
    v_mfma_f32_32x32x16_bf16 v[32:47], v[120:123], a[20:23], v[32:47]
    ds_read_b64_tr_b16 v[116:117], v12 offset:18432
    ds_read_b64_tr_b16 v[118:119], v12 offset:18944
    buffer_load_dwordx4 v8, s[8:11], s60 offen offset:0 lds
    v_fma_f32 v137, v136, -0.5, -1.0
    v_fma_f32 v139, v138, -0.5, -1.0
    v_fma_f32 v137, v136, v137, -1.0
    v_mfma_f32_32x32x16_bf16 v[48:63], v[120:123], a[228:231], v[48:63]
    v_fma_f32 v139, v138, v139, -1.0
    v_mul_f32 v136, s49, v74
    v_rcp_f32 v137, v137
    v_rcp_f32 v139, v139
    v_mfma_f32_32x32x16_bf16 v[32:47], v[124:127], a[24:27], v[32:47]
    s_waitcnt lgkmcnt(2)
    ds_read_b64_tr_b16 v[120:121], v12 offset:20480
    ds_read_b64_tr_b16 v[122:123], v12 offset:20992
    v_fmac_f32 v68, v68, v137
    v_fmac_f32 v69, v69, v139
    v_cvt_pk_bf16_f32 v146, v68, v69
    v_mfma_f32_32x32x16_bf16 v[48:63], v[124:127], a[232:235], v[48:63]
    v_mul_f32 v138, s49, v75
    v_exp_f32 v128, v128
    v_exp_f32 v130, v130
    v_fma_f32 v129, v128, -0.5, -1.0
    v_mfma_f32_32x32x16_bf16 v[32:47], v[140:143], a[28:31], v[32:47]
    ds_read_b64_tr_b16 v[124:125], v12 offset:22528
    ds_read_b64_tr_b16 v[126:127], v12 offset:23040
    buffer_load_dwordx4 v9, s[8:11], s60 offen offset:1024 lds
    s_add_u32 m0, s51, 40960
    v_fma_f32 v131, v130, -0.5, -1.0
    v_fma_f32 v129, v128, v129, -1.0
    v_mfma_f32_32x32x16_bf16 v[48:63], v[140:143], a[236:239], v[48:63]
    v_fma_f32 v131, v130, v131, -1.0
    v_mul_f32 v128, s49, v76
    v_rcp_f32 v129, v129
    v_rcp_f32 v131, v131
    v_mfma_f32_32x32x16_bf16 v[32:47], v[112:115], a[32:35], v[32:47]
    s_waitcnt vmcnt(16)
    s_barrier
    s_waitcnt lgkmcnt(2)
    ds_read_b64_tr_b16 v[140:141], v12 offset:24576
    ds_read_b64_tr_b16 v[142:143], v12 offset:25088
    s_bitcmp1_b32 s36, 0
    s_cbranch_scc1 L_ex_3
    ds_read_b128 v[216:219], v16 offset:0
    ds_read_b128 v[220:223], v16 offset:1024
    s_branch L_exe_4
L_ex_3:
    ds_read_b128 v[208:211], v16 offset:0
    ds_read_b128 v[212:215], v16 offset:1024
L_exe_4:
    v_mfma_f32_32x32x16_bf16 v[48:63], v[112:115], a[240:243], v[48:63]
    v_fmac_f32 v70, v70, v129
    v_fmac_f32 v71, v71, v131
    v_exp_f32 v132, v132
    v_exp_f32 v134, v134
    v_mfma_f32_32x32x16_bf16 v[32:47], v[116:119], a[36:39], v[32:47]
    ds_read_b64_tr_b16 v[112:113], v12 offset:26624
    ds_read_b64_tr_b16 v[114:115], v12 offset:27136
    buffer_load_dwordx4 v8, s[8:11], s61 offen offset:0 lds
    v_cvt_pk_bf16_f32 v147, v70, v71
    v_fma_f32 v133, v132, -0.5, -1.0
    v_fma_f32 v135, v134, -0.5, -1.0
    v_mfma_f32_32x32x16_bf16 v[48:63], v[116:119], a[244:247], v[48:63]
    v_fma_f32 v133, v132, v133, -1.0
    v_fma_f32 v135, v134, v135, -1.0
    v_rcp_f32 v133, v133
    v_rcp_f32 v135, v135
    v_mfma_f32_32x32x16_bf16 v[32:47], v[120:123], a[40:43], v[32:47]
    s_waitcnt lgkmcnt(2)
    ds_read_b64_tr_b16 v[116:117], v12 offset:28672
    ds_read_b64_tr_b16 v[118:119], v12 offset:29184
    v_fmac_f32 v72, v72, v133
    v_fmac_f32 v73, v73, v135
    v_cvt_pk_bf16_f32 v148, v72, v73
    v_mfma_f32_32x32x16_bf16 v[48:63], v[120:123], a[248:251], v[48:63]
    buffer_store_dwordx4 v[208:211], v17, s[12:15], s48 offen offset:0 sc1
    v_mul_f32 v130, s49, v77
    v_exp_f32 v136, v136
    v_exp_f32 v138, v138
    v_mfma_f32_32x32x16_bf16 v[32:47], v[124:127], a[44:47], v[32:47]
    ds_read_b64_tr_b16 v[120:121], v12 offset:30720
    ds_read_b64_tr_b16 v[122:123], v12 offset:31232
    buffer_load_dwordx4 v9, s[8:11], s61 offen offset:1024 lds
    s_add_u32 m0, s51, 73728
    v_fma_f32 v137, v136, -0.5, -1.0
    v_fma_f32 v139, v138, -0.5, -1.0
    v_mfma_f32_32x32x16_bf16 v[48:63], v[124:127], a[252:255], v[48:63]
    v_fma_f32 v137, v136, v137, -1.0
    v_fma_f32 v139, v138, v139, -1.0
    v_rcp_f32 v137, v137
    v_rcp_f32 v139, v139
    v_mfma_f32_32x32x16_bf16 v[32:47], v[140:143], a[48:51], v[32:47]
    s_waitcnt lgkmcnt(2)
    ds_read_b64_tr_b16 v[124:125], v12 offset:32768
    ds_read_b64_tr_b16 v[126:127], v12 offset:33280
    v_fmac_f32 v74, v74, v137
    v_fmac_f32 v75, v75, v139
    v_cvt_pk_bf16_f32 v149, v74, v75
    v_mfma_f32_32x32x16_bf16 v[48:63], v[140:143], a[144:147], v[48:63]
    v_mul_f32 v132, s49, v78
    v_mul_f32 v134, s49, v79
    v_exp_f32 v128, v128
    v_exp_f32 v130, v130
    v_mfma_f32_32x32x16_bf16 v[32:47], v[112:115], a[52:55], v[32:47]
    ds_read_b64_tr_b16 v[140:141], v12 offset:34816
    ds_read_b64_tr_b16 v[142:143], v12 offset:35328
    buffer_load_dwordx4 v8, s[8:11], s62 offen offset:0 lds
    v_fma_f32 v129, v128, -0.5, -1.0
    v_fma_f32 v131, v130, -0.5, -1.0
    v_fma_f32 v129, v128, v129, -1.0
    v_mfma_f32_32x32x16_bf16 v[48:63], v[112:115], a[148:151], v[48:63]
    v_fma_f32 v131, v130, v131, -1.0
    v_mul_f32 v136, s49, v80
    v_rcp_f32 v129, v129
    v_rcp_f32 v131, v131
    v_mfma_f32_32x32x16_bf16 v[32:47], v[116:119], a[56:59], v[32:47]
    s_waitcnt lgkmcnt(2)
    ds_read_b64_tr_b16 v[112:113], v12 offset:36864
    ds_read_b64_tr_b16 v[114:115], v12 offset:37376
    v_fmac_f32 v76, v76, v129
    v_fmac_f32 v77, v77, v131
    v_cvt_pk_bf16_f32 v150, v76, v77
    v_mfma_f32_32x32x16_bf16 v[48:63], v[116:119], a[152:155], v[48:63]
    v_mul_f32 v138, s49, v81
    v_mul_f32 v128, s49, v82
    v_exp_f32 v132, v132
    v_exp_f32 v134, v134
    v_mfma_f32_32x32x16_bf16 v[32:47], v[120:123], a[60:63], v[32:47]
    ds_read_b64_tr_b16 v[116:117], v12 offset:38912
    ds_read_b64_tr_b16 v[118:119], v12 offset:39424
    buffer_load_dwordx4 v9, s[8:11], s62 offen offset:1024 lds
    s_add_u32 m0, s51, 81920
    v_fma_f32 v133, v132, -0.5, -1.0
    v_fma_f32 v135, v134, -0.5, -1.0
    v_mfma_f32_32x32x16_bf16 v[48:63], v[120:123], a[156:159], v[48:63]
    v_fma_f32 v133, v132, v133, -1.0
    v_fma_f32 v135, v134, v135, -1.0
    v_rcp_f32 v133, v133
    v_rcp_f32 v135, v135
    v_mfma_f32_32x32x16_bf16 v[32:47], v[124:127], a[64:67], v[32:47]
    s_waitcnt lgkmcnt(2)
    ds_read_b64_tr_b16 v[120:121], v12 offset:40960
    ds_read_b64_tr_b16 v[122:123], v12 offset:41472
    v_fmac_f32 v78, v78, v133
    v_fmac_f32 v79, v79, v135
    v_cvt_pk_bf16_f32 v151, v78, v79
    v_mfma_f32_32x32x16_bf16 v[48:63], v[124:127], a[160:163], v[48:63]
    buffer_store_dwordx4 v[212:215], v17, s[12:15], s48 offen offset:1024 sc1
    v_mul_f32 v130, s49, v83
    v_exp_f32 v136, v136
    v_exp_f32 v138, v138
    v_mfma_f32_32x32x16_bf16 v[32:47], v[140:143], a[68:71], v[32:47]
    ds_read_b64_tr_b16 v[124:125], v12 offset:43008
    ds_read_b64_tr_b16 v[126:127], v12 offset:43520
    buffer_load_dwordx4 v8, s[8:11], s63 offen offset:0 lds
    v_fma_f32 v137, v136, -0.5, -1.0
    v_fma_f32 v139, v138, -0.5, -1.0
    v_fma_f32 v137, v136, v137, -1.0
    v_mfma_f32_32x32x16_bf16 v[48:63], v[140:143], a[164:167], v[48:63]
    v_fma_f32 v139, v138, v139, -1.0
    v_mul_f32 v132, s49, v84
    v_rcp_f32 v137, v137
    v_rcp_f32 v139, v139
    v_mfma_f32_32x32x16_bf16 v[32:47], v[112:115], a[72:75], v[32:47]
    s_waitcnt lgkmcnt(2)
    ds_read_b64_tr_b16 v[140:141], v12 offset:45056
    ds_read_b64_tr_b16 v[142:143], v12 offset:45568
    v_fmac_f32 v80, v80, v137
    v_fmac_f32 v81, v81, v139
    v_cvt_pk_bf16_f32 v152, v80, v81
    v_mfma_f32_32x32x16_bf16 v[48:63], v[112:115], a[168:171], v[48:63]
    v_mul_f32 v134, s49, v85
    v_mul_f32 v136, s49, v86
    v_exp_f32 v128, v128
    v_exp_f32 v130, v130
    v_mfma_f32_32x32x16_bf16 v[32:47], v[116:119], a[76:79], v[32:47]
    ds_read_b64_tr_b16 v[112:113], v12 offset:47104
    ds_read_b64_tr_b16 v[114:115], v12 offset:47616
    buffer_load_dwordx4 v9, s[8:11], s63 offen offset:1024 lds
    s_add_u32 m0, s51, 90112
    v_fma_f32 v129, v128, -0.5, -1.0
    v_fma_f32 v131, v130, -0.5, -1.0
    v_mfma_f32_32x32x16_bf16 v[48:63], v[116:119], a[172:175], v[48:63]
    v_fma_f32 v129, v128, v129, -1.0
    v_fma_f32 v131, v130, v131, -1.0
    v_rcp_f32 v129, v129
    v_rcp_f32 v131, v131
    v_mfma_f32_32x32x16_bf16 v[32:47], v[120:123], a[80:83], v[32:47]
    s_waitcnt vmcnt(18)
    s_barrier
    s_waitcnt lgkmcnt(2)
    ds_read_b64_tr_b16 v[116:117], v11 offset:0
    ds_read_b64_tr_b16 v[118:119], v11 offset:512
    v_fmac_f32 v82, v82, v129
    v_mfma_f32_32x32x16_bf16 v[48:63], v[120:123], a[176:179], v[48:63]
    v_fmac_f32 v83, v83, v131
    v_cvt_pk_bf16_f32 v153, v82, v83
    v_exp_f32 v132, v132
    v_exp_f32 v134, v134
    v_mfma_f32_32x32x16_bf16 v[32:47], v[124:127], a[84:87], v[32:47]
    ds_read_b64_tr_b16 v[120:121], v11 offset:2048
    ds_read_b64_tr_b16 v[122:123], v11 offset:2560
    buffer_load_dwordx4 v8, s[8:11], s64 offen offset:0 lds
    v_fma_f32 v133, v132, -0.5, -1.0
    v_fma_f32 v135, v134, -0.5, -1.0
    v_fma_f32 v133, v132, v133, -1.0
    v_mfma_f32_32x32x16_bf16 v[48:63], v[124:127], a[180:183], v[48:63]
    v_fma_f32 v135, v134, v135, -1.0
    v_mul_f32 v138, s49, v87
    v_rcp_f32 v133, v133
    v_rcp_f32 v135, v135
    v_mfma_f32_32x32x16_bf16 v[32:47], v[140:143], a[88:91], v[32:47]
    s_waitcnt lgkmcnt(2)
    ds_read_b64_tr_b16 v[124:125], v11 offset:4096
    ds_read_b64_tr_b16 v[126:127], v11 offset:4608
    ds_read_b128 v[96:99], v13 offset:768
    ds_read_b128 v[100:103], v13 offset:800
    ds_read_b128 v[104:107], v13 offset:832
    ds_read_b128 v[108:111], v13 offset:864
    v_mfma_f32_32x32x16_bf16 v[48:63], v[140:143], a[184:187], v[48:63]
    v_fmac_f32 v84, v84, v133
    v_fmac_f32 v85, v85, v135
    v_exp_f32 v136, v136
    v_exp_f32 v138, v138
    v_mfma_f32_32x32x16_bf16 v[32:47], v[112:115], a[92:95], v[32:47]
    ds_read_b64_tr_b16 v[140:141], v11 offset:6144
    ds_read_b64_tr_b16 v[142:143], v11 offset:6656
    buffer_load_dwordx4 v9, s[8:11], s64 offen offset:1024 lds
    s_add_u32 s8, s8, 128
    s_addc_u32 s9, s9, 0
    s_add_u32 m0, s51, 98304
    v_mfma_f32_32x32x16_bf16 v[48:63], v[112:115], a[188:191], v[48:63]
    v_cvt_pk_bf16_f32 v154, v84, v85
    v_fma_f32 v137, v136, -0.5, -1.0
    v_fma_f32 v139, v138, -0.5, -1.0
    v_fma_f32 v137, v136, v137, -1.0
    v_rcp_f32 v137, v137
    v_mfma_f32_32x32x16_bf16 v[32:47], v[116:119], a[96:99], v[32:47]
    s_waitcnt lgkmcnt(6)
    ds_read_b64_tr_b16 v[112:113], v11 offset:8192
    ds_read_b64_tr_b16 v[114:115], v11 offset:8704
    v_fma_f32 v139, v138, v139, -1.0
    v_fmac_f32 v86, v86, v137
    v_mul_f32 v128, s49, v88
    v_mfma_f32_32x32x16_bf16 v[48:63], v[116:119], a[192:195], v[48:63]
    buffer_store_dwordx4 v[216:219], v17, s[12:15], s48 offen offset:2048 sc1
    v_mul_f32 v130, s49, v89
    v_rcp_f32 v139, v139
    v_exp_f32 v128, v128
    v_mfma_f32_32x32x16_bf16 v[32:47], v[120:123], a[100:103], v[32:47]
    ds_read_b64_tr_b16 v[116:117], v11 offset:10240
    ds_read_b64_tr_b16 v[118:119], v11 offset:10752
    buffer_load_dwordx4 v8, s[8:11], s56 offen offset:0 lds
    v_fmac_f32 v87, v87, v139
    v_cvt_pk_bf16_f32 v155, v86, v87
    v_fma_f32 v129, v128, -0.5, -1.0
    v_mfma_f32_32x32x16_bf16 v[48:63], v[120:123], a[196:199], v[48:63]
    v_fma_f32 v129, v128, v129, -1.0
    v_mul_f32 v132, s49, v90
    v_exp_f32 v130, v130
    v_rcp_f32 v129, v129
    v_mfma_f32_32x32x16_bf16 v[32:47], v[124:127], a[104:107], v[32:47]
    s_waitcnt lgkmcnt(2)
    ds_read_b64_tr_b16 v[120:121], v11 offset:12288
    ds_read_b64_tr_b16 v[122:123], v11 offset:12800
    v_fma_f32 v131, v130, -0.5, -1.0
    v_fma_f32 v131, v130, v131, -1.0
    v_fmac_f32 v88, v88, v129
    v_mfma_f32_32x32x16_bf16 v[48:63], v[124:127], a[200:203], v[48:63]
    v_mul_f32 v134, s49, v91
    v_mul_f32 v136, s49, v92
    v_rcp_f32 v131, v131
    v_exp_f32 v132, v132
    v_mfma_f32_32x32x16_bf16 v[32:47], v[140:143], a[108:111], v[32:47]
    ds_read_b64_tr_b16 v[124:125], v11 offset:14336
    ds_read_b64_tr_b16 v[126:127], v11 offset:14848
    buffer_load_dwordx4 v9, s[8:11], s56 offen offset:1024 lds
    s_add_u32 m0, s51, 106496
    v_fmac_f32 v89, v89, v131
    v_cvt_pk_bf16_f32 v156, v88, v89
    v_mfma_f32_32x32x16_bf16 v[48:63], v[140:143], a[204:207], v[48:63]
    v_fma_f32 v133, v132, -0.5, -1.0
    v_fma_f32 v133, v132, v133, -1.0
    v_exp_f32 v134, v134
    v_rcp_f32 v133, v133
    v_mfma_f32_32x32x16_bf16 v[32:47], v[112:115], a[112:115], v[32:47]
    s_waitcnt lgkmcnt(2)
    ds_read_b64_tr_b16 v[140:141], v11 offset:16384
    ds_read_b64_tr_b16 v[142:143], v11 offset:16896
    v_fma_f32 v135, v134, -0.5, -1.0
    v_fma_f32 v135, v134, v135, -1.0
    v_fmac_f32 v90, v90, v133
    v_mfma_f32_32x32x16_bf16 v[48:63], v[112:115], v[224:227], v[48:63]
    v_mul_f32 v138, s49, v93
    v_mul_f32 v128, s49, v94
    v_rcp_f32 v135, v135
    v_exp_f32 v136, v136
    v_mfma_f32_32x32x16_bf16 v[32:47], v[116:119], a[116:119], v[32:47]
    ds_read_b64_tr_b16 v[112:113], v11 offset:18432
    ds_read_b64_tr_b16 v[114:115], v11 offset:18944
    buffer_load_dwordx4 v8, s[8:11], s57 offen offset:0 lds
    v_fmac_f32 v91, v91, v135
    v_cvt_pk_bf16_f32 v157, v90, v91
    v_fma_f32 v137, v136, -0.5, -1.0
    v_mfma_f32_32x32x16_bf16 v[48:63], v[116:119], v[228:231], v[48:63]
    v_fma_f32 v137, v136, v137, -1.0
    v_mul_f32 v130, s49, v95
    v_exp_f32 v138, v138
    v_rcp_f32 v137, v137
    v_mfma_f32_32x32x16_bf16 v[32:47], v[120:123], a[120:123], v[32:47]
    s_waitcnt lgkmcnt(2)
    ds_read_b64_tr_b16 v[116:117], v11 offset:20480
    ds_read_b64_tr_b16 v[118:119], v11 offset:20992
    v_fma_f32 v139, v138, -0.5, -1.0
    v_fma_f32 v139, v138, v139, -1.0
    v_fmac_f32 v92, v92, v137
    v_mfma_f32_32x32x16_bf16 v[48:63], v[120:123], v[232:235], v[48:63]
    buffer_store_dwordx4 v[220:223], v17, s[12:15], s48 offen offset:3072 sc1
    s_add_u32 s48, s48, 4096
    v_rcp_f32 v139, v139
    v_exp_f32 v128, v128
    v_mfma_f32_32x32x16_bf16 v[32:47], v[124:127], a[124:127], v[32:47]
    ds_read_b64_tr_b16 v[120:121], v11 offset:22528
    ds_read_b64_tr_b16 v[122:123], v11 offset:23040
    buffer_load_dwordx4 v9, s[8:11], s57 offen offset:1024 lds
    s_add_u32 m0, s51, 114688
    v_fmac_f32 v93, v93, v139
    v_cvt_pk_bf16_f32 v158, v92, v93
    v_mfma_f32_32x32x16_bf16 v[48:63], v[124:127], v[236:239], v[48:63]
    v_fma_f32 v129, v128, -0.5, -1.0
    v_fma_f32 v129, v128, v129, -1.0
    v_exp_f32 v130, v130
    v_rcp_f32 v129, v129
    v_mfma_f32_32x32x16_bf16 v[32:47], v[140:143], a[128:131], v[32:47]
    s_waitcnt vmcnt(20)
    s_barrier
    s_waitcnt lgkmcnt(2)
    ds_read_b64_tr_b16 v[124:125], v10 offset:0
    ds_read_b64_tr_b16 v[126:127], v10 offset:512
    v_fma_f32 v131, v130, -0.5, -1.0
    v_mfma_f32_32x32x16_bf16 v[48:63], v[140:143], v[240:243], v[48:63]
    v_fma_f32 v131, v130, v131, -1.0
    v_fmac_f32 v94, v94, v129
    v_rcp_f32 v131, v131
    v_mfma_f32_32x32x16_bf16 v[32:47], v[112:115], a[132:135], v[32:47]
    ds_read_b64_tr_b16 v[140:141], v10 offset:2048
    ds_read_b64_tr_b16 v[142:143], v10 offset:2560
    buffer_load_dwordx4 v8, s[8:11], s58 offen offset:0 lds
    v_fmac_f32 v95, v95, v131
    v_cvt_pk_bf16_f32 v159, v94, v95
    v_mfma_f32_32x32x16_bf16 v[48:63], v[112:115], v[244:247], v[48:63]
    v_mfma_f32_32x32x16_bf16 v[32:47], v[116:119], a[136:139], v[32:47]
    s_waitcnt lgkmcnt(2)
    ds_read_b64_tr_b16 v[112:113], v10 offset:4096
    ds_read_b64_tr_b16 v[114:115], v10 offset:4608
    v_mfma_f32_32x32x16_bf16 v[48:63], v[116:119], v[248:251], v[48:63]
    v_mfma_f32_32x32x16_bf16 v[64:79], v[120:123], a[140:143], v[32:47]
    ds_read_b64_tr_b16 v[116:117], v10 offset:6144
    ds_read_b64_tr_b16 v[118:119], v10 offset:6656
    buffer_load_dwordx4 v9, s[8:11], s58 offen offset:1024 lds
    s_add_u32 m0, s51, 122880
    v_mfma_f32_32x32x16_bf16 v[80:95], v[120:123], v[252:255], v[48:63]
    s_bitcmp1_b32 s36, 0
    s_cbranch_scc1 L_ex_5
    ds_write_b128 v15, v[152:155] offset:0
    ds_write_b128 v15, v[156:159] offset:1024
    s_branch L_exe_6
L_ex_5:
    ds_write_b128 v15, v[144:147] offset:0
    ds_write_b128 v15, v[148:151] offset:1024
L_exe_6:
    v_mfma_f32_32x32x16_bf16 v[32:47], v[124:127], a[0:3], v[96:111]
    s_waitcnt lgkmcnt(4)
    ds_read_b64_tr_b16 v[120:121], v10 offset:8192
    ds_read_b64_tr_b16 v[122:123], v10 offset:8704
    v_and_b32 v2, 31, v1
    v_lshlrev_b32 v2, 2, v2
    v_mul_f32 v128, s49, v64
    v_mfma_f32_32x32x16_bf16 v[48:63], v[124:127], a[208:211], v[96:111]
    v_and_b32 v3, 3, v1
    v_lshlrev_b32 v3, 4, v3
    s_mul_i32 s85, s36, 260
    s_add_u32 s85, s85, 157696
    v_add_u32 v3, s85, v3
    v_exp_f32 v128, v128
    v_mul_f32 v130, s49, v65
    v_exp_f32 v130, v130
    v_mfma_f32_32x32x16_bf16 v[32:47], v[140:143], a[4:7], v[32:47]
    ds_read_b64_tr_b16 v[124:125], v10 offset:10240
    ds_read_b64_tr_b16 v[126:127], v10 offset:10752
    buffer_load_dwordx4 v8, s[8:11], s59 offen offset:0 lds
    v_fma_f32 v129, v128, -0.5, -1.0
    v_fma_f32 v131, v130, -0.5, -1.0
    v_fma_f32 v129, v128, v129, -1.0
    v_mfma_f32_32x32x16_bf16 v[48:63], v[140:143], a[212:215], v[48:63]
    v_mov_b32 v6, 0
    s_lshl_b32 s85, s36, 8
    s_add_u32 s85, s85, 157696
    v_lshl_add_u32 v7, v1, 2, s85
    ds_write_b32 v7, v6
    v_fma_f32 v131, v130, v131, -1.0
    v_rcp_f32 v129, v129
    v_rcp_f32 v131, v131
    v_mfma_f32_32x32x16_bf16 v[32:47], v[112:115], a[8:11], v[32:47]
    s_waitcnt lgkmcnt(3)
    ds_read_b64_tr_b16 v[140:141], v10 offset:12288
    ds_read_b64_tr_b16 v[142:143], v10 offset:12800
    v_fmac_f32 v64, v64, v129
    v_fmac_f32 v65, v65, v131
    v_cvt_pk_bf16_f32 v160, v64, v65
    v_mfma_f32_32x32x16_bf16 v[48:63], v[112:115], a[216:219], v[48:63]
    v_mul_f32 v132, s49, v66
    v_mul_f32 v134, s49, v67
    v_mul_f32 v136, s49, v68
    v_exp_f32 v132, v132
    v_exp_f32 v134, v134
    v_mfma_f32_32x32x16_bf16 v[32:47], v[116:119], a[12:15], v[32:47]
    ds_read_b64_tr_b16 v[112:113], v10 offset:14336
    ds_read_b64_tr_b16 v[114:115], v10 offset:14848
    buffer_load_dwordx4 v9, s[8:11], s59 offen offset:1024 lds
    s_add_u32 m0, s51, 131072
    v_fma_f32 v133, v132, -0.5, -1.0
    v_fma_f32 v135, v134, -0.5, -1.0
    v_mfma_f32_32x32x16_bf16 v[48:63], v[116:119], a[220:223], v[48:63]
    v_fma_f32 v133, v132, v133, -1.0
    v_fma_f32 v135, v134, v135, -1.0
    v_rcp_f32 v133, v133
    v_rcp_f32 v135, v135
    v_mfma_f32_32x32x16_bf16 v[32:47], v[120:123], a[16:19], v[32:47]
    s_waitcnt lgkmcnt(2)
    ds_read_b64_tr_b16 v[116:117], v10 offset:16384
    ds_read_b64_tr_b16 v[118:119], v10 offset:16896
    v_fmac_f32 v66, v66, v133
    v_fmac_f32 v67, v67, v135
    v_cvt_pk_bf16_f32 v161, v66, v67
    v_mfma_f32_32x32x16_bf16 v[48:63], v[120:123], a[224:227], v[48:63]
    v_mul_f32 v138, s49, v69
    v_mul_f32 v128, s49, v70
    v_exp_f32 v136, v136
    v_exp_f32 v138, v138
    v_mfma_f32_32x32x16_bf16 v[32:47], v[124:127], a[20:23], v[32:47]
    ds_read_b64_tr_b16 v[120:121], v10 offset:18432
    ds_read_b64_tr_b16 v[122:123], v10 offset:18944
    buffer_load_dwordx4 v8, s[8:11], s60 offen offset:0 lds
    v_fma_f32 v137, v136, -0.5, -1.0
    v_fma_f32 v139, v138, -0.5, -1.0
    v_fma_f32 v137, v136, v137, -1.0
    v_mfma_f32_32x32x16_bf16 v[48:63], v[124:127], a[228:231], v[48:63]
    v_fma_f32 v139, v138, v139, -1.0
    v_mul_f32 v130, s49, v71
    v_rcp_f32 v137, v137
    v_rcp_f32 v139, v139
    v_mfma_f32_32x32x16_bf16 v[32:47], v[140:143], a[24:27], v[32:47]
    s_waitcnt lgkmcnt(2)
    ds_read_b64_tr_b16 v[124:125], v10 offset:20480
    ds_read_b64_tr_b16 v[126:127], v10 offset:20992
    v_fmac_f32 v68, v68, v137
    v_fmac_f32 v69, v69, v139
    v_cvt_pk_bf16_f32 v162, v68, v69
    v_mfma_f32_32x32x16_bf16 v[48:63], v[140:143], a[232:235], v[48:63]
    v_mul_f32 v132, s49, v72
    v_mul_f32 v134, s49, v73
    v_exp_f32 v128, v128
    v_exp_f32 v130, v130
    v_mfma_f32_32x32x16_bf16 v[32:47], v[112:115], a[28:31], v[32:47]
    ds_read_b64_tr_b16 v[140:141], v10 offset:22528
    ds_read_b64_tr_b16 v[142:143], v10 offset:23040
    buffer_load_dwordx4 v9, s[8:11], s60 offen offset:1024 lds
    s_add_u32 m0, s51, 139264
    v_fma_f32 v129, v128, -0.5, -1.0
    v_fma_f32 v131, v130, -0.5, -1.0
    v_mfma_f32_32x32x16_bf16 v[48:63], v[112:115], a[236:239], v[48:63]
    v_fma_f32 v129, v128, v129, -1.0
    v_fma_f32 v131, v130, v131, -1.0
    v_rcp_f32 v129, v129
    v_rcp_f32 v131, v131
    v_mfma_f32_32x32x16_bf16 v[32:47], v[116:119], a[32:35], v[32:47]
    s_waitcnt vmcnt(19)
    s_barrier
    s_waitcnt lgkmcnt(2)
    ds_read_b64_tr_b16 v[112:113], v10 offset:24576
    ds_read_b64_tr_b16 v[114:115], v10 offset:25088
    s_bitcmp1_b32 s36, 0
    s_cbranch_scc1 L_ex_7
    ds_read_b128 v[152:155], v16 offset:0
    ds_read_b128 v[156:159], v16 offset:1024
    s_branch L_exe_8
L_ex_7:
    ds_read_b128 v[144:147], v16 offset:0
    ds_read_b128 v[148:151], v16 offset:1024
L_exe_8:
    v_mfma_f32_32x32x16_bf16 v[48:63], v[116:119], a[240:243], v[48:63]
    v_fmac_f32 v70, v70, v129
    v_fmac_f32 v71, v71, v131
    v_exp_f32 v132, v132
    v_exp_f32 v134, v134
    v_mfma_f32_32x32x16_bf16 v[32:47], v[120:123], a[36:39], v[32:47]
    ds_read_b64_tr_b16 v[116:117], v10 offset:26624
    ds_read_b64_tr_b16 v[118:119], v10 offset:27136
    buffer_load_dwordx4 v8, s[8:11], s61 offen offset:0 lds
    v_cvt_pk_bf16_f32 v163, v70, v71
    v_fma_f32 v133, v132, -0.5, -1.0
    v_fma_f32 v135, v134, -0.5, -1.0
    v_mfma_f32_32x32x16_bf16 v[48:63], v[120:123], a[244:247], v[48:63]
    v_fma_f32 v133, v132, v133, -1.0
    v_fma_f32 v135, v134, v135, -1.0
    v_rcp_f32 v133, v133
    v_rcp_f32 v135, v135
    v_mfma_f32_32x32x16_bf16 v[32:47], v[124:127], a[40:43], v[32:47]
    s_waitcnt lgkmcnt(2)
    ds_read_b64_tr_b16 v[120:121], v10 offset:28672
    ds_read_b64_tr_b16 v[122:123], v10 offset:29184
    v_fmac_f32 v72, v72, v133
    v_fmac_f32 v73, v73, v135
    v_cvt_pk_bf16_f32 v164, v72, v73
    v_mfma_f32_32x32x16_bf16 v[48:63], v[124:127], a[248:251], v[48:63]
    buffer_store_dwordx4 v[144:147], v17, s[12:15], s48 offen offset:0 sc1
    v_mul_f32 v136, s49, v74
    v_mul_f32 v138, s49, v75
    v_mul_f32 v128, s49, v76
    v_exp_f32 v136, v136
    v_mfma_f32_32x32x16_bf16 v[32:47], v[140:143], a[44:47], v[32:47]
    ds_read_b64_tr_b16 v[124:125], v10 offset:30720
    ds_read_b64_tr_b16 v[126:127], v10 offset:31232
    buffer_load_dwordx4 v9, s[8:11], s61 offen offset:1024 lds
    s_add_u32 m0, s51, 49152
    v_fma_f32 v137, v136, -0.5, -1.0
    v_fma_f32 v137, v136, v137, -1.0
    v_mfma_f32_32x32x16_bf16 v[48:63], v[140:143], a[252:255], v[48:63]
    v_mul_f32 v130, s49, v77
    v_mul_f32 v132, s49, v78
    v_exp_f32 v138, v138
    v_rcp_f32 v137, v137
    v_mfma_f32_32x32x16_bf16 v[32:47], v[112:115], a[48:51], v[32:47]
    s_waitcnt lgkmcnt(2)
    ds_read_b64_tr_b16 v[140:141], v10 offset:32768
    ds_read_b64_tr_b16 v[142:143], v10 offset:33280
    v_fma_f32 v139, v138, -0.5, -1.0
    v_fma_f32 v139, v138, v139, -1.0
    v_fmac_f32 v74, v74, v137
    v_mfma_f32_32x32x16_bf16 v[48:63], v[112:115], a[144:147], v[48:63]
    v_mul_f32 v134, s49, v79
    v_mul_f32 v136, s49, v80
    v_rcp_f32 v139, v139
    v_exp_f32 v128, v128
    v_mfma_f32_32x32x16_bf16 v[32:47], v[116:119], a[52:55], v[32:47]
    ds_read_b64_tr_b16 v[112:113], v10 offset:34816
    ds_read_b64_tr_b16 v[114:115], v10 offset:35328
    buffer_load_dwordx4 v8, s[8:11], s62 offen offset:0 lds
    v_fmac_f32 v75, v75, v139
    v_cvt_pk_bf16_f32 v165, v74, v75
    v_fma_f32 v129, v128, -0.5, -1.0
    v_mfma_f32_32x32x16_bf16 v[48:63], v[116:119], a[148:151], v[48:63]
    v_fma_f32 v129, v128, v129, -1.0
    v_mul_f32 v138, s49, v81
    v_exp_f32 v130, v130
    v_rcp_f32 v129, v129
    v_mfma_f32_32x32x16_bf16 v[32:47], v[120:123], a[56:59], v[32:47]
    s_waitcnt lgkmcnt(2)
    ds_read_b64_tr_b16 v[116:117], v10 offset:36864
    ds_read_b64_tr_b16 v[118:119], v10 offset:37376
    v_fma_f32 v131, v130, -0.5, -1.0
    v_fma_f32 v131, v130, v131, -1.0
    v_fmac_f32 v76, v76, v129
    v_mfma_f32_32x32x16_bf16 v[48:63], v[120:123], a[152:155], v[48:63]
    v_mul_f32 v128, s49, v82
    v_mul_f32 v130, s49, v83
    v_rcp_f32 v131, v131
    v_exp_f32 v132, v132
    v_mfma_f32_32x32x16_bf16 v[32:47], v[124:127], a[60:63], v[32:47]
    ds_read_b64_tr_b16 v[120:121], v10 offset:38912
    ds_read_b64_tr_b16 v[122:123], v10 offset:39424
    buffer_load_dwordx4 v9, s[8:11], s62 offen offset:1024 lds
    s_add_u32 m0, s51, 57344
    v_fmac_f32 v77, v77, v131
    v_cvt_pk_bf16_f32 v166, v76, v77
    v_mfma_f32_32x32x16_bf16 v[48:63], v[124:127], a[156:159], v[48:63]
    v_fma_f32 v133, v132, -0.5, -1.0
    v_fma_f32 v133, v132, v133, -1.0
    v_exp_f32 v134, v134
    v_rcp_f32 v133, v133
    v_mfma_f32_32x32x16_bf16 v[32:47], v[140:143], a[64:67], v[32:47]
    s_waitcnt lgkmcnt(2)
    ds_read_b64_tr_b16 v[124:125], v10 offset:40960
    ds_read_b64_tr_b16 v[126:127], v10 offset:41472
    v_fma_f32 v135, v134, -0.5, -1.0
    v_fma_f32 v135, v134, v135, -1.0
    v_fmac_f32 v78, v78, v133
    v_mfma_f32_32x32x16_bf16 v[48:63], v[140:143], a[160:163], v[48:63]
    buffer_store_dwordx4 v[148:151], v17, s[12:15], s48 offen offset:1024 sc1
    v_mul_f32 v132, s49, v84
    v_rcp_f32 v135, v135
    v_exp_f32 v136, v136
    v_mfma_f32_32x32x16_bf16 v[32:47], v[112:115], a[68:71], v[32:47]
    ds_read_b64_tr_b16 v[140:141], v10 offset:43008
    ds_read_b64_tr_b16 v[142:143], v10 offset:43520
    buffer_load_dwordx4 v8, s[8:11], s63 offen offset:0 lds
    v_fmac_f32 v79, v79, v135
    v_cvt_pk_bf16_f32 v167, v78, v79
    v_fma_f32 v137, v136, -0.5, -1.0
    v_mfma_f32_32x32x16_bf16 v[48:63], v[112:115], a[164:167], v[48:63]
    v_fma_f32 v137, v136, v137, -1.0
    v_mul_f32 v134, s49, v85
    v_exp_f32 v138, v138
    v_rcp_f32 v137, v137
    v_mfma_f32_32x32x16_bf16 v[32:47], v[116:119], a[72:75], v[32:47]
    s_waitcnt lgkmcnt(2)
    ds_read_b64_tr_b16 v[112:113], v10 offset:45056
    ds_read_b64_tr_b16 v[114:115], v10 offset:45568
    v_fma_f32 v139, v138, -0.5, -1.0
    v_fma_f32 v139, v138, v139, -1.0
    v_fmac_f32 v80, v80, v137
    v_mfma_f32_32x32x16_bf16 v[48:63], v[116:119], a[168:171], v[48:63]
    v_mul_f32 v136, s49, v86
    v_mul_f32 v138, s49, v87
    v_rcp_f32 v139, v139
    v_exp_f32 v128, v128
    v_mfma_f32_32x32x16_bf16 v[32:47], v[120:123], a[76:79], v[32:47]
    ds_read_b64_tr_b16 v[116:117], v10 offset:47104
    ds_read_b64_tr_b16 v[118:119], v10 offset:47616
    buffer_load_dwordx4 v9, s[8:11], s63 offen offset:1024 lds
    s_add_u32 m0, s51, 65536
    v_fmac_f32 v81, v81, v139
    v_cvt_pk_bf16_f32 v168, v80, v81
    v_mfma_f32_32x32x16_bf16 v[48:63], v[120:123], a[172:175], v[48:63]
    v_fma_f32 v129, v128, -0.5, -1.0
    v_fma_f32 v129, v128, v129, -1.0
    v_exp_f32 v130, v130
    v_rcp_f32 v129, v129
    v_mfma_f32_32x32x16_bf16 v[32:47], v[124:127], a[80:83], v[32:47]
    s_waitcnt vmcnt(20)
    s_barrier
    s_waitcnt lgkmcnt(2)
    ds_read_b64_tr_b16 v[120:121], v11 offset:24576
    ds_read_b64_tr_b16 v[122:123], v11 offset:25088
    v_fma_f32 v131, v130, -0.5, -1.0
    v_mfma_f32_32x32x16_bf16 v[48:63], v[124:127], a[176:179], v[48:63]
    v_fma_f32 v131, v130, v131, -1.0
    v_fmac_f32 v82, v82, v129
    v_rcp_f32 v131, v131
    v_exp_f32 v132, v132
    v_mfma_f32_32x32x16_bf16 v[32:47], v[140:143], a[84:87], v[32:47]
    ds_read_b64_tr_b16 v[124:125], v11 offset:26624
    ds_read_b64_tr_b16 v[126:127], v11 offset:27136
    buffer_load_dwordx4 v8, s[8:11], s64 offen offset:0 lds
    v_fmac_f32 v83, v83, v131
    v_cvt_pk_bf16_f32 v169, v82, v83
    v_fma_f32 v133, v132, -0.5, -1.0
    v_mfma_f32_32x32x16_bf16 v[48:63], v[140:143], a[180:183], v[48:63]
    v_fma_f32 v133, v132, v133, -1.0
    v_mul_f32 v128, s49, v88
    v_exp_f32 v134, v134
    v_rcp_f32 v133, v133
    v_mfma_f32_32x32x16_bf16 v[32:47], v[112:115], a[88:91], v[32:47]
    s_waitcnt lgkmcnt(2)
    ds_read_b64_tr_b16 v[140:141], v11 offset:28672
    ds_read_b64_tr_b16 v[142:143], v11 offset:29184
    ds_read_b128 v[96:99], v13 offset:1024
    ds_read_b128 v[100:103], v13 offset:1056
    ds_read_b128 v[104:107], v13 offset:1088
    ds_read_b128 v[108:111], v13 offset:1120
    v_mfma_f32_32x32x16_bf16 v[48:63], v[112:115], a[184:187], v[48:63]
    v_fma_f32 v135, v134, -0.5, -1.0
    v_fma_f32 v135, v134, v135, -1.0
    v_rcp_f32 v135, v135
    v_exp_f32 v136, v136
    v_mfma_f32_32x32x16_bf16 v[32:47], v[116:119], a[92:95], v[32:47]
    ds_read_b64_tr_b16 v[112:113], v11 offset:30720
    ds_read_b64_tr_b16 v[114:115], v11 offset:31232
    buffer_load_dwordx4 v9, s[8:11], s64 offen offset:1024 lds
    s_add_u32 s8, s8, 128
    s_addc_u32 s9, s9, 0
    s_add_u32 m0, s51, 0
    v_mfma_f32_32x32x16_bf16 v[48:63], v[116:119], a[188:191], v[48:63]
    v_fmac_f32 v84, v84, v133
    v_fmac_f32 v85, v85, v135
    v_exp_f32 v138, v138
    v_exp_f32 v128, v128
    v_mfma_f32_32x32x16_bf16 v[32:47], v[120:123], a[96:99], v[32:47]
    s_waitcnt lgkmcnt(6)
    ds_read_b64_tr_b16 v[116:117], v11 offset:32768
    ds_read_b64_tr_b16 v[118:119], v11 offset:33280
    v_cvt_pk_bf16_f32 v170, v84, v85
    v_fma_f32 v137, v136, -0.5, -1.0
    v_fma_f32 v139, v138, -0.5, -1.0
    v_mfma_f32_32x32x16_bf16 v[48:63], v[120:123], a[192:195], v[48:63]
    buffer_store_dwordx4 v[152:155], v17, s[12:15], s48 offen offset:2048 sc1
    v_fma_f32 v137, v136, v137, -1.0
    v_fma_f32 v139, v138, v139, -1.0
    v_mul_f32 v130, s49, v89
    v_rcp_f32 v137, v137
    v_mfma_f32_32x32x16_bf16 v[32:47], v[124:127], a[100:103], v[32:47]
    ds_read_b64_tr_b16 v[120:121], v11 offset:34816
    ds_read_b64_tr_b16 v[122:123], v11 offset:35328
    buffer_load_dwordx4 v8, s[8:11], s56 offen offset:0 lds
    v_fmac_f32 v86, v86, v137
    v_fma_f32 v129, v128, -0.5, -1.0
    v_fma_f32 v129, v128, v129, -1.0
    v_mfma_f32_32x32x16_bf16 v[48:63], v[124:127], a[196:199], v[48:63]
    v_mul_f32 v132, s49, v90
    v_mul_f32 v134, s49, v91
    v_rcp_f32 v139, v139
    v_exp_f32 v130, v130
    v_mfma_f32_32x32x16_bf16 v[32:47], v[140:143], a[104:107], v[32:47]
    s_waitcnt lgkmcnt(2)
    ds_read_b64_tr_b16 v[124:125], v11 offset:36864
    ds_read_b64_tr_b16 v[126:127], v11 offset:37376
    v_fmac_f32 v87, v87, v139
    v_cvt_pk_bf16_f32 v171, v86, v87
    v_fma_f32 v131, v130, -0.5, -1.0
    v_mfma_f32_32x32x16_bf16 v[48:63], v[140:143], a[200:203], v[48:63]
    v_fma_f32 v131, v130, v131, -1.0
    v_mul_f32 v136, s49, v92
    v_rcp_f32 v129, v129
    v_rcp_f32 v131, v131
    v_mfma_f32_32x32x16_bf16 v[32:47], v[112:115], a[108:111], v[32:47]
    ds_read_b64_tr_b16 v[140:141], v11 offset:38912
    ds_read_b64_tr_b16 v[142:143], v11 offset:39424
    buffer_load_dwordx4 v9, s[8:11], s56 offen offset:1024 lds
    s_add_u32 m0, s51, 8192
    v_fmac_f32 v88, v88, v129
    v_fmac_f32 v89, v89, v131
    v_mfma_f32_32x32x16_bf16 v[48:63], v[112:115], a[204:207], v[48:63]
    v_cvt_pk_bf16_f32 v172, v88, v89
    v_mul_f32 v138, s49, v93
    v_exp_f32 v132, v132
    v_exp_f32 v134, v134
    v_mfma_f32_32x32x16_bf16 v[32:47], v[116:119], a[112:115], v[32:47]
    s_waitcnt lgkmcnt(2)
    ds_read_b64_tr_b16 v[112:113], v11 offset:40960
    ds_read_b64_tr_b16 v[114:115], v11 offset:41472
    v_fma_f32 v133, v132, -0.5, -1.0
    v_fma_f32 v135, v134, -0.5, -1.0
    v_fma_f32 v133, v132, v133, -1.0
    v_mfma_f32_32x32x16_bf16 v[48:63], v[116:119], v[224:227], v[48:63]
    v_fma_f32 v135, v134, v135, -1.0
    v_mul_f32 v128, s49, v94
    v_rcp_f32 v133, v133
    v_rcp_f32 v135, v135
    v_mfma_f32_32x32x16_bf16 v[32:47], v[120:123], a[116:119], v[32:47]
    ds_read_b64_tr_b16 v[116:117], v11 offset:43008
    ds_read_b64_tr_b16 v[118:119], v11 offset:43520
    buffer_load_dwordx4 v8, s[8:11], s57 offen offset:0 lds
    v_fmac_f32 v90, v90, v133
    v_fmac_f32 v91, v91, v135
    v_cvt_pk_bf16_f32 v173, v90, v91
    v_mfma_f32_32x32x16_bf16 v[48:63], v[120:123], v[228:231], v[48:63]
    v_mul_f32 v130, s49, v95
    v_exp_f32 v136, v136
    v_exp_f32 v138, v138
    v_fma_f32 v137, v136, -0.5, -1.0
    v_mfma_f32_32x32x16_bf16 v[32:47], v[124:127], a[120:123], v[32:47]
    s_waitcnt lgkmcnt(2)
    ds_read_b64_tr_b16 v[120:121], v11 offset:45056
    ds_read_b64_tr_b16 v[122:123], v11 offset:45568
    v_fma_f32 v139, v138, -0.5, -1.0
    v_fma_f32 v137, v136, v137, -1.0
    v_fma_f32 v139, v138, v139, -1.0
    v_mfma_f32_32x32x16_bf16 v[48:63], v[124:127], v[232:235], v[48:63]
    buffer_store_dwordx4 v[156:159], v17, s[12:15], s48 offen offset:3072 sc1
    s_add_u32 s48, s48, 4096
    v_rcp_f32 v137, v137
    v_rcp_f32 v139, v139
    v_mfma_f32_32x32x16_bf16 v[32:47], v[140:143], a[124:127], v[32:47]
    ds_read_b64_tr_b16 v[124:125], v11 offset:47104
    ds_read_b64_tr_b16 v[126:127], v11 offset:47616
    buffer_load_dwordx4 v9, s[8:11], s57 offen offset:1024 lds
    s_add_u32 m0, s51, 16384
    v_fmac_f32 v92, v92, v137
    v_fmac_f32 v93, v93, v139
    v_mfma_f32_32x32x16_bf16 v[48:63], v[140:143], v[236:239], v[48:63]
    v_cvt_pk_bf16_f32 v174, v92, v93
    v_exp_f32 v128, v128
    v_exp_f32 v130, v130
    v_fma_f32 v129, v128, -0.5, -1.0
    v_mfma_f32_32x32x16_bf16 v[32:47], v[112:115], a[128:131], v[32:47]
    s_waitcnt vmcnt(20)
    s_barrier
    s_waitcnt lgkmcnt(2)
    ds_read_b64_tr_b16 v[140:141], v12 offset:0
    ds_read_b64_tr_b16 v[142:143], v12 offset:512
    v_fma_f32 v131, v130, -0.5, -1.0
    v_mfma_f32_32x32x16_bf16 v[48:63], v[112:115], v[240:243], v[48:63]
    v_fma_f32 v129, v128, v129, -1.0
    v_fma_f32 v131, v130, v131, -1.0
    v_rcp_f32 v129, v129
    v_rcp_f32 v131, v131
    v_mfma_f32_32x32x16_bf16 v[32:47], v[116:119], a[132:135], v[32:47]
    ds_read_b64_tr_b16 v[112:113], v12 offset:2048
    ds_read_b64_tr_b16 v[114:115], v12 offset:2560
    buffer_load_dwordx4 v8, s[8:11], s58 offen offset:0 lds
    v_fmac_f32 v94, v94, v129
    v_fmac_f32 v95, v95, v131
    v_cvt_pk_bf16_f32 v175, v94, v95
    v_mfma_f32_32x32x16_bf16 v[48:63], v[116:119], v[244:247], v[48:63]
    v_mfma_f32_32x32x16_bf16 v[32:47], v[120:123], a[136:139], v[32:47]
    s_waitcnt lgkmcnt(2)
    ds_read_b64_tr_b16 v[116:117], v12 offset:4096
    ds_read_b64_tr_b16 v[118:119], v12 offset:4608
    v_mfma_f32_32x32x16_bf16 v[48:63], v[120:123], v[248:251], v[48:63]
    v_mfma_f32_32x32x16_bf16 v[64:79], v[124:127], a[140:143], v[32:47]
    ds_read_b64_tr_b16 v[120:121], v12 offset:6144
    ds_read_b64_tr_b16 v[122:123], v12 offset:6656
    buffer_load_dwordx4 v9, s[8:11], s58 offen offset:1024 lds
    s_add_u32 m0, s51, 24576
    v_mfma_f32_32x32x16_bf16 v[80:95], v[124:127], v[252:255], v[48:63]
    s_bitcmp1_b32 s36, 0
    s_cbranch_scc1 L_ex_9
    ds_write_b128 v15, v[168:171] offset:0
    ds_write_b128 v15, v[172:175] offset:1024
    s_branch L_exe_10
L_ex_9:
    ds_write_b128 v15, v[160:163] offset:0
    ds_write_b128 v15, v[164:167] offset:1024
L_exe_10:
    v_mfma_f32_32x32x16_bf16 v[32:47], v[140:143], a[0:3], v[96:111]
    s_waitcnt lgkmcnt(4)
    ds_read_b64_tr_b16 v[124:125], v12 offset:8192
    ds_read_b64_tr_b16 v[126:127], v12 offset:8704
    v_mul_f32 v128, s49, v64
    v_mul_f32 v130, s49, v65
    v_mul_f32 v132, s49, v66
    v_mfma_f32_32x32x16_bf16 v[48:63], v[140:143], a[208:211], v[96:111]
    v_mul_f32 v134, s49, v67
    v_mul_f32 v136, s49, v68
    v_exp_f32 v128, v128
    v_exp_f32 v130, v130
    v_mfma_f32_32x32x16_bf16 v[32:47], v[112:115], a[4:7], v[32:47]
    ds_read_b64_tr_b16 v[140:141], v12 offset:10240
    ds_read_b64_tr_b16 v[142:143], v12 offset:10752
    buffer_load_dwordx4 v8, s[8:11], s59 offen offset:0 lds
    v_fma_f32 v129, v128, -0.5, -1.0
    v_fma_f32 v131, v130, -0.5, -1.0
    v_fma_f32 v129, v128, v129, -1.0
    v_mfma_f32_32x32x16_bf16 v[48:63], v[112:115], a[212:215], v[48:63]
    v_fma_f32 v131, v130, v131, -1.0
    v_mul_f32 v138, s49, v69
    v_rcp_f32 v129, v129
    v_rcp_f32 v131, v131
    v_mfma_f32_32x32x16_bf16 v[32:47], v[116:119], a[8:11], v[32:47]
    s_waitcnt lgkmcnt(2)
    ds_read_b64_tr_b16 v[112:113], v12 offset:12288
    ds_read_b64_tr_b16 v[114:115], v12 offset:12800
    v_fmac_f32 v64, v64, v129
    v_fmac_f32 v65, v65, v131
    v_cvt_pk_bf16_f32 v176, v64, v65
    v_mfma_f32_32x32x16_bf16 v[48:63], v[116:119], a[216:219], v[48:63]
    v_mul_f32 v128, s49, v70
    v_mul_f32 v130, s49, v71
    v_exp_f32 v132, v132
    v_exp_f32 v134, v134
    v_mfma_f32_32x32x16_bf16 v[32:47], v[120:123], a[12:15], v[32:47]
    ds_read_b64_tr_b16 v[116:117], v12 offset:14336
    ds_read_b64_tr_b16 v[118:119], v12 offset:14848
    buffer_load_dwordx4 v9, s[8:11], s59 offen offset:1024 lds
    s_add_u32 m0, s51, 32768
    v_fma_f32 v133, v132, -0.5, -1.0
    v_fma_f32 v135, v134, -0.5, -1.0
    v_mfma_f32_32x32x16_bf16 v[48:63], v[120:123], a[220:223], v[48:63]
    v_fma_f32 v133, v132, v133, -1.0
    v_fma_f32 v135, v134, v135, -1.0
    v_rcp_f32 v133, v133
    v_rcp_f32 v135, v135
    v_mfma_f32_32x32x16_bf16 v[32:47], v[124:127], a[16:19], v[32:47]
    s_waitcnt lgkmcnt(2)
    ds_read_b64_tr_b16 v[120:121], v12 offset:16384
    ds_read_b64_tr_b16 v[122:123], v12 offset:16896
    v_fmac_f32 v66, v66, v133
    v_fmac_f32 v67, v67, v135
    v_cvt_pk_bf16_f32 v177, v66, v67
    v_mfma_f32_32x32x16_bf16 v[48:63], v[124:127], a[224:227], v[48:63]
    v_mul_f32 v132, s49, v72
    v_mul_f32 v134, s49, v73
    v_exp_f32 v136, v136
    v_exp_f32 v138, v138
    v_mfma_f32_32x32x16_bf16 v[32:47], v[140:143], a[20:23], v[32:47]
    ds_read_b64_tr_b16 v[124:125], v12 offset:18432
    ds_read_b64_tr_b16 v[126:127], v12 offset:18944
    buffer_load_dwordx4 v8, s[8:11], s60 offen offset:0 lds
    v_fma_f32 v137, v136, -0.5, -1.0
    v_fma_f32 v139, v138, -0.5, -1.0
    v_fma_f32 v137, v136, v137, -1.0
    v_mfma_f32_32x32x16_bf16 v[48:63], v[140:143], a[228:231], v[48:63]
    v_fma_f32 v139, v138, v139, -1.0
    v_mul_f32 v136, s49, v74
    v_rcp_f32 v137, v137
    v_rcp_f32 v139, v139
    v_mfma_f32_32x32x16_bf16 v[32:47], v[112:115], a[24:27], v[32:47]
    s_waitcnt lgkmcnt(2)
    ds_read_b64_tr_b16 v[140:141], v12 offset:20480
    ds_read_b64_tr_b16 v[142:143], v12 offset:20992
    v_fmac_f32 v68, v68, v137
    v_fmac_f32 v69, v69, v139
    v_cvt_pk_bf16_f32 v178, v68, v69
    v_mfma_f32_32x32x16_bf16 v[48:63], v[112:115], a[232:235], v[48:63]
    v_mul_f32 v138, s49, v75
    v_exp_f32 v128, v128
    v_exp_f32 v130, v130
    v_fma_f32 v129, v128, -0.5, -1.0
    v_mfma_f32_32x32x16_bf16 v[32:47], v[116:119], a[28:31], v[32:47]
    ds_read_b64_tr_b16 v[112:113], v12 offset:22528
    ds_read_b64_tr_b16 v[114:115], v12 offset:23040
    buffer_load_dwordx4 v9, s[8:11], s60 offen offset:1024 lds
    s_add_u32 m0, s51, 40960
    v_fma_f32 v131, v130, -0.5, -1.0
    v_fma_f32 v129, v128, v129, -1.0
    v_mfma_f32_32x32x16_bf16 v[48:63], v[116:119], a[236:239], v[48:63]
    v_fma_f32 v131, v130, v131, -1.0
    v_mul_f32 v128, s49, v76
    v_rcp_f32 v129, v129
    v_rcp_f32 v131, v131
    v_mfma_f32_32x32x16_bf16 v[32:47], v[120:123], a[32:35], v[32:47]
    s_waitcnt vmcnt(19)
    s_barrier
    s_waitcnt lgkmcnt(2)
    ds_read_b64_tr_b16 v[116:117], v12 offset:24576
    ds_read_b64_tr_b16 v[118:119], v12 offset:25088
    s_bitcmp1_b32 s36, 0
    s_cbranch_scc1 L_ex_11
    ds_read_b128 v[168:171], v16 offset:0
    ds_read_b128 v[172:175], v16 offset:1024
    s_branch L_exe_12
L_ex_11:
    ds_read_b128 v[160:163], v16 offset:0
    ds_read_b128 v[164:167], v16 offset:1024
L_exe_12:
    v_mfma_f32_32x32x16_bf16 v[48:63], v[120:123], a[240:243], v[48:63]
    v_fmac_f32 v70, v70, v129
    v_fmac_f32 v71, v71, v131
    v_exp_f32 v132, v132
    v_exp_f32 v134, v134
    v_mfma_f32_32x32x16_bf16 v[32:47], v[124:127], a[36:39], v[32:47]
    ds_read_b64_tr_b16 v[120:121], v12 offset:26624
    ds_read_b64_tr_b16 v[122:123], v12 offset:27136
    buffer_load_dwordx4 v8, s[8:11], s61 offen offset:0 lds
    v_cvt_pk_bf16_f32 v179, v70, v71
    v_fma_f32 v133, v132, -0.5, -1.0
    v_fma_f32 v135, v134, -0.5, -1.0
    v_mfma_f32_32x32x16_bf16 v[48:63], v[124:127], a[244:247], v[48:63]
    v_fma_f32 v133, v132, v133, -1.0
    v_fma_f32 v135, v134, v135, -1.0
    v_rcp_f32 v133, v133
    v_rcp_f32 v135, v135
    v_mfma_f32_32x32x16_bf16 v[32:47], v[140:143], a[40:43], v[32:47]
    s_waitcnt lgkmcnt(2)
    ds_read_b64_tr_b16 v[124:125], v12 offset:28672
    ds_read_b64_tr_b16 v[126:127], v12 offset:29184
    v_fmac_f32 v72, v72, v133
    v_fmac_f32 v73, v73, v135
    v_cvt_pk_bf16_f32 v180, v72, v73
    v_mfma_f32_32x32x16_bf16 v[48:63], v[140:143], a[248:251], v[48:63]
    buffer_store_dwordx4 v[160:163], v17, s[12:15], s48 offen offset:0 sc1
    v_mul_f32 v130, s49, v77
    v_exp_f32 v136, v136
    v_exp_f32 v138, v138
    v_mfma_f32_32x32x16_bf16 v[32:47], v[112:115], a[44:47], v[32:47]
    ds_read_b64_tr_b16 v[140:141], v12 offset:30720
    ds_read_b64_tr_b16 v[142:143], v12 offset:31232
    buffer_load_dwordx4 v9, s[8:11], s61 offen offset:1024 lds
    v_fma_f32 v137, v136, -0.5, -1.0
    v_fma_f32 v139, v138, -0.5, -1.0
    v_fma_f32 v137, v136, v137, -1.0
    v_mfma_f32_32x32x16_bf16 v[48:63], v[112:115], a[252:255], v[48:63]
    v_fma_f32 v139, v138, v139, -1.0
    v_mul_f32 v132, s49, v78
    v_rcp_f32 v137, v137
    v_rcp_f32 v139, v139
    v_mfma_f32_32x32x16_bf16 v[32:47], v[116:119], a[48:51], v[32:47]
    s_waitcnt lgkmcnt(2)
    ds_read_b64_tr_b16 v[112:113], v12 offset:32768
    ds_read_b64_tr_b16 v[114:115], v12 offset:33280
    v_fmac_f32 v74, v74, v137
    v_fmac_f32 v75, v75, v139
    v_cvt_pk_bf16_f32 v181, v74, v75
    v_mfma_f32_32x32x16_bf16 v[48:63], v[116:119], a[144:147], v[48:63]
    v_mul_f32 v134, s49, v79
    v_mul_f32 v136, s49, v80
    v_exp_f32 v128, v128
    v_exp_f32 v130, v130
    v_mfma_f32_32x32x16_bf16 v[32:47], v[120:123], a[52:55], v[32:47]
    ds_read_b64_tr_b16 v[116:117], v12 offset:34816
    ds_read_b64_tr_b16 v[118:119], v12 offset:35328
    buffer_load_dword v7, off, s[28:31], 0 sc1
    s_add_u32 m0, s51, 73728
    v_fma_f32 v129, v128, -0.5, -1.0
    v_fma_f32 v131, v130, -0.5, -1.0
    v_mfma_f32_32x32x16_bf16 v[48:63], v[120:123], a[148:151], v[48:63]
    v_fma_f32 v129, v128, v129, -1.0
    v_fma_f32 v131, v130, v131, -1.0
    v_rcp_f32 v129, v129
    v_rcp_f32 v131, v131
    v_mfma_f32_32x32x16_bf16 v[32:47], v[124:127], a[56:59], v[32:47]
    s_waitcnt lgkmcnt(2)
    ds_read_b64_tr_b16 v[120:121], v12 offset:36864
    ds_read_b64_tr_b16 v[122:123], v12 offset:37376
    v_fmac_f32 v76, v76, v129
    v_fmac_f32 v77, v77, v131
    v_cvt_pk_bf16_f32 v182, v76, v77
    v_mfma_f32_32x32x16_bf16 v[48:63], v[124:127], a[152:155], v[48:63]
    v_mul_f32 v138, s49, v81
    v_mul_f32 v128, s49, v82
    v_exp_f32 v132, v132
    v_exp_f32 v134, v134
    v_mfma_f32_32x32x16_bf16 v[32:47], v[140:143], a[60:63], v[32:47]
    ds_read_b64_tr_b16 v[124:125], v12 offset:38912
    ds_read_b64_tr_b16 v[126:127], v12 offset:39424
    buffer_load_dwordx4 v8, s[8:11], s62 offen offset:0 lds
    v_fma_f32 v133, v132, -0.5, -1.0
    v_fma_f32 v135, v134, -0.5, -1.0
    v_fma_f32 v133, v132, v133, -1.0
    v_mfma_f32_32x32x16_bf16 v[48:63], v[140:143], a[156:159], v[48:63]
    v_fma_f32 v135, v134, v135, -1.0
    v_mul_f32 v130, s49, v83
    v_rcp_f32 v133, v133
    v_rcp_f32 v135, v135
    v_mfma_f32_32x32x16_bf16 v[32:47], v[112:115], a[64:67], v[32:47]
    s_waitcnt lgkmcnt(2)
    ds_read_b64_tr_b16 v[140:141], v12 offset:40960
    ds_read_b64_tr_b16 v[142:143], v12 offset:41472
    v_fmac_f32 v78, v78, v133
    v_fmac_f32 v79, v79, v135
    v_cvt_pk_bf16_f32 v183, v78, v79
    v_mfma_f32_32x32x16_bf16 v[48:63], v[112:115], a[160:163], v[48:63]
    buffer_store_dwordx4 v[164:167], v17, s[12:15], s48 offen offset:1024 sc1
    v_mul_f32 v132, s49, v84
    v_exp_f32 v136, v136
    v_exp_f32 v138, v138
    v_mfma_f32_32x32x16_bf16 v[32:47], v[116:119], a[68:71], v[32:47]
    ds_read_b64_tr_b16 v[112:113], v12 offset:43008
    ds_read_b64_tr_b16 v[114:115], v12 offset:43520
    buffer_load_dwordx4 v9, s[8:11], s62 offen offset:1024 lds
    s_add_u32 m0, s51, 81920
    v_fma_f32 v137, v136, -0.5, -1.0
    v_fma_f32 v139, v138, -0.5, -1.0
    v_mfma_f32_32x32x16_bf16 v[48:63], v[116:119], a[164:167], v[48:63]
    v_fma_f32 v137, v136, v137, -1.0
    v_fma_f32 v139, v138, v139, -1.0
    v_rcp_f32 v137, v137
    v_rcp_f32 v139, v139
    v_mfma_f32_32x32x16_bf16 v[32:47], v[120:123], a[72:75], v[32:47]
    s_waitcnt lgkmcnt(2)
    ds_read_b64_tr_b16 v[116:117], v12 offset:45056
    ds_read_b64_tr_b16 v[118:119], v12 offset:45568
    v_fmac_f32 v80, v80, v137
    v_fmac_f32 v81, v81, v139
    v_cvt_pk_bf16_f32 v184, v80, v81
    v_mfma_f32_32x32x16_bf16 v[48:63], v[120:123], a[168:171], v[48:63]
    v_mul_f32 v134, s49, v85
    v_mul_f32 v136, s49, v86
    v_exp_f32 v128, v128
    v_exp_f32 v130, v130
    v_mfma_f32_32x32x16_bf16 v[32:47], v[124:127], a[76:79], v[32:47]
    ds_read_b64_tr_b16 v[120:121], v12 offset:47104
    ds_read_b64_tr_b16 v[122:123], v12 offset:47616
    buffer_load_dwordx4 v8, s[8:11], s63 offen offset:0 lds
    v_fma_f32 v129, v128, -0.5, -1.0
    v_fma_f32 v131, v130, -0.5, -1.0
    v_fma_f32 v129, v128, v129, -1.0
    v_mfma_f32_32x32x16_bf16 v[48:63], v[124:127], a[172:175], v[48:63]
    v_fma_f32 v131, v130, v131, -1.0
    v_mul_f32 v138, s49, v87
    v_rcp_f32 v129, v129
    v_rcp_f32 v131, v131
    v_mfma_f32_32x32x16_bf16 v[32:47], v[140:143], a[80:83], v[32:47]
    s_waitcnt vmcnt(20)
    s_barrier
    s_waitcnt lgkmcnt(2)
    ds_read_b64_tr_b16 v[124:125], v11 offset:0
    ds_read_b64_tr_b16 v[126:127], v11 offset:512
    v_fmac_f32 v82, v82, v129
    v_mfma_f32_32x32x16_bf16 v[48:63], v[140:143], a[176:179], v[48:63]
    v_fmac_f32 v83, v83, v131
    v_cvt_pk_bf16_f32 v185, v82, v83
    v_exp_f32 v132, v132
    v_exp_f32 v134, v134
    v_mfma_f32_32x32x16_bf16 v[32:47], v[112:115], a[84:87], v[32:47]
    ds_read_b64_tr_b16 v[140:141], v11 offset:2048
    ds_read_b64_tr_b16 v[142:143], v11 offset:2560
    buffer_load_dwordx4 v9, s[8:11], s63 offen offset:1024 lds
    s_add_u32 m0, s51, 90112
    v_fma_f32 v133, v132, -0.5, -1.0
    v_fma_f32 v135, v134, -0.5, -1.0
    v_mfma_f32_32x32x16_bf16 v[48:63], v[112:115], a[180:183], v[48:63]
    v_fma_f32 v133, v132, v133, -1.0
    v_fma_f32 v135, v134, v135, -1.0
    v_rcp_f32 v133, v133
    v_rcp_f32 v135, v135
    v_mfma_f32_32x32x16_bf16 v[32:47], v[116:119], a[88:91], v[32:47]
    s_waitcnt lgkmcnt(2)
    ds_read_b64_tr_b16 v[112:113], v11 offset:4096
    ds_read_b64_tr_b16 v[114:115], v11 offset:4608
    ds_read_b128 v[96:99], v13 offset:1280
    ds_read_b128 v[100:103], v13 offset:1312
    ds_read_b128 v[104:107], v13 offset:1344
    ds_read_b128 v[108:111], v13 offset:1376
    v_mfma_f32_32x32x16_bf16 v[48:63], v[116:119], a[184:187], v[48:63]
    v_fmac_f32 v84, v84, v133
    v_fmac_f32 v85, v85, v135
    v_exp_f32 v136, v136
    v_exp_f32 v138, v138
    v_mfma_f32_32x32x16_bf16 v[32:47], v[120:123], a[92:95], v[32:47]
    ds_read_b64_tr_b16 v[116:117], v11 offset:6144
    ds_read_b64_tr_b16 v[118:119], v11 offset:6656
    buffer_load_dwordx4 v8, s[8:11], s64 offen offset:0 lds
    v_cvt_pk_bf16_f32 v186, v84, v85
    v_fma_f32 v137, v136, -0.5, -1.0
    v_fma_f32 v139, v138, -0.5, -1.0
    v_mfma_f32_32x32x16_bf16 v[48:63], v[120:123], a[188:191], v[48:63]
    v_fma_f32 v137, v136, v137, -1.0
    v_fma_f32 v139, v138, v139, -1.0
    v_rcp_f32 v137, v137
    v_rcp_f32 v139, v139
    v_mfma_f32_32x32x16_bf16 v[32:47], v[124:127], a[96:99], v[32:47]
    s_waitcnt lgkmcnt(6)
    ds_read_b64_tr_b16 v[120:121], v11 offset:8192
    ds_read_b64_tr_b16 v[122:123], v11 offset:8704
    v_fmac_f32 v86, v86, v137
    v_fmac_f32 v87, v87, v139
    v_cvt_pk_bf16_f32 v187, v86, v87
    v_mfma_f32_32x32x16_bf16 v[48:63], v[124:127], a[192:195], v[48:63]
    buffer_store_dwordx4 v[168:171], v17, s[12:15], s48 offen offset:2048 sc1
    v_mul_f32 v128, s49, v88
    v_mul_f32 v130, s49, v89
    v_mul_f32 v132, s49, v90
    v_exp_f32 v128, v128
    v_mfma_f32_32x32x16_bf16 v[32:47], v[140:143], a[100:103], v[32:47]
    ds_read_b64_tr_b16 v[124:125], v11 offset:10240
    ds_read_b64_tr_b16 v[126:127], v11 offset:10752
    buffer_load_dwordx4 v9, s[8:11], s64 offen offset:1024 lds
    s_add_u32 m0, s3, 98304
    s_add_u32 s47, s66, 73728
    v_fma_f32 v129, v128, -0.5, -1.0
    v_mfma_f32_32x32x16_bf16 v[48:63], v[140:143], a[196:199], v[48:63]
    v_fma_f32 v129, v128, v129, -1.0
    v_mul_f32 v134, s49, v91
    v_exp_f32 v130, v130
    v_rcp_f32 v129, v129
    v_mfma_f32_32x32x16_bf16 v[32:47], v[112:115], a[104:107], v[32:47]
    s_waitcnt lgkmcnt(2)
    ds_read_b64_tr_b16 v[140:141], v11 offset:12288
    ds_read_b64_tr_b16 v[142:143], v11 offset:12800
    v_fma_f32 v131, v130, -0.5, -1.0
    v_fma_f32 v131, v130, v131, -1.0
    v_fmac_f32 v88, v88, v129
    v_mfma_f32_32x32x16_bf16 v[48:63], v[112:115], a[200:203], v[48:63]
    v_mul_f32 v136, s49, v92
    v_mul_f32 v138, s49, v93
    v_rcp_f32 v131, v131
    v_exp_f32 v132, v132
    v_mfma_f32_32x32x16_bf16 v[32:47], v[116:119], a[108:111], v[32:47]
    ds_read_b64_tr_b16 v[112:113], v11 offset:14336
    ds_read_b64_tr_b16 v[114:115], v11 offset:14848
    buffer_load_dwordx4 v18, s[16:19], s47 offen offset:0 lds
    v_fmac_f32 v89, v89, v131
    v_cvt_pk_bf16_f32 v188, v88, v89
    v_fma_f32 v133, v132, -0.5, -1.0
    v_mfma_f32_32x32x16_bf16 v[48:63], v[116:119], a[204:207], v[48:63]
    v_fma_f32 v133, v132, v133, -1.0
    v_mul_f32 v128, s49, v94
    v_exp_f32 v134, v134
    v_rcp_f32 v133, v133
    v_mfma_f32_32x32x16_bf16 v[32:47], v[120:123], a[112:115], v[32:47]
    s_waitcnt lgkmcnt(2)
    ds_read_b64_tr_b16 v[116:117], v11 offset:16384
    ds_read_b64_tr_b16 v[118:119], v11 offset:16896
    v_fma_f32 v135, v134, -0.5, -1.0
    v_fma_f32 v135, v134, v135, -1.0
    v_fmac_f32 v90, v90, v133
    v_mfma_f32_32x32x16_bf16 v[48:63], v[120:123], v[224:227], v[48:63]
    v_mul_f32 v130, s49, v95
    v_rcp_f32 v135, v135
    v_exp_f32 v136, v136
    v_fmac_f32 v91, v91, v135
    v_mfma_f32_32x32x16_bf16 v[32:47], v[124:127], a[116:119], v[32:47]
    ds_read_b64_tr_b16 v[120:121], v11 offset:18432
    ds_read_b64_tr_b16 v[122:123], v11 offset:18944
    buffer_load_dwordx4 v19, s[16:19], s47 offen offset:1024 lds
    v_cvt_pk_bf16_f32 v189, v90, v91
    v_fma_f32 v137, v136, -0.5, -1.0
    v_fma_f32 v137, v136, v137, -1.0
    v_mfma_f32_32x32x16_bf16 v[48:63], v[124:127], v[228:231], v[48:63]
    v_exp_f32 v138, v138
    v_rcp_f32 v137, v137
    v_exp_f32 v128, v128
    v_mfma_f32_32x32x16_bf16 v[32:47], v[140:143], a[120:123], v[32:47]
    s_waitcnt lgkmcnt(2)
    ds_read_b64_tr_b16 v[124:125], v11 offset:20480
    ds_read_b64_tr_b16 v[126:127], v11 offset:20992
    v_fma_f32 v139, v138, -0.5, -1.0
    v_fma_f32 v139, v138, v139, -1.0
    v_fmac_f32 v92, v92, v137
    v_mfma_f32_32x32x16_bf16 v[48:63], v[140:143], v[232:235], v[48:63]
    buffer_store_dwordx4 v[172:175], v17, s[12:15], s48 offen offset:3072 sc1
    s_add_u32 s48, s48, 4096
    v_rcp_f32 v139, v139
    v_exp_f32 v130, v130
    v_mfma_f32_32x32x16_bf16 v[32:47], v[112:115], a[124:127], v[32:47]
    ds_read_b64_tr_b16 v[140:141], v11 offset:22528
    ds_read_b64_tr_b16 v[142:143], v11 offset:23040
    buffer_load_dwordx4 v20, s[16:19], s47 offen offset:2048 lds
    v_fmac_f32 v93, v93, v139
    v_cvt_pk_bf16_f32 v190, v92, v93
    v_fma_f32 v129, v128, -0.5, -1.0
    v_mfma_f32_32x32x16_bf16 v[48:63], v[112:115], v[236:239], v[48:63]
    v_fma_f32 v131, v130, -0.5, -1.0
    v_fma_f32 v129, v128, v129, -1.0
    v_fma_f32 v131, v130, v131, -1.0
    v_rcp_f32 v129, v129
    v_mfma_f32_32x32x16_bf16 v[32:47], v[116:119], a[128:131], v[32:47]
    s_waitcnt vmcnt(20)
    s_barrier
    s_waitcnt lgkmcnt(2)
    ds_read_b64_tr_b16 v[112:113], v10 offset:0
    ds_read_b64_tr_b16 v[114:115], v10 offset:512
    v_fmac_f32 v94, v94, v129
    v_mfma_f32_32x32x16_bf16 v[48:63], v[116:119], v[240:243], v[48:63]
    v_rcp_f32 v131, v131
    v_mfma_f32_32x32x16_bf16 v[32:47], v[120:123], a[132:135], v[32:47]
    ds_read_b64_tr_b16 v[116:117], v10 offset:2048
    ds_read_b64_tr_b16 v[118:119], v10 offset:2560
    buffer_load_dwordx4 v21, s[16:19], s47 offen offset:3072 lds
    s_add_u32 m0, s3, 102400
    v_fmac_f32 v95, v95, v131
    v_cvt_pk_bf16_f32 v191, v94, v95
    v_mfma_f32_32x32x16_bf16 v[48:63], v[120:123], v[244:247], v[48:63]
    v_mfma_f32_32x32x16_bf16 v[32:47], v[124:127], a[136:139], v[32:47]
    s_waitcnt lgkmcnt(2)
    ds_read_b64_tr_b16 v[120:121], v10 offset:4096
    ds_read_b64_tr_b16 v[122:123], v10 offset:4608
    v_mfma_f32_32x32x16_bf16 v[48:63], v[124:127], v[248:251], v[48:63]
    v_mfma_f32_32x32x16_bf16 v[64:79], v[140:143], a[140:143], v[32:47]
    ds_read_b64_tr_b16 v[124:125], v10 offset:6144
    ds_read_b64_tr_b16 v[126:127], v10 offset:6656
    buffer_load_dwordx4 v22, s[16:19], s47 offen offset:0 lds
    v_mfma_f32_32x32x16_bf16 v[80:95], v[140:143], v[252:255], v[48:63]
    s_bitcmp1_b32 s36, 0
    s_cbranch_scc1 L_ex_13
    ds_write_b128 v15, v[184:187] offset:0
    ds_write_b128 v15, v[188:191] offset:1024
    s_branch L_exe_14
L_ex_13:
    ds_write_b128 v15, v[176:179] offset:0
    ds_write_b128 v15, v[180:183] offset:1024
L_exe_14:
    v_mfma_f32_32x32x16_bf16 v[32:47], v[112:115], a[0:3], v[96:111]
    s_waitcnt lgkmcnt(4)
    ds_read_b64_tr_b16 v[140:141], v10 offset:8192
    ds_read_b64_tr_b16 v[142:143], v10 offset:8704
    v_mul_f32 v128, s49, v64
    v_mul_f32 v130, s49, v65
    v_mul_f32 v132, s49, v66
    v_mfma_f32_32x32x16_bf16 v[48:63], v[112:115], a[208:211], v[96:111]
    v_mul_f32 v134, s49, v67
    v_mul_f32 v136, s49, v68
    v_exp_f32 v128, v128
    v_exp_f32 v130, v130
    v_mfma_f32_32x32x16_bf16 v[32:47], v[116:119], a[4:7], v[32:47]
    ds_read_b64_tr_b16 v[112:113], v10 offset:10240
    ds_read_b64_tr_b16 v[114:115], v10 offset:10752
    buffer_load_dwordx4 v23, s[16:19], s47 offen offset:1024 lds
    s_add_u32 m0, s3, 122880
    s_add_u32 s47, s66, 147456
    v_fma_f32 v129, v128, -0.5, -1.0
    v_mfma_f32_32x32x16_bf16 v[48:63], v[116:119], a[212:215], v[48:63]
    v_fma_f32 v131, v130, -0.5, -1.0
    v_fma_f32 v129, v128, v129, -1.0
    v_rcp_f32 v129, v129
    v_exp_f32 v132, v132
    v_mfma_f32_32x32x16_bf16 v[32:47], v[120:123], a[8:11], v[32:47]
    s_waitcnt lgkmcnt(2)
    ds_read_b64_tr_b16 v[116:117], v10 offset:12288
    ds_read_b64_tr_b16 v[118:119], v10 offset:12800
    v_fma_f32 v131, v130, v131, -1.0
    v_fmac_f32 v64, v64, v129
    v_fma_f32 v133, v132, -0.5, -1.0
    v_mfma_f32_32x32x16_bf16 v[48:63], v[120:123], a[216:219], v[48:63]
    v_fma_f32 v133, v132, v133, -1.0
    v_mul_f32 v138, s49, v69
    v_rcp_f32 v131, v131
    v_exp_f32 v134, v134
    v_mfma_f32_32x32x16_bf16 v[32:47], v[124:127], a[12:15], v[32:47]
    ds_read_b64_tr_b16 v[120:121], v10 offset:14336
    ds_read_b64_tr_b16 v[122:123], v10 offset:14848
    buffer_load_dwordx4 v18, s[16:19], s47 offen offset:0 lds
    v_fmac_f32 v65, v65, v131
    v_cvt_pk_bf16_f32 v192, v64, v65
    v_fma_f32 v135, v134, -0.5, -1.0
    v_mfma_f32_32x32x16_bf16 v[48:63], v[124:127], a[220:223], v[48:63]
    v_fma_f32 v135, v134, v135, -1.0
    v_mul_f32 v128, s49, v70
    v_rcp_f32 v133, v133
    v_rcp_f32 v135, v135
    v_mfma_f32_32x32x16_bf16 v[32:47], v[140:143], a[16:19], v[32:47]
    s_waitcnt lgkmcnt(2)
    ds_read_b64_tr_b16 v[124:125], v10 offset:16384
    ds_read_b64_tr_b16 v[126:127], v10 offset:16896
    v_fmac_f32 v66, v66, v133
    v_fmac_f32 v67, v67, v135
    v_cvt_pk_bf16_f32 v193, v66, v67
    v_mfma_f32_32x32x16_bf16 v[48:63], v[140:143], a[224:227], v[48:63]
    v_mul_f32 v130, s49, v71
    v_mul_f32 v132, s49, v72
    v_exp_f32 v136, v136
    v_exp_f32 v138, v138
    v_mfma_f32_32x32x16_bf16 v[32:47], v[112:115], a[20:23], v[32:47]
    ds_read_b64_tr_b16 v[140:141], v10 offset:18432
    ds_read_b64_tr_b16 v[142:143], v10 offset:18944
    buffer_load_dwordx4 v19, s[16:19], s47 offen offset:1024 lds
    v_fma_f32 v137, v136, -0.5, -1.0
    v_fma_f32 v139, v138, -0.5, -1.0
    v_fma_f32 v137, v136, v137, -1.0
    v_mfma_f32_32x32x16_bf16 v[48:63], v[112:115], a[228:231], v[48:63]
    v_fma_f32 v139, v138, v139, -1.0
    v_mul_f32 v134, s49, v73
    v_rcp_f32 v137, v137
    v_rcp_f32 v139, v139
    v_mfma_f32_32x32x16_bf16 v[32:47], v[116:119], a[24:27], v[32:47]
    s_waitcnt lgkmcnt(2)
    ds_read_b64_tr_b16 v[112:113], v10 offset:20480
    ds_read_b64_tr_b16 v[114:115], v10 offset:20992
    v_fmac_f32 v68, v68, v137
    v_fmac_f32 v69, v69, v139
    v_cvt_pk_bf16_f32 v194, v68, v69
    v_mfma_f32_32x32x16_bf16 v[48:63], v[116:119], a[232:235], v[48:63]
    v_mul_f32 v136, s49, v74
    v_mul_f32 v138, s49, v75
    v_exp_f32 v128, v128
    v_exp_f32 v130, v130
    v_mfma_f32_32x32x16_bf16 v[32:47], v[120:123], a[28:31], v[32:47]
    ds_read_b64_tr_b16 v[116:117], v10 offset:22528
    ds_read_b64_tr_b16 v[118:119], v10 offset:23040
    buffer_load_dwordx4 v20, s[16:19], s47 offen offset:2048 lds
    v_fma_f32 v129, v128, -0.5, -1.0
    v_fma_f32 v131, v130, -0.5, -1.0
    v_fma_f32 v129, v128, v129, -1.0
    v_mfma_f32_32x32x16_bf16 v[48:63], v[120:123], a[236:239], v[48:63]
    v_fma_f32 v131, v130, v131, -1.0
    v_mul_f32 v128, s49, v76
    v_rcp_f32 v129, v129
    v_rcp_f32 v131, v131
    v_mfma_f32_32x32x16_bf16 v[32:47], v[124:127], a[32:35], v[32:47]
    s_waitcnt vmcnt(7)
    s_barrier
    v_readfirstlane_b32 s85, v7
    s_nop 0
    s_cmp_ge_u32 s85, 64
    s_cbranch_scc1 L_chk_15
    s_call_b64 s[54:55], L_pollc
L_chk_15:
    s_waitcnt lgkmcnt(2)
    ds_read_b64_tr_b16 v[120:121], v10 offset:24576
    ds_read_b64_tr_b16 v[122:123], v10 offset:25088
    s_bitcmp1_b32 s36, 0
    s_cbranch_scc1 L_ex_16
    ds_read_b128 v[184:187], v16 offset:0
    ds_read_b128 v[188:191], v16 offset:1024
    s_branch L_exe_17
L_ex_16:
    ds_read_b128 v[176:179], v16 offset:0
    ds_read_b128 v[180:183], v16 offset:1024
L_exe_17:
    v_mfma_f32_32x32x16_bf16 v[48:63], v[124:127], a[240:243], v[48:63]
    v_mov_b32 v31, 1
    s_add_u32 s44, s42, 0
    buffer_store_dword v31, off, s[12:15], s44 sc1
    v_fmac_f32 v70, v70, v129
    v_exp_f32 v132, v132
    v_mfma_f32_32x32x16_bf16 v[32:47], v[140:143], a[36:39], v[32:47]
    ds_read_b64_tr_b16 v[124:125], v10 offset:26624
    ds_read_b64_tr_b16 v[126:127], v10 offset:27136
    buffer_load_dwordx4 v21, s[16:19], s47 offen offset:3072 lds
    s_add_u32 m0, s3, 126976
    v_fmac_f32 v71, v71, v131
    v_cvt_pk_bf16_f32 v195, v70, v71
    v_mfma_f32_32x32x16_bf16 v[48:63], v[140:143], a[244:247], v[48:63]
    v_fma_f32 v133, v132, -0.5, -1.0
    v_fma_f32 v133, v132, v133, -1.0
    v_exp_f32 v134, v134
    v_rcp_f32 v133, v133
    v_mfma_f32_32x32x16_bf16 v[32:47], v[112:115], a[40:43], v[32:47]
    s_waitcnt lgkmcnt(2)
    ds_read_b64_tr_b16 v[140:141], v10 offset:28672
    ds_read_b64_tr_b16 v[142:143], v10 offset:29184
    v_fma_f32 v135, v134, -0.5, -1.0
    v_fma_f32 v135, v134, v135, -1.0
    v_fmac_f32 v72, v72, v133
    v_mfma_f32_32x32x16_bf16 v[48:63], v[112:115], a[248:251], v[48:63]
    buffer_store_dwordx4 v[176:179], v17, s[12:15], s48 offen offset:0 sc1
    v_mul_f32 v130, s49, v77
    v_rcp_f32 v135, v135
    v_exp_f32 v136, v136
    v_mfma_f32_32x32x16_bf16 v[32:47], v[116:119], a[44:47], v[32:47]
    ds_read_b64_tr_b16 v[112:113], v10 offset:30720
    ds_read_b64_tr_b16 v[114:115], v10 offset:31232
    buffer_load_dwordx4 v22, s[16:19], s47 offen offset:0 lds
    v_fmac_f32 v73, v73, v135
    v_cvt_pk_bf16_f32 v196, v72, v73
    v_fma_f32 v137, v136, -0.5, -1.0
    v_mfma_f32_32x32x16_bf16 v[48:63], v[116:119], a[252:255], v[48:63]
    v_fma_f32 v137, v136, v137, -1.0
    v_mul_f32 v132, s49, v78
    v_exp_f32 v138, v138
    v_rcp_f32 v137, v137
    v_mfma_f32_32x32x16_bf16 v[32:47], v[120:123], a[48:51], v[32:47]
    s_waitcnt lgkmcnt(2)
    ds_read_b64_tr_b16 v[116:117], v10 offset:32768
    ds_read_b64_tr_b16 v[118:119], v10 offset:33280
    v_fma_f32 v139, v138, -0.5, -1.0
    v_fma_f32 v139, v138, v139, -1.0
    v_fmac_f32 v74, v74, v137
    v_mfma_f32_32x32x16_bf16 v[48:63], v[120:123], a[144:147], v[48:63]
    v_mul_f32 v134, s49, v79
    v_mul_f32 v136, s49, v80
    v_rcp_f32 v139, v139
    v_exp_f32 v128, v128
    v_mfma_f32_32x32x16_bf16 v[32:47], v[124:127], a[52:55], v[32:47]
    ds_read_b64_tr_b16 v[120:121], v10 offset:34816
    ds_read_b64_tr_b16 v[122:123], v10 offset:35328
    buffer_load_dwordx4 v23, s[16:19], s47 offen offset:1024 lds
    s_add_u32 m0, s3, 49152
    s_add_u32 s47, s66, 221184
    v_fmac_f32 v75, v75, v139
    v_mfma_f32_32x32x16_bf16 v[48:63], v[124:127], a[148:151], v[48:63]
    v_cvt_pk_bf16_f32 v197, v74, v75
    v_fma_f32 v129, v128, -0.5, -1.0
    v_exp_f32 v130, v130
    v_exp_f32 v132, v132
    v_mfma_f32_32x32x16_bf16 v[32:47], v[140:143], a[56:59], v[32:47]
    s_waitcnt lgkmcnt(2)
    ds_read_b64_tr_b16 v[124:125], v10 offset:36864
    ds_read_b64_tr_b16 v[126:127], v10 offset:37376
    v_fma_f32 v131, v130, -0.5, -1.0
    v_fma_f32 v129, v128, v129, -1.0
    v_fma_f32 v131, v130, v131, -1.0
    v_mfma_f32_32x32x16_bf16 v[48:63], v[140:143], a[152:155], v[48:63]
    v_fma_f32 v133, v132, -0.5, -1.0
    v_fma_f32 v133, v132, v133, -1.0
    v_rcp_f32 v129, v129
    v_rcp_f32 v131, v131
    v_mfma_f32_32x32x16_bf16 v[32:47], v[112:115], a[60:63], v[32:47]
    ds_read_b64_tr_b16 v[140:141], v10 offset:38912
    ds_read_b64_tr_b16 v[142:143], v10 offset:39424
    buffer_load_dwordx4 v18, s[16:19], s47 offen offset:0 lds
    v_fmac_f32 v76, v76, v129
    v_fmac_f32 v77, v77, v131
    v_cvt_pk_bf16_f32 v198, v76, v77
    v_mfma_f32_32x32x16_bf16 v[48:63], v[112:115], a[156:159], v[48:63]
    v_mul_f32 v138, s49, v81
    v_mul_f32 v128, s49, v82
    v_exp_f32 v134, v134
    v_rcp_f32 v133, v133
    v_mfma_f32_32x32x16_bf16 v[32:47], v[116:119], a[64:67], v[32:47]
    s_waitcnt lgkmcnt(2)
    ds_read_b64_tr_b16 v[112:113], v10 offset:40960
    ds_read_b64_tr_b16 v[114:115], v10 offset:41472
    v_fma_f32 v135, v134, -0.5, -1.0
    v_fma_f32 v135, v134, v135, -1.0
    v_fmac_f32 v78, v78, v133
    v_mfma_f32_32x32x16_bf16 v[48:63], v[116:119], a[160:163], v[48:63]
    buffer_store_dwordx4 v[180:183], v17, s[12:15], s48 offen offset:1024 sc1
    v_mul_f32 v130, s49, v83
    v_rcp_f32 v135, v135
    v_exp_f32 v136, v136
    v_mfma_f32_32x32x16_bf16 v[32:47], v[120:123], a[68:71], v[32:47]
    ds_read_b64_tr_b16 v[116:117], v10 offset:43008
    ds_read_b64_tr_b16 v[118:119], v10 offset:43520
    buffer_load_dwordx4 v19, s[16:19], s47 offen offset:1024 lds
    v_fmac_f32 v79, v79, v135
    v_cvt_pk_bf16_f32 v199, v78, v79
    v_fma_f32 v137, v136, -0.5, -1.0
    v_mfma_f32_32x32x16_bf16 v[48:63], v[120:123], a[164:167], v[48:63]
    v_fma_f32 v137, v136, v137, -1.0
    v_mul_f32 v132, s49, v84
    v_exp_f32 v138, v138
    v_rcp_f32 v137, v137
    v_mfma_f32_32x32x16_bf16 v[32:47], v[124:127], a[72:75], v[32:47]
    s_waitcnt lgkmcnt(2)
    ds_read_b64_tr_b16 v[120:121], v10 offset:45056
    ds_read_b64_tr_b16 v[122:123], v10 offset:45568
    v_fma_f32 v139, v138, -0.5, -1.0
    v_fma_f32 v139, v138, v139, -1.0
    v_fmac_f32 v80, v80, v137
    v_mfma_f32_32x32x16_bf16 v[48:63], v[124:127], a[168:171], v[48:63]
    v_mul_f32 v134, s49, v85
    v_mul_f32 v136, s49, v86
    v_rcp_f32 v139, v139
    v_exp_f32 v128, v128
    v_mfma_f32_32x32x16_bf16 v[32:47], v[140:143], a[76:79], v[32:47]
    ds_read_b64_tr_b16 v[124:125], v10 offset:47104
    ds_read_b64_tr_b16 v[126:127], v10 offset:47616
    buffer_load_dwordx4 v20, s[16:19], s47 offen offset:2048 lds
    v_fmac_f32 v81, v81, v139
    v_cvt_pk_bf16_f32 v200, v80, v81
    v_fma_f32 v129, v128, -0.5, -1.0
    v_mfma_f32_32x32x16_bf16 v[48:63], v[140:143], a[172:175], v[48:63]
    v_fma_f32 v129, v128, v129, -1.0
    v_mul_f32 v138, s49, v87
    v_exp_f32 v130, v130
    v_rcp_f32 v129, v129
    v_mfma_f32_32x32x16_bf16 v[32:47], v[112:115], a[80:83], v[32:47]
    s_barrier
    s_waitcnt lgkmcnt(2)
    ds_read_b64_tr_b16 v[140:141], v11 offset:24576
    ds_read_b64_tr_b16 v[142:143], v11 offset:25088
    v_fma_f32 v131, v130, -0.5, -1.0
    v_fma_f32 v131, v130, v131, -1.0
    v_mfma_f32_32x32x16_bf16 v[48:63], v[112:115], a[176:179], v[48:63]
    v_fmac_f32 v82, v82, v129
    v_mul_f32 v128, s49, v88
    v_rcp_f32 v131, v131
    v_exp_f32 v132, v132
    v_mfma_f32_32x32x16_bf16 v[32:47], v[116:119], a[84:87], v[32:47]
    ds_read_b64_tr_b16 v[112:113], v11 offset:26624
    ds_read_b64_tr_b16 v[114:115], v11 offset:27136
    buffer_load_dwordx4 v21, s[16:19], s47 offen offset:3072 lds
    s_add_u32 m0, s3, 53248
    v_fmac_f32 v83, v83, v131
    v_cvt_pk_bf16_f32 v201, v82, v83
    v_mfma_f32_32x32x16_bf16 v[48:63], v[116:119], a[180:183], v[48:63]
    v_fma_f32 v133, v132, -0.5, -1.0
    v_fma_f32 v133, v132, v133, -1.0
    v_exp_f32 v134, v134
    v_rcp_f32 v133, v133
    v_mfma_f32_32x32x16_bf16 v[32:47], v[120:123], a[88:91], v[32:47]
    s_waitcnt lgkmcnt(2)
    ds_read_b64_tr_b16 v[116:117], v11 offset:28672
    ds_read_b64_tr_b16 v[118:119], v11 offset:29184
    v_fma_f32 v135, v134, -0.5, -1.0
    v_fma_f32 v135, v134, v135, -1.0
    v_fmac_f32 v84, v84, v133
    v_mfma_f32_32x32x16_bf16 v[48:63], v[120:123], a[184:187], v[48:63]
    v_mul_f32 v130, s49, v89
    v_mul_f32 v132, s49, v90
    v_rcp_f32 v135, v135
    v_exp_f32 v136, v136
    v_mfma_f32_32x32x16_bf16 v[32:47], v[124:127], a[92:95], v[32:47]
    ds_read_b64_tr_b16 v[120:121], v11 offset:30720
    ds_read_b64_tr_b16 v[122:123], v11 offset:31232
    buffer_load_dwordx4 v22, s[16:19], s47 offen offset:0 lds
    v_fmac_f32 v85, v85, v135
    v_cvt_pk_bf16_f32 v202, v84, v85
    v_fma_f32 v137, v136, -0.5, -1.0
    v_mfma_f32_32x32x16_bf16 v[48:63], v[124:127], a[188:191], v[48:63]
    v_fma_f32 v137, v136, v137, -1.0
    v_mul_f32 v134, s49, v91
    v_exp_f32 v138, v138
    v_rcp_f32 v137, v137
    v_mfma_f32_32x32x16_bf16 v[32:47], v[140:143], a[96:99], v[32:47]
    s_waitcnt lgkmcnt(2)
    ds_read_b64_tr_b16 v[124:125], v11 offset:32768
    ds_read_b64_tr_b16 v[126:127], v11 offset:33280
    v_fma_f32 v139, v138, -0.5, -1.0
    v_fma_f32 v139, v138, v139, -1.0
    v_fmac_f32 v86, v86, v137
    v_mfma_f32_32x32x16_bf16 v[48:63], v[140:143], a[192:195], v[48:63]
    buffer_store_dwordx4 v[184:187], v17, s[12:15], s48 offen offset:2048 sc1
    v_mul_f32 v136, s49, v92
    v_rcp_f32 v139, v139
    v_exp_f32 v128, v128
    v_mfma_f32_32x32x16_bf16 v[32:47], v[112:115], a[100:103], v[32:47]
    ds_read_b64_tr_b16 v[140:141], v11 offset:34816
    ds_read_b64_tr_b16 v[142:143], v11 offset:35328
    buffer_load_dwordx4 v23, s[16:19], s47 offen offset:1024 lds
    s_add_u32 m0, s3, 0
    s_add_u32 s47, s66, 294912
    v_fmac_f32 v87, v87, v139
    v_mfma_f32_32x32x16_bf16 v[48:63], v[112:115], a[196:199], v[48:63]
    v_cvt_pk_bf16_f32 v203, v86, v87
    v_fma_f32 v129, v128, -0.5, -1.0
    v_exp_f32 v130, v130
    v_exp_f32 v132, v132
    v_mfma_f32_32x32x16_bf16 v[32:47], v[116:119], a[104:107], v[32:47]
    s_waitcnt lgkmcnt(2)
    ds_read_b64_tr_b16 v[112:113], v11 offset:36864
    ds_read_b64_tr_b16 v[114:115], v11 offset:37376
    v_fma_f32 v131, v130, -0.5, -1.0
    v_fma_f32 v129, v128, v129, -1.0
    v_fma_f32 v131, v130, v131, -1.0
    v_mfma_f32_32x32x16_bf16 v[48:63], v[116:119], a[200:203], v[48:63]
    v_fma_f32 v133, v132, -0.5, -1.0
    v_fma_f32 v133, v132, v133, -1.0
    v_rcp_f32 v129, v129
    v_rcp_f32 v131, v131
    v_mfma_f32_32x32x16_bf16 v[32:47], v[120:123], a[108:111], v[32:47]
    ds_read_b64_tr_b16 v[116:117], v11 offset:38912
    ds_read_b64_tr_b16 v[118:119], v11 offset:39424
    buffer_load_dwordx4 v18, s[16:19], s47 offen offset:0 lds
    v_fmac_f32 v88, v88, v129
    v_fmac_f32 v89, v89, v131
    v_cvt_pk_bf16_f32 v204, v88, v89
    v_mfma_f32_32x32x16_bf16 v[48:63], v[120:123], a[204:207], v[48:63]
    v_mul_f32 v138, s49, v93
    v_mul_f32 v128, s49, v94
    v_exp_f32 v134, v134
    v_rcp_f32 v133, v133
    v_mfma_f32_32x32x16_bf16 v[32:47], v[124:127], a[112:115], v[32:47]
    s_waitcnt lgkmcnt(2)
    ds_read_b64_tr_b16 v[120:121], v11 offset:40960
    ds_read_b64_tr_b16 v[122:123], v11 offset:41472
    v_fma_f32 v135, v134, -0.5, -1.0
    v_fma_f32 v135, v134, v135, -1.0
    v_fmac_f32 v90, v90, v133
    v_mfma_f32_32x32x16_bf16 v[48:63], v[124:127], v[224:227], v[48:63]
    v_mul_f32 v130, s49, v95
    v_rcp_f32 v135, v135
    v_exp_f32 v136, v136
    v_fmac_f32 v91, v91, v135
    v_mfma_f32_32x32x16_bf16 v[32:47], v[140:143], a[116:119], v[32:47]
    ds_read_b64_tr_b16 v[124:125], v11 offset:43008
    ds_read_b64_tr_b16 v[126:127], v11 offset:43520
    buffer_load_dwordx4 v19, s[16:19], s47 offen offset:1024 lds
    v_cvt_pk_bf16_f32 v205, v90, v91
    v_fma_f32 v137, v136, -0.5, -1.0
    v_fma_f32 v137, v136, v137, -1.0
    v_mfma_f32_32x32x16_bf16 v[48:63], v[140:143], v[228:231], v[48:63]
    v_exp_f32 v138, v138
    v_rcp_f32 v137, v137
    v_exp_f32 v128, v128
    v_mfma_f32_32x32x16_bf16 v[32:47], v[112:115], a[120:123], v[32:47]
    s_waitcnt lgkmcnt(2)
    ds_read_b64_tr_b16 v[140:141], v11 offset:45056
    ds_read_b64_tr_b16 v[142:143], v11 offset:45568
    v_fma_f32 v139, v138, -0.5, -1.0
    v_fma_f32 v139, v138, v139, -1.0
    v_fmac_f32 v92, v92, v137
    v_mfma_f32_32x32x16_bf16 v[48:63], v[112:115], v[232:235], v[48:63]
    buffer_store_dwordx4 v[188:191], v17, s[12:15], s48 offen offset:3072 sc1
    s_add_u32 s48, s48, 4096
    v_rcp_f32 v139, v139
    v_exp_f32 v130, v130
    v_mfma_f32_32x32x16_bf16 v[32:47], v[116:119], a[124:127], v[32:47]
    ds_read_b64_tr_b16 v[112:113], v11 offset:47104
    ds_read_b64_tr_b16 v[114:115], v11 offset:47616
    buffer_load_dwordx4 v20, s[16:19], s47 offen offset:2048 lds
    v_fmac_f32 v93, v93, v139
    v_cvt_pk_bf16_f32 v206, v92, v93
    v_fma_f32 v129, v128, -0.5, -1.0
    v_mfma_f32_32x32x16_bf16 v[48:63], v[116:119], v[236:239], v[48:63]
    v_fma_f32 v131, v130, -0.5, -1.0
    v_fma_f32 v129, v128, v129, -1.0
    v_fma_f32 v131, v130, v131, -1.0
    v_rcp_f32 v129, v129
    v_mfma_f32_32x32x16_bf16 v[32:47], v[120:123], a[128:131], v[32:47]
    s_waitcnt vmcnt(20)
    s_barrier
    s_waitcnt lgkmcnt(2)
    ds_read_b64_tr_b16 a[208:209], v28 offset:0
    ds_read_b64_tr_b16 a[210:211], v28 offset:3072
    ds_read_b64_tr_b16 a[212:213], v29 offset:64
    ds_read_b64_tr_b16 a[214:215], v29 offset:3136
    v_mfma_f32_32x32x16_bf16 v[48:63], v[120:123], v[240:243], v[48:63]
    v_fmac_f32 v94, v94, v129
    v_rcp_f32 v131, v131
    v_mfma_f32_32x32x16_bf16 v[32:47], v[124:127], a[132:135], v[32:47]
    ds_read_b64_tr_b16 a[216:217], v28 offset:128
    ds_read_b64_tr_b16 a[218:219], v28 offset:3200
    ds_read_b64_tr_b16 a[220:221], v29 offset:192
    ds_read_b64_tr_b16 a[222:223], v29 offset:3264
    buffer_load_dwordx4 v21, s[16:19], s47 offen offset:3072 lds
    s_add_u32 m0, s3, 4096
    v_mfma_f32_32x32x16_bf16 v[48:63], v[124:127], v[244:247], v[48:63]
    v_fmac_f32 v95, v95, v131
    v_cvt_pk_bf16_f32 v207, v94, v95
    v_mfma_f32_32x32x16_bf16 v[32:47], v[140:143], a[136:139], v[32:47]
    s_waitcnt lgkmcnt(8)
    ds_read_b64_tr_b16 a[224:225], v28 offset:256
    ds_read_b64_tr_b16 a[226:227], v28 offset:3328
    ds_read_b64_tr_b16 a[228:229], v29 offset:320
    ds_read_b64_tr_b16 a[230:231], v29 offset:3392
    v_mfma_f32_32x32x16_bf16 v[48:63], v[140:143], v[248:251], v[48:63]
    v_mfma_f32_32x32x16_bf16 v[64:79], v[112:115], a[140:143], v[32:47]
    ds_read_b64_tr_b16 a[232:233], v28 offset:6144
    ds_read_b64_tr_b16 a[234:235], v28 offset:9216
    buffer_load_dwordx4 v22, s[16:19], s47 offen offset:0 lds
    v_mfma_f32_32x32x16_bf16 v[80:95], v[112:115], v[252:255], v[48:63]
    s_bitcmp1_b32 s36, 0
    s_cbranch_scc1 L_ex_18
    ds_write_b128 v15, v[200:203] offset:0
    ds_write_b128 v15, v[204:207] offset:1024
    s_branch L_exe_19
L_ex_18:
    ds_write_b128 v15, v[192:195] offset:0
    ds_write_b128 v15, v[196:199] offset:1024
L_exe_19:
    s_waitcnt lgkmcnt(12)
    v_mfma_f32_32x32x16_bf16 v[32:47], a[208:211], v[144:147], 0
    s_waitcnt lgkmcnt(8)
    ds_read_b64_tr_b16 a[236:237], v29 offset:6208
    ds_read_b64_tr_b16 a[238:239], v29 offset:9280
    v_mul_f32 v128, s49, v64
    v_mul_f32 v130, s49, v65
    v_exp_f32 v128, v128
    v_mfma_f32_32x32x16_bf16 v[48:63], a[212:215], v[144:147], 0
    ds_read_b64_tr_b16 a[240:241], v28 offset:6272
    ds_read_b64_tr_b16 a[242:243], v28 offset:9344
    buffer_load_dwordx4 v23, s[16:19], s47 offen offset:1024 lds
    v_fma_f32 v129, v128, -0.5, -1.0
    v_fma_f32 v129, v128, v129, -1.0
    v_exp_f32 v130, v130
    v_mfma_f32_32x32x16_bf16 v[96:111], a[216:219], v[144:147], 0
    ds_read_b64_tr_b16 a[244:245], v29 offset:6336
    ds_read_b64_tr_b16 a[246:247], v29 offset:9408
    s_lshl_b32 s85, s36, 8
    s_add_u32 m0, s85, 157696
    s_and_b32 s85, s42, 0xffffff80
    s_add_u32 s85, s85, 0
    buffer_load_dword v2, s[12:15], s85 offen sc1 lds
    v_mfma_f32_32x32x16_bf16 v[112:127], a[220:223], v[144:147], 0
    s_waitcnt lgkmcnt(8)
    ds_read_b64_tr_b16 a[248:249], v28 offset:6400
    ds_read_b64_tr_b16 a[250:251], v28 offset:9472
    s_add_u32 m0, s3, 24576
    s_add_u32 s47, s66, 0
    buffer_load_dwordx4 v18, s[16:19], s47 offen offset:0 lds
    v_fma_f32 v131, v130, -0.5, -1.0
    v_mfma_f32_32x32x16_bf16 v[224:239], a[224:227], v[144:147], 0
    ds_read_b64_tr_b16 a[252:253], v29 offset:6464
    ds_read_b64_tr_b16 a[254:255], v29 offset:9536
    buffer_load_dwordx4 v19, s[16:19], s47 offen offset:1024 lds
    v_fma_f32 v131, v130, v131, -1.0
    v_mul_f32 v132, s49, v66
    v_rcp_f32 v129, v129
    v_mfma_f32_32x32x16_bf16 v[240:255], a[228:231], v[144:147], 0
    ds_read_b64_tr_b16 a[208:209], v28 offset:12288
    ds_read_b64_tr_b16 a[210:211], v28 offset:15360
    buffer_load_dwordx4 v20, s[16:19], s47 offen offset:2048 lds
    v_rcp_f32 v131, v131
    v_exp_f32 v132, v132
    v_mfma_f32_32x32x16_bf16 v[32:47], a[232:235], v[148:151], v[32:47]
    s_waitcnt lgkmcnt(6)
    ds_read_b64_tr_b16 a[212:213], v29 offset:12352
    ds_read_b64_tr_b16 a[214:215], v29 offset:15424
    buffer_load_dwordx4 v21, s[16:19], s47 offen offset:3072 lds
    s_add_u32 m0, s3, 28672
    v_fmac_f32 v64, v64, v129
    v_fmac_f32 v65, v65, v131
    v_mfma_f32_32x32x16_bf16 v[48:63], a[236:239], v[148:151], v[48:63]
    ds_read_b64_tr_b16 a[216:217], v28 offset:12416
    ds_read_b64_tr_b16 a[218:219], v28 offset:15488
    buffer_load_dwordx4 v22, s[16:19], s47 offen offset:0 lds
    v_cvt_pk_bf16_f32 v208, v64, v65
    v_mul_f32 v134, s49, v67
    v_exp_f32 v134, v134
    v_mfma_f32_32x32x16_bf16 v[96:111], a[240:243], v[148:151], v[96:111]
    ds_read_b64_tr_b16 a[220:221], v29 offset:12480
    ds_read_b64_tr_b16 a[222:223], v29 offset:15552
    v_fma_f32 v133, v132, -0.5, -1.0
    v_fma_f32 v135, v134, -0.5, -1.0
    v_fma_f32 v133, v132, v133, -1.0
    v_rcp_f32 v133, v133
    v_mfma_f32_32x32x16_bf16 v[112:127], a[244:247], v[148:151], v[112:127]
    s_waitcnt lgkmcnt(6)
    ds_read_b64_tr_b16 a[224:225], v28 offset:12544
    ds_read_b64_tr_b16 a[226:227], v28 offset:15616
    v_fma_f32 v135, v134, v135, -1.0
    v_rcp_f32 v135, v135
    v_mfma_f32_32x32x16_bf16 v[224:239], a[248:251], v[148:151], v[224:239]
    ds_read_b64_tr_b16 a[228:229], v29 offset:12608
    ds_read_b64_tr_b16 a[230:231], v29 offset:15680
    buffer_load_dwordx4 v23, s[16:19], s47 offen offset:1024 lds
    s_add_u32 s45, s70, 0
    v_fmac_f32 v66, v66, v133
    v_fmac_f32 v67, v67, v135
    v_mfma_f32_32x32x16_bf16 v[240:255], a[252:255], v[148:151], v[240:255]
    ds_read_b64_tr_b16 a[232:233], v28 offset:18432
    ds_read_b64_tr_b16 a[234:235], v28 offset:21504
    buffer_load_dwordx4 a[0:3], v17, s[12:15], s45 offen offset:0 sc1
    v_cvt_pk_bf16_f32 v209, v66, v67
    v_mul_f32 v136, s49, v68
    v_mul_f32 v138, s49, v69
    v_mfma_f32_32x32x16_bf16 v[32:47], a[208:211], v[152:155], v[32:47]
    s_waitcnt lgkmcnt(6)
    ds_read_b64_tr_b16 a[236:237], v29 offset:18496
    ds_read_b64_tr_b16 a[238:239], v29 offset:21568
    v_mul_f32 v128, s49, v70
    v_exp_f32 v136, v136
    v_mfma_f32_32x32x16_bf16 v[48:63], a[212:215], v[152:155], v[48:63]
    ds_read_b64_tr_b16 a[240:241], v28 offset:18560
    ds_read_b64_tr_b16 a[242:243], v28 offset:21632
    buffer_load_dwordx4 a[4:7], v17, s[12:15], s45 offen offset:1024 sc1
    v_fma_f32 v137, v136, -0.5, -1.0
    v_exp_f32 v138, v138
    v_mfma_f32_32x32x16_bf16 v[96:111], a[216:219], v[152:155], v[96:111]
    ds_read_b64_tr_b16 a[244:245], v29 offset:18624
    ds_read_b64_tr_b16 a[246:247], v29 offset:21696
    v_fma_f32 v139, v138, -0.5, -1.0
    v_fma_f32 v137, v136, v137, -1.0
    v_rcp_f32 v137, v137
    v_mfma_f32_32x32x16_bf16 v[112:127], a[220:223], v[152:155], v[112:127]
    s_waitcnt lgkmcnt(6)
    ds_read_b64_tr_b16 a[248:249], v28 offset:18688
    ds_read_b64_tr_b16 a[250:251], v28 offset:21760
    v_fma_f32 v139, v138, v139, -1.0
    v_rcp_f32 v139, v139
    v_mfma_f32_32x32x16_bf16 v[224:239], a[224:227], v[152:155], v[224:239]
    ds_read_b64_tr_b16 a[252:253], v29 offset:18752
    ds_read_b64_tr_b16 a[254:255], v29 offset:21824
    buffer_load_dwordx4 a[8:11], v17, s[12:15], s45 offen offset:2048 sc1
    v_fmac_f32 v68, v68, v137
    v_exp_f32 v128, v128
    v_mfma_f32_32x32x16_bf16 v[240:255], a[228:231], v[152:155], v[240:255]
    s_waitcnt vmcnt(25)
    s_barrier
    ds_read_b64_tr_b16 a[208:209], v28 offset:24576
    ds_read_b64_tr_b16 a[210:211], v28 offset:27648
    s_bitcmp1_b32 s36, 0
    s_cbranch_scc1 L_ex_20
    ds_read_b128 v[200:203], v16 offset:0
    ds_read_b128 v[204:207], v16 offset:1024
    s_branch L_exe_21
L_ex_20:
    ds_read_b128 v[192:195], v16 offset:0
    ds_read_b128 v[196:199], v16 offset:1024
L_exe_21:
    v_mfma_f32_32x32x16_bf16 v[32:47], a[232:235], v[156:159], v[32:47]
    s_waitcnt lgkmcnt(8)
    ds_read_b64_tr_b16 a[212:213], v29 offset:24640
    ds_read_b64_tr_b16 a[214:215], v29 offset:27712
    v_fmac_f32 v69, v69, v139
    v_cvt_pk_bf16_f32 v210, v68, v69
    v_mul_f32 v130, s49, v71
    v_mfma_f32_32x32x16_bf16 v[48:63], a[236:239], v[156:159], v[48:63]
    ds_read_b64_tr_b16 a[216:217], v28 offset:24704
    ds_read_b64_tr_b16 a[218:219], v28 offset:27776
    buffer_load_dwordx4 a[12:15], v17, s[12:15], s45 offen offset:3072 sc1
    s_add_u32 m0, s3, 73728
    s_add_u32 s47, s66, 368640
    v_fma_f32 v129, v128, -0.5, -1.0
    v_mfma_f32_32x32x16_bf16 v[96:111], a[240:243], v[156:159], v[96:111]
    ds_read_b64_tr_b16 a[220:221], v29 offset:24768
    ds_read_b64_tr_b16 a[222:223], v29 offset:27840
    v_fma_f32 v129, v128, v129, -1.0
    v_exp_f32 v130, v130
    v_rcp_f32 v129, v129
    v_mfma_f32_32x32x16_bf16 v[112:127], a[244:247], v[156:159], v[112:127]
    s_waitcnt lgkmcnt(6)
    ds_read_b64_tr_b16 a[224:225], v28 offset:24832
    ds_read_b64_tr_b16 a[226:227], v28 offset:27904
    buffer_store_dwordx4 v[192:195], v17, s[12:15], s48 offen offset:0 sc1
    v_fma_f32 v131, v130, -0.5, -1.0
    v_fma_f32 v131, v130, v131, -1.0
    v_mfma_f32_32x32x16_bf16 v[224:239], a[248:251], v[156:159], v[224:239]
    ds_read_b64_tr_b16 a[228:229], v29 offset:24896
    ds_read_b64_tr_b16 a[230:231], v29 offset:27968
    buffer_load_dwordx4 v18, s[16:19], s47 offen offset:0 lds
    v_fmac_f32 v70, v70, v129
    v_rcp_f32 v131, v131
    v_mfma_f32_32x32x16_bf16 v[240:255], a[252:255], v[156:159], v[240:255]
    ds_read_b64_tr_b16 a[232:233], v28 offset:30720
    ds_read_b64_tr_b16 a[234:235], v28 offset:33792
    buffer_load_dwordx4 v19, s[16:19], s47 offen offset:1024 lds
    v_fmac_f32 v71, v71, v131
    v_cvt_pk_bf16_f32 v211, v70, v71
    v_mul_f32 v132, s49, v72
    v_mfma_f32_32x32x16_bf16 v[32:47], a[208:211], v[160:163], v[32:47]
    s_waitcnt lgkmcnt(6)
    ds_read_b64_tr_b16 a[236:237], v29 offset:30784
    ds_read_b64_tr_b16 a[238:239], v29 offset:33856
    v_mul_f32 v134, s49, v73
    v_exp_f32 v132, v132
    v_mfma_f32_32x32x16_bf16 v[48:63], a[212:215], v[160:163], v[48:63]
    ds_read_b64_tr_b16 a[240:241], v28 offset:30848
    ds_read_b64_tr_b16 a[242:243], v28 offset:33920
    buffer_load_dwordx4 v20, s[16:19], s47 offen offset:2048 lds
    v_fma_f32 v133, v132, -0.5, -1.0
    v_exp_f32 v134, v134
    v_mfma_f32_32x32x16_bf16 v[96:111], a[216:219], v[160:163], v[96:111]
    ds_read_b64_tr_b16 a[244:245], v29 offset:30912
    ds_read_b64_tr_b16 a[246:247], v29 offset:33984
    v_fma_f32 v135, v134, -0.5, -1.0
    v_fma_f32 v133, v132, v133, -1.0
    v_rcp_f32 v133, v133
    v_mfma_f32_32x32x16_bf16 v[112:127], a[220:223], v[160:163], v[112:127]
    s_waitcnt lgkmcnt(6)
    ds_read_b64_tr_b16 a[248:249], v28 offset:30976
    ds_read_b64_tr_b16 a[250:251], v28 offset:34048
    v_fma_f32 v135, v134, v135, -1.0
    v_rcp_f32 v135, v135
    v_mfma_f32_32x32x16_bf16 v[224:239], a[224:227], v[160:163], v[224:239]
    ds_read_b64_tr_b16 a[252:253], v29 offset:31040
    ds_read_b64_tr_b16 a[254:255], v29 offset:34112
    buffer_load_dwordx4 v21, s[16:19], s47 offen offset:3072 lds
    s_add_u32 m0, s3, 77824
    v_fmac_f32 v72, v72, v133
    v_fmac_f32 v73, v73, v135
    v_mfma_f32_32x32x16_bf16 v[240:255], a[228:231], v[160:163], v[240:255]
    ds_read_b64_tr_b16 a[208:209], v28 offset:36864
    ds_read_b64_tr_b16 a[210:211], v28 offset:39936
    v_cvt_pk_bf16_f32 v212, v72, v73
    v_mul_f32 v136, s49, v74
    v_exp_f32 v136, v136
    v_mfma_f32_32x32x16_bf16 v[32:47], a[232:235], v[164:167], v[32:47]
    s_waitcnt lgkmcnt(6)
    ds_read_b64_tr_b16 a[212:213], v29 offset:36928
    ds_read_b64_tr_b16 a[214:215], v29 offset:40000
    v_mul_f32 v138, s49, v75
    v_exp_f32 v138, v138
    v_mfma_f32_32x32x16_bf16 v[48:63], a[236:239], v[164:167], v[48:63]
    ds_read_b64_tr_b16 a[216:217], v28 offset:36992
    ds_read_b64_tr_b16 a[218:219], v28 offset:40064
    buffer_load_dwordx4 v22, s[16:19], s47 offen offset:0 lds
    v_fma_f32 v137, v136, -0.5, -1.0
    v_fma_f32 v139, v138, -0.5, -1.0
    v_fma_f32 v137, v136, v137, -1.0
    v_mfma_f32_32x32x16_bf16 v[96:111], a[240:243], v[164:167], v[96:111]
    ds_read_b64_tr_b16 a[220:221], v29 offset:37056
    ds_read_b64_tr_b16 a[222:223], v29 offset:40128
    v_fma_f32 v139, v138, v139, -1.0
    v_mul_f32 v128, s49, v76
    v_rcp_f32 v137, v137
    v_mfma_f32_32x32x16_bf16 v[112:127], a[244:247], v[164:167], v[112:127]
    s_waitcnt lgkmcnt(6)
    ds_read_b64_tr_b16 a[224:225], v28 offset:37120
    ds_read_b64_tr_b16 a[226:227], v28 offset:40192
    buffer_store_dwordx4 v[196:199], v17, s[12:15], s48 offen offset:1024 sc1
    v_rcp_f32 v139, v139
    v_mfma_f32_32x32x16_bf16 v[224:239], a[248:251], v[164:167], v[224:239]
    ds_read_b64_tr_b16 a[228:229], v29 offset:37184
    ds_read_b64_tr_b16 a[230:231], v29 offset:40256
    buffer_load_dwordx4 v23, s[16:19], s47 offen offset:1024 lds
    v_fmac_f32 v74, v74, v137
    v_exp_f32 v128, v128
    v_mfma_f32_32x32x16_bf16 v[240:255], a[252:255], v[164:167], v[240:255]
    ds_read_b64_tr_b16 a[232:233], v28 offset:43008
    ds_read_b64_tr_b16 a[234:235], v28 offset:46080
    v_fmac_f32 v75, v75, v139
    v_cvt_pk_bf16_f32 v213, v74, v75
    v_mul_f32 v130, s49, v77
    v_fma_f32 v129, v128, -0.5, -1.0
    v_mfma_f32_32x32x16_bf16 v[32:47], a[208:211], v[168:171], v[32:47]
    s_waitcnt lgkmcnt(6)
    ds_read_b64_tr_b16 a[236:237], v29 offset:43072
    ds_read_b64_tr_b16 a[238:239], v29 offset:46144
    v_fma_f32 v129, v128, v129, -1.0
    v_exp_f32 v130, v130
    v_mfma_f32_32x32x16_bf16 v[48:63], a[212:215], v[168:171], v[48:63]
    ds_read_b64_tr_b16 a[240:241], v28 offset:43136
    ds_read_b64_tr_b16 a[242:243], v28 offset:46208
    ds_read_b32 v6, v3
    v_fma_f32 v131, v130, -0.5, -1.0
    v_rcp_f32 v129, v129
    v_mfma_f32_32x32x16_bf16 v[96:111], a[216:219], v[168:171], v[96:111]
    ds_read_b64_tr_b16 a[244:245], v29 offset:43200
    ds_read_b64_tr_b16 a[246:247], v29 offset:46272
    v_fma_f32 v131, v130, v131, -1.0
    v_fmac_f32 v76, v76, v129
    v_rcp_f32 v131, v131
    v_mfma_f32_32x32x16_bf16 v[112:127], a[220:223], v[168:171], v[112:127]
    s_waitcnt lgkmcnt(7)
    ds_read_b64_tr_b16 a[248:249], v28 offset:43264
    ds_read_b64_tr_b16 a[250:251], v28 offset:46336
    v_fmac_f32 v77, v77, v131
    v_cvt_pk_bf16_f32 v214, v76, v77
    v_mul_f32 v132, s49, v78
    v_mfma_f32_32x32x16_bf16 v[224:239], a[224:227], v[168:171], v[224:239]
    ds_read_b64_tr_b16 a[252:253], v29 offset:43328
    ds_read_b64_tr_b16 a[254:255], v29 offset:46400
    v_mul_f32 v134, s49, v79
    v_mul_f32 v136, s49, v80
    v_exp_f32 v132, v132
    v_mfma_f32_32x32x16_bf16 v[240:255], a[228:231], v[168:171], v[240:255]
    s_waitcnt vmcnt(26)
    s_barrier
    s_waitcnt lgkmcnt(6)
    v_readlane_b32 s85, v6, s79
    s_movk_i32 s83, 0
    s_mov_b32 s84, s79
    s_cmp_eq_u32 s85, 1
    s_cbranch_scc1 L_chk_22
    s_call_b64 s[54:55], L_poll
L_chk_22:
    v_readlane_b32 s85, v6, s80
    s_movk_i32 s83, 0
    s_mov_b32 s84, s80
    s_cmp_eq_u32 s85, 1
    s_cbranch_scc1 L_chk_23
    s_call_b64 s[54:55], L_poll
L_chk_23:
    ds_read_b64_tr_b16 a[208:209], v26 offset:0
    ds_read_b64_tr_b16 a[210:211], v26 offset:3072
    v_mfma_f32_32x32x16_bf16 v[32:47], a[232:235], v[172:175], v[32:47]
    s_waitcnt lgkmcnt(6)
    ds_read_b64_tr_b16 a[212:213], v27 offset:64
    ds_read_b64_tr_b16 a[214:215], v27 offset:3136
    s_add_u32 m0, s3, 98304
    s_add_u32 s47, s67, 0
    v_fma_f32 v133, v132, -0.5, -1.0
    v_mfma_f32_32x32x16_bf16 v[48:63], a[236:239], v[172:175], v[48:63]
    ds_read_b64_tr_b16 a[216:217], v26 offset:128
    ds_read_b64_tr_b16 a[218:219], v26 offset:3200
    buffer_load_dwordx4 v18, s[16:19], s47 offen offset:0 lds
    v_fma_f32 v133, v132, v133, -1.0
    v_exp_f32 v134, v134
    v_mfma_f32_32x32x16_bf16 v[96:111], a[240:243], v[172:175], v[96:111]
    ds_read_b64_tr_b16 a[220:221], v27 offset:192
    ds_read_b64_tr_b16 a[222:223], v27 offset:3264
    v_rcp_f32 v133, v133
    v_exp_f32 v136, v136
    v_mfma_f32_32x32x16_bf16 v[112:127], a[244:247], v[172:175], v[112:127]
    s_waitcnt lgkmcnt(6)
    ds_read_b64_tr_b16 a[224:225], v26 offset:256
    ds_read_b64_tr_b16 a[226:227], v26 offset:3328
    buffer_store_dwordx4 v[200:203], v17, s[12:15], s48 offen offset:2048 sc1
    v_fma_f32 v135, v134, -0.5, -1.0
    v_fma_f32 v135, v134, v135, -1.0
    v_mfma_f32_32x32x16_bf16 v[224:239], a[248:251], v[172:175], v[224:239]
    ds_read_b64_tr_b16 a[228:229], v27 offset:320
    ds_read_b64_tr_b16 a[230:231], v27 offset:3392
    buffer_load_dwordx4 v19, s[16:19], s47 offen offset:1024 lds
    v_fmac_f32 v78, v78, v133
    v_rcp_f32 v135, v135
    v_mfma_f32_32x32x16_bf16 v[240:255], a[252:255], v[172:175], v[240:255]
    ds_read_b64_tr_b16 a[232:233], v26 offset:6144
    ds_read_b64_tr_b16 a[234:235], v26 offset:9216
    buffer_load_dwordx4 v20, s[16:19], s47 offen offset:2048 lds
    v_fmac_f32 v79, v79, v135
    v_cvt_pk_bf16_f32 v215, v78, v79
    v_mul_f32 v138, s49, v81
    v_mfma_f32_32x32x16_bf16 v[32:47], a[208:211], v[176:179], v[32:47]
    s_waitcnt lgkmcnt(6)
    ds_read_b64_tr_b16 a[236:237], v27 offset:6208
    ds_read_b64_tr_b16 a[238:239], v27 offset:9280
    v_fma_f32 v137, v136, -0.5, -1.0
    v_exp_f32 v138, v138
    v_mfma_f32_32x32x16_bf16 v[48:63], a[212:215], v[176:179], v[48:63]
    ds_read_b64_tr_b16 a[240:241], v26 offset:6272
    ds_read_b64_tr_b16 a[242:243], v26 offset:9344
    buffer_load_dwordx4 v21, s[16:19], s47 offen offset:3072 lds
    s_add_u32 m0, s3, 102400
    v_fma_f32 v139, v138, -0.5, -1.0
    v_fma_f32 v137, v136, v137, -1.0
    v_mfma_f32_32x32x16_bf16 v[96:111], a[216:219], v[176:179], v[96:111]
    ds_read_b64_tr_b16 a[244:245], v27 offset:6336
    ds_read_b64_tr_b16 a[246:247], v27 offset:9408
    v_fma_f32 v139, v138, v139, -1.0
    v_mul_f32 v128, s49, v82
    v_rcp_f32 v137, v137
    v_mfma_f32_32x32x16_bf16 v[112:127], a[220:223], v[176:179], v[112:127]
    s_waitcnt lgkmcnt(6)
    ds_read_b64_tr_b16 a[248:249], v26 offset:6400
    ds_read_b64_tr_b16 a[250:251], v26 offset:9472
    v_fmac_f32 v80, v80, v137
    v_rcp_f32 v139, v139
    v_mfma_f32_32x32x16_bf16 v[224:239], a[224:227], v[176:179], v[224:239]
    ds_read_b64_tr_b16 a[252:253], v27 offset:6464
    ds_read_b64_tr_b16 a[254:255], v27 offset:9536
    buffer_load_dwordx4 v22, s[16:19], s47 offen offset:0 lds
    v_fmac_f32 v81, v81, v139
    v_exp_f32 v128, v128
    v_mfma_f32_32x32x16_bf16 v[240:255], a[228:231], v[176:179], v[240:255]
    ds_read_b64_tr_b16 a[208:209], v26 offset:12288
    ds_read_b64_tr_b16 a[210:211], v26 offset:15360
    v_cvt_pk_bf16_f32 v216, v80, v81
    v_mul_f32 v130, s49, v83
    v_exp_f32 v130, v130
    v_mfma_f32_32x32x16_bf16 v[32:47], a[232:235], v[180:183], v[32:47]
    s_waitcnt lgkmcnt(6)
    ds_read_b64_tr_b16 a[212:213], v27 offset:12352
    ds_read_b64_tr_b16 a[214:215], v27 offset:15424
    v_fma_f32 v129, v128, -0.5, -1.0
    v_fma_f32 v131, v130, -0.5, -1.0
    v_fma_f32 v129, v128, v129, -1.0
    v_mfma_f32_32x32x16_bf16 v[48:63], a[236:239], v[180:183], v[48:63]
    ds_read_b64_tr_b16 a[216:217], v26 offset:12416
    ds_read_b64_tr_b16 a[218:219], v26 offset:15488
    buffer_load_dwordx4 v23, s[16:19], s47 offen offset:1024 lds
    s_add_u32 s45, s71, 0
    v_rcp_f32 v129, v129
    v_mfma_f32_32x32x16_bf16 v[96:111], a[240:243], v[180:183], v[96:111]
    ds_read_b64_tr_b16 a[220:221], v27 offset:12480
    ds_read_b64_tr_b16 a[222:223], v27 offset:15552
    v_fma_f32 v131, v130, v131, -1.0
    v_fmac_f32 v82, v82, v129
    v_rcp_f32 v131, v131
    v_mfma_f32_32x32x16_bf16 v[112:127], a[244:247], v[180:183], v[112:127]
    s_waitcnt lgkmcnt(6)
    ds_read_b64_tr_b16 a[224:225], v26 offset:12544
    ds_read_b64_tr_b16 a[226:227], v26 offset:15616
    buffer_store_dwordx4 v[204:207], v17, s[12:15], s48 offen offset:3072 sc1
    s_add_u32 s48, s48, 4096
    v_fmac_f32 v83, v83, v131
    v_mfma_f32_32x32x16_bf16 v[224:239], a[248:251], v[180:183], v[224:239]
    ds_read_b64_tr_b16 a[228:229], v27 offset:12608
    ds_read_b64_tr_b16 a[230:231], v27 offset:15680
    buffer_load_dwordx4 a[16:19], v17, s[12:15], s45 offen offset:0 sc1
    v_cvt_pk_bf16_f32 v217, v82, v83
    v_mul_f32 v132, s49, v84
    v_mul_f32 v134, s49, v85
    v_mfma_f32_32x32x16_bf16 v[240:255], a[252:255], v[180:183], v[240:255]
    ds_read_b64_tr_b16 a[232:233], v26 offset:18432
    ds_read_b64_tr_b16 a[234:235], v26 offset:21504
    buffer_load_dwordx4 a[20:23], v17, s[12:15], s45 offen offset:1024 sc1
    v_mul_f32 v136, s49, v86
    v_exp_f32 v132, v132
    v_mfma_f32_32x32x16_bf16 v[32:47], a[208:211], v[184:187], v[32:47]
    s_waitcnt lgkmcnt(6)
    ds_read_b64_tr_b16 a[236:237], v27 offset:18496
    ds_read_b64_tr_b16 a[238:239], v27 offset:21568
    v_fma_f32 v133, v132, -0.5, -1.0
    v_exp_f32 v134, v134
    v_mfma_f32_32x32x16_bf16 v[48:63], a[212:215], v[184:187], v[48:63]
    ds_read_b64_tr_b16 a[240:241], v26 offset:18560
    ds_read_b64_tr_b16 a[242:243], v26 offset:21632
    buffer_load_dwordx4 a[24:27], v17, s[12:15], s45 offen offset:2048 sc1
    v_fma_f32 v135, v134, -0.5, -1.0
    v_exp_f32 v136, v136
    v_mfma_f32_32x32x16_bf16 v[96:111], a[216:219], v[184:187], v[96:111]
    ds_read_b64_tr_b16 a[244:245], v27 offset:18624
    ds_read_b64_tr_b16 a[246:247], v27 offset:21696
    v_fma_f32 v133, v132, v133, -1.0
    v_fma_f32 v135, v134, v135, -1.0
    v_rcp_f32 v133, v133
    v_mfma_f32_32x32x16_bf16 v[112:127], a[220:223], v[184:187], v[112:127]
    s_waitcnt lgkmcnt(6)
    ds_read_b64_tr_b16 a[248:249], v26 offset:18688
    ds_read_b64_tr_b16 a[250:251], v26 offset:21760
    v_fmac_f32 v84, v84, v133
    v_rcp_f32 v135, v135
    v_mfma_f32_32x32x16_bf16 v[224:239], a[224:227], v[184:187], v[224:239]
    ds_read_b64_tr_b16 a[252:253], v27 offset:18752
    ds_read_b64_tr_b16 a[254:255], v27 offset:21824
    buffer_load_dwordx4 a[28:31], v17, s[12:15], s45 offen offset:3072 sc1
    v_fmac_f32 v85, v85, v135
    v_cvt_pk_bf16_f32 v218, v84, v85
    v_mul_f32 v138, s49, v87
    v_mfma_f32_32x32x16_bf16 v[240:255], a[228:231], v[184:187], v[240:255]
    s_waitcnt vmcnt(31)
    s_barrier
    ds_read_b64_tr_b16 a[208:209], v24 offset:0
    ds_read_b64_tr_b16 a[210:211], v24 offset:3072
    s_add_u32 m0, s3, 122880
    s_add_u32 s47, s67, 73728
    v_mfma_f32_32x32x16_bf16 v[32:47], a[232:235], v[188:191], v[32:47]
    s_waitcnt lgkmcnt(6)
    ds_read_b64_tr_b16 a[212:213], v25 offset:64
    ds_read_b64_tr_b16 a[214:215], v25 offset:3136
    v_fma_f32 v137, v136, -0.5, -1.0
    v_exp_f32 v138, v138
    v_mfma_f32_32x32x16_bf16 v[48:63], a[236:239], v[188:191], v[48:63]
    ds_read_b64_tr_b16 a[216:217], v24 offset:128
    ds_read_b64_tr_b16 a[218:219], v24 offset:3200
    buffer_load_dwordx4 v18, s[16:19], s47 offen offset:0 lds
    v_fma_f32 v139, v138, -0.5, -1.0
    v_fma_f32 v137, v136, v137, -1.0
    v_fma_f32 v139, v138, v139, -1.0
    v_mfma_f32_32x32x16_bf16 v[96:111], a[240:243], v[188:191], v[96:111]
    ds_read_b64_tr_b16 a[220:221], v25 offset:192
    ds_read_b64_tr_b16 a[222:223], v25 offset:3264
    v_rcp_f32 v137, v137
    v_rcp_f32 v139, v139
    v_mfma_f32_32x32x16_bf16 v[112:127], a[244:247], v[188:191], v[112:127]
    s_waitcnt lgkmcnt(6)
    ds_read_b64_tr_b16 a[224:225], v24 offset:256
    ds_read_b64_tr_b16 a[226:227], v24 offset:3328
    v_fmac_f32 v86, v86, v137
    v_fmac_f32 v87, v87, v139
    v_cvt_pk_bf16_f32 v219, v86, v87
    v_mfma_f32_32x32x16_bf16 v[224:239], a[248:251], v[188:191], v[224:239]
    ds_read_b64_tr_b16 a[228:229], v25 offset:320
    ds_read_b64_tr_b16 a[230:231], v25 offset:3392
    buffer_load_dwordx4 v19, s[16:19], s47 offen offset:1024 lds
    v_mul_f32 v128, s49, v88
    v_exp_f32 v128, v128
    v_mfma_f32_32x32x16_bf16 v[240:255], a[252:255], v[188:191], v[240:255]
    ds_read_b64_tr_b16 a[232:233], v24 offset:6144
    ds_read_b64_tr_b16 a[234:235], v24 offset:9216
    buffer_load_dwordx4 v20, s[16:19], s47 offen offset:2048 lds
    v_mul_f32 v130, s49, v89
    v_exp_f32 v130, v130
    v_mfma_f32_32x32x16_bf16 v[32:47], a[208:211], v[192:195], v[32:47]
    s_waitcnt lgkmcnt(6)
    ds_read_b64_tr_b16 a[236:237], v25 offset:6208
    ds_read_b64_tr_b16 a[238:239], v25 offset:9280
    v_fma_f32 v129, v128, -0.5, -1.0
    v_fma_f32 v131, v130, -0.5, -1.0
    v_fma_f32 v129, v128, v129, -1.0
    v_mfma_f32_32x32x16_bf16 v[48:63], a[212:215], v[192:195], v[48:63]
    ds_read_b64_tr_b16 a[240:241], v24 offset:6272
    ds_read_b64_tr_b16 a[242:243], v24 offset:9344
    buffer_load_dwordx4 v21, s[16:19], s47 offen offset:3072 lds
    s_add_u32 m0, s3, 126976
    v_rcp_f32 v129, v129
    v_mfma_f32_32x32x16_bf16 v[96:111], a[216:219], v[192:195], v[96:111]
    ds_read_b64_tr_b16 a[244:245], v25 offset:6336
    ds_read_b64_tr_b16 a[246:247], v25 offset:9408
    v_fma_f32 v131, v130, v131, -1.0
    v_fmac_f32 v88, v88, v129
    v_rcp_f32 v131, v131
    v_mfma_f32_32x32x16_bf16 v[112:127], a[220:223], v[192:195], v[112:127]
    s_waitcnt lgkmcnt(6)
    ds_read_b64_tr_b16 a[248:249], v24 offset:6400
    ds_read_b64_tr_b16 a[250:251], v24 offset:9472
    v_fmac_f32 v89, v89, v131
    v_cvt_pk_bf16_f32 v220, v88, v89
    v_mul_f32 v132, s49, v90
    v_mfma_f32_32x32x16_bf16 v[224:239], a[224:227], v[192:195], v[224:239]
    ds_read_b64_tr_b16 a[252:253], v25 offset:6464
    ds_read_b64_tr_b16 a[254:255], v25 offset:9536
    buffer_load_dwordx4 v22, s[16:19], s47 offen offset:0 lds
    v_mul_f32 v134, s49, v91
    v_exp_f32 v132, v132
    v_mfma_f32_32x32x16_bf16 v[240:255], a[228:231], v[192:195], v[240:255]
    ds_read_b64_tr_b16 a[208:209], v24 offset:12288
    ds_read_b64_tr_b16 a[210:211], v24 offset:15360
    v_fma_f32 v133, v132, -0.5, -1.0
    v_fma_f32 v133, v132, v133, -1.0
    v_exp_f32 v134, v134
    v_mfma_f32_32x32x16_bf16 v[32:47], a[232:235], v[196:199], v[32:47]
    s_waitcnt lgkmcnt(6)
    ds_read_b64_tr_b16 a[212:213], v25 offset:12352
    ds_read_b64_tr_b16 a[214:215], v25 offset:15424
    v_fma_f32 v135, v134, -0.5, -1.0
    v_rcp_f32 v133, v133
    v_mfma_f32_32x32x16_bf16 v[48:63], a[236:239], v[196:199], v[48:63]
    ds_read_b64_tr_b16 a[216:217], v24 offset:12416
    ds_read_b64_tr_b16 a[218:219], v24 offset:15488
    buffer_load_dwordx4 v23, s[16:19], s47 offen offset:1024 lds
    s_add_u32 s45, s71, 4096
    v_fma_f32 v135, v134, v135, -1.0
    v_fmac_f32 v90, v90, v133
    v_mfma_f32_32x32x16_bf16 v[96:111], a[240:243], v[196:199], v[96:111]
    ds_read_b64_tr_b16 a[220:221], v25 offset:12480
    ds_read_b64_tr_b16 a[222:223], v25 offset:15552
    v_mul_f32 v136, s49, v92
    v_mul_f32 v138, s49, v93
    v_rcp_f32 v135, v135
    v_mfma_f32_32x32x16_bf16 v[112:127], a[244:247], v[196:199], v[112:127]
    s_waitcnt lgkmcnt(6)
    ds_read_b64_tr_b16 a[224:225], v24 offset:12544
    ds_read_b64_tr_b16 a[226:227], v24 offset:15616
    v_fmac_f32 v91, v91, v135
    v_exp_f32 v136, v136
    v_mfma_f32_32x32x16_bf16 v[224:239], a[248:251], v[196:199], v[224:239]
    ds_read_b64_tr_b16 a[228:229], v25 offset:12608
    ds_read_b64_tr_b16 a[230:231], v25 offset:15680
    buffer_load_dwordx4 a[32:35], v17, s[12:15], s45 offen offset:0 sc1
    v_cvt_pk_bf16_f32 v221, v90, v91
    v_exp_f32 v138, v138
    v_mfma_f32_32x32x16_bf16 v[240:255], a[252:255], v[196:199], v[240:255]
    ds_read_b64_tr_b16 a[232:233], v24 offset:18432
    ds_read_b64_tr_b16 a[234:235], v24 offset:21504
    buffer_load_dwordx4 a[36:39], v17, s[12:15], s45 offen offset:1024 sc1
    v_fma_f32 v137, v136, -0.5, -1.0
    v_fma_f32 v139, v138, -0.5, -1.0
    v_fma_f32 v137, v136, v137, -1.0
    v_mfma_f32_32x32x16_bf16 v[32:47], a[208:211], v[200:203], v[32:47]
    s_waitcnt lgkmcnt(6)
    ds_read_b64_tr_b16 a[236:237], v25 offset:18496
    ds_read_b64_tr_b16 a[238:239], v25 offset:21568
    v_fma_f32 v139, v138, v139, -1.0
    v_rcp_f32 v137, v137
    v_mfma_f32_32x32x16_bf16 v[48:63], a[212:215], v[200:203], v[48:63]
    ds_read_b64_tr_b16 a[240:241], v24 offset:18560
    ds_read_b64_tr_b16 a[242:243], v24 offset:21632
    buffer_load_dwordx4 a[40:43], v17, s[12:15], s45 offen offset:2048 sc1
    v_fmac_f32 v92, v92, v137
    v_rcp_f32 v139, v139
    v_mfma_f32_32x32x16_bf16 v[96:111], a[216:219], v[200:203], v[96:111]
    ds_read_b64_tr_b16 a[244:245], v25 offset:18624
    ds_read_b64_tr_b16 a[246:247], v25 offset:21696
    v_fmac_f32 v93, v93, v139
    v_cvt_pk_bf16_f32 v222, v92, v93
    v_mul_f32 v128, s49, v94
    v_mul_f32 v130, s49, v95
    v_mfma_f32_32x32x16_bf16 v[112:127], a[220:223], v[200:203], v[112:127]
    s_waitcnt lgkmcnt(6)
    ds_read_b64_tr_b16 a[248:249], v24 offset:18688
    ds_read_b64_tr_b16 a[250:251], v24 offset:21760
    v_exp_f32 v128, v128
    v_mfma_f32_32x32x16_bf16 v[224:239], a[224:227], v[200:203], v[224:239]
    ds_read_b64_tr_b16 a[252:253], v25 offset:18752
    ds_read_b64_tr_b16 a[254:255], v25 offset:21824
    buffer_load_dwordx4 a[44:47], v17, s[12:15], s45 offen offset:3072 sc1
    v_fma_f32 v129, v128, -0.5, -1.0
    v_exp_f32 v130, v130
    v_mfma_f32_32x32x16_bf16 v[240:255], a[228:231], v[200:203], v[240:255]
    s_waitcnt vmcnt(30)
    s_barrier
    ds_read_b64_tr_b16 a[208:209], v24 offset:24576
    ds_read_b64_tr_b16 a[210:211], v24 offset:27648
    s_add_u32 m0, s3, 49152
    s_add_u32 s47, s67, 147456
    v_mfma_f32_32x32x16_bf16 v[32:47], a[232:235], v[204:207], v[32:47]
    s_waitcnt lgkmcnt(6)
    ds_read_b64_tr_b16 a[212:213], v25 offset:24640
    ds_read_b64_tr_b16 a[214:215], v25 offset:27712
    v_fma_f32 v131, v130, -0.5, -1.0
    v_fma_f32 v129, v128, v129, -1.0
    v_fma_f32 v131, v130, v131, -1.0
    v_mfma_f32_32x32x16_bf16 v[48:63], a[236:239], v[204:207], v[48:63]
    ds_read_b64_tr_b16 a[216:217], v24 offset:24704
    ds_read_b64_tr_b16 a[218:219], v24 offset:27776
    buffer_load_dwordx4 v18, s[16:19], s47 offen offset:0 lds
    v_rcp_f32 v129, v129
    v_mfma_f32_32x32x16_bf16 v[96:111], a[240:243], v[204:207], v[96:111]
    ds_read_b64_tr_b16 a[220:221], v25 offset:24768
    ds_read_b64_tr_b16 a[222:223], v25 offset:27840
    v_fmac_f32 v94, v94, v129
    v_rcp_f32 v131, v131
    v_mfma_f32_32x32x16_bf16 v[112:127], a[244:247], v[204:207], v[112:127]
    s_waitcnt lgkmcnt(6)
    ds_read_b64_tr_b16 a[224:225], v24 offset:24832
    ds_read_b64_tr_b16 a[226:227], v24 offset:27904
    v_fmac_f32 v95, v95, v131
    v_cvt_pk_bf16_f32 v223, v94, v95
    v_mfma_f32_32x32x16_bf16 v[224:239], a[248:251], v[204:207], v[224:239]
    ds_read_b64_tr_b16 a[228:229], v25 offset:24896
    ds_read_b64_tr_b16 a[230:231], v25 offset:27968
    s_bitcmp1_b32 s36, 0
    s_cbranch_scc1 L_ex_24
    ds_write_b128 v15, v[216:219] offset:0
    ds_write_b128 v15, v[220:223] offset:1024
    s_branch L_exe_25
L_ex_24:
    ds_write_b128 v15, v[208:211] offset:0
    ds_write_b128 v15, v[212:215] offset:1024
L_exe_25:
    v_mfma_f32_32x32x16_bf16 v[240:255], a[252:255], v[204:207], v[240:255]
    ds_read_b64_tr_b16 a[232:233], v24 offset:30720
    ds_read_b64_tr_b16 a[234:235], v24 offset:33792
    buffer_load_dwordx4 v19, s[16:19], s47 offen offset:1024 lds
    v_mfma_f32_32x32x16_bf16 v[32:47], a[208:211], a[0:3], v[32:47]
    s_waitcnt lgkmcnt(8)
    ds_read_b64_tr_b16 a[236:237], v25 offset:30784
    ds_read_b64_tr_b16 a[238:239], v25 offset:33856
    v_mfma_f32_32x32x16_bf16 v[48:63], a[212:215], a[0:3], v[48:63]
    ds_read_b64_tr_b16 a[240:241], v24 offset:30848
    ds_read_b64_tr_b16 a[242:243], v24 offset:33920
    buffer_load_dwordx4 v20, s[16:19], s47 offen offset:2048 lds
    v_mfma_f32_32x32x16_bf16 v[96:111], a[216:219], a[0:3], v[96:111]
    ds_read_b64_tr_b16 a[244:245], v25 offset:30912
    ds_read_b64_tr_b16 a[246:247], v25 offset:33984
    v_mfma_f32_32x32x16_bf16 v[112:127], a[220:223], a[0:3], v[112:127]
    s_waitcnt lgkmcnt(6)
    ds_read_b64_tr_b16 a[248:249], v24 offset:30976
    ds_read_b64_tr_b16 a[250:251], v24 offset:34048
    v_mfma_f32_32x32x16_bf16 v[224:239], a[224:227], a[0:3], v[224:239]
    ds_read_b64_tr_b16 a[252:253], v25 offset:31040
    ds_read_b64_tr_b16 a[254:255], v25 offset:34112
    buffer_load_dwordx4 v21, s[16:19], s47 offen offset:3072 lds
    s_add_u32 m0, s3, 53248
    v_mfma_f32_32x32x16_bf16 v[240:255], a[228:231], a[0:3], v[240:255]
    ds_read_b64_tr_b16 a[208:209], v24 offset:36864
    ds_read_b64_tr_b16 a[210:211], v24 offset:39936
    v_mfma_f32_32x32x16_bf16 v[32:47], a[232:235], a[4:7], v[32:47]
    s_waitcnt lgkmcnt(6)
    ds_read_b64_tr_b16 a[212:213], v25 offset:36928
    ds_read_b64_tr_b16 a[214:215], v25 offset:40000
    v_mfma_f32_32x32x16_bf16 v[48:63], a[236:239], a[4:7], v[48:63]
    ds_read_b64_tr_b16 a[216:217], v24 offset:36992
    ds_read_b64_tr_b16 a[218:219], v24 offset:40064
    buffer_load_dwordx4 v22, s[16:19], s47 offen offset:0 lds
    v_mfma_f32_32x32x16_bf16 v[96:111], a[240:243], a[4:7], v[96:111]
    ds_read_b64_tr_b16 a[220:221], v25 offset:37056
    ds_read_b64_tr_b16 a[222:223], v25 offset:40128
    v_mfma_f32_32x32x16_bf16 v[112:127], a[244:247], a[4:7], v[112:127]
    s_waitcnt lgkmcnt(6)
    ds_read_b64_tr_b16 a[224:225], v24 offset:37120
    ds_read_b64_tr_b16 a[226:227], v24 offset:40192
    v_mfma_f32_32x32x16_bf16 v[224:239], a[248:251], a[4:7], v[224:239]
    ds_read_b64_tr_b16 a[228:229], v25 offset:37184
    ds_read_b64_tr_b16 a[230:231], v25 offset:40256
    buffer_load_dwordx4 v23, s[16:19], s47 offen offset:1024 lds
    s_add_u32 s45, s71, 8192
    v_mfma_f32_32x32x16_bf16 v[240:255], a[252:255], a[4:7], v[240:255]
    ds_read_b64_tr_b16 a[232:233], v24 offset:43008
    ds_read_b64_tr_b16 a[234:235], v24 offset:46080
    buffer_load_dwordx4 a[48:51], v17, s[12:15], s45 offen offset:0 sc1
    v_mfma_f32_32x32x16_bf16 v[32:47], a[208:211], a[8:11], v[32:47]
    s_waitcnt lgkmcnt(6)
    ds_read_b64_tr_b16 a[236:237], v25 offset:43072
    ds_read_b64_tr_b16 a[238:239], v25 offset:46144
    v_mfma_f32_32x32x16_bf16 v[48:63], a[212:215], a[8:11], v[48:63]
    ds_read_b64_tr_b16 a[240:241], v24 offset:43136
    ds_read_b64_tr_b16 a[242:243], v24 offset:46208
    buffer_load_dwordx4 a[52:55], v17, s[12:15], s45 offen offset:1024 sc1
    v_mfma_f32_32x32x16_bf16 v[96:111], a[216:219], a[8:11], v[96:111]
    ds_read_b64_tr_b16 a[244:245], v25 offset:43200
    ds_read_b64_tr_b16 a[246:247], v25 offset:46272
    v_mfma_f32_32x32x16_bf16 v[112:127], a[220:223], a[8:11], v[112:127]
    s_waitcnt lgkmcnt(6)
    ds_read_b64_tr_b16 a[248:249], v24 offset:43264
    ds_read_b64_tr_b16 a[250:251], v24 offset:46336
    v_mfma_f32_32x32x16_bf16 v[224:239], a[224:227], a[8:11], v[224:239]
    ds_read_b64_tr_b16 a[252:253], v25 offset:43328
    ds_read_b64_tr_b16 a[254:255], v25 offset:46400
    buffer_load_dwordx4 a[56:59], v17, s[12:15], s45 offen offset:2048 sc1
    v_mfma_f32_32x32x16_bf16 v[240:255], a[228:231], a[8:11], v[240:255]
    s_waitcnt vmcnt(23)
    s_barrier
    ds_read_b64_tr_b16 a[208:209], v26 offset:24576
    ds_read_b64_tr_b16 a[210:211], v26 offset:27648
    s_bitcmp1_b32 s36, 0
    s_cbranch_scc1 L_ex_26
    ds_read_b128 v[216:219], v16 offset:0
    ds_read_b128 v[220:223], v16 offset:1024
    s_branch L_exe_27
L_ex_26:
    ds_read_b128 v[208:211], v16 offset:0
    ds_read_b128 v[212:215], v16 offset:1024
L_exe_27:
    v_mfma_f32_32x32x16_bf16 v[32:47], a[232:235], a[12:15], v[32:47]
    s_waitcnt lgkmcnt(8)
    ds_read_b64_tr_b16 a[212:213], v27 offset:24640
    ds_read_b64_tr_b16 a[214:215], v27 offset:27712
    v_mov_b32 v31, 2
    s_add_u32 s44, s42, 8192
    buffer_store_dword v31, off, s[12:15], s44 sc1
    v_mfma_f32_32x32x16_bf16 v[48:63], a[236:239], a[12:15], v[48:63]
    ds_read_b64_tr_b16 a[216:217], v26 offset:24704
    ds_read_b64_tr_b16 a[218:219], v26 offset:27776
    buffer_load_dwordx4 a[60:63], v17, s[12:15], s45 offen offset:3072 sc1
    s_add_u32 m0, s3, 0
    s_add_u32 s47, s68, 0
    v_mfma_f32_32x32x16_bf16 v[96:111], a[240:243], a[12:15], v[96:111]
    ds_read_b64_tr_b16 a[220:221], v27 offset:24768
    ds_read_b64_tr_b16 a[222:223], v27 offset:27840
    v_mfma_f32_32x32x16_bf16 v[112:127], a[244:247], a[12:15], v[112:127]
    s_waitcnt lgkmcnt(6)
    ds_read_b64_tr_b16 a[224:225], v26 offset:24832
    ds_read_b64_tr_b16 a[226:227], v26 offset:27904
    buffer_store_dwordx4 v[208:211], v17, s[12:15], s48 offen offset:0 sc1
    v_mfma_f32_32x32x16_bf16 v[224:239], a[248:251], a[12:15], v[224:239]
    ds_read_b64_tr_b16 a[228:229], v27 offset:24896
    ds_read_b64_tr_b16 a[230:231], v27 offset:27968
    buffer_load_dwordx4 v18, s[16:19], s47 offen offset:0 lds
    v_mfma_f32_32x32x16_bf16 v[240:255], a[252:255], a[12:15], v[240:255]
    ds_read_b64_tr_b16 a[232:233], v26 offset:30720
    ds_read_b64_tr_b16 a[234:235], v26 offset:33792
    buffer_load_dwordx4 v19, s[16:19], s47 offen offset:1024 lds
    v_mfma_f32_32x32x16_bf16 v[32:47], a[208:211], v[208:211], v[32:47]
    s_waitcnt lgkmcnt(6)
    ds_read_b64_tr_b16 a[236:237], v27 offset:30784
    ds_read_b64_tr_b16 a[238:239], v27 offset:33856
    v_mfma_f32_32x32x16_bf16 v[48:63], a[212:215], v[208:211], v[48:63]
    ds_read_b64_tr_b16 a[240:241], v26 offset:30848
    ds_read_b64_tr_b16 a[242:243], v26 offset:33920
    buffer_load_dwordx4 v20, s[16:19], s47 offen offset:2048 lds
    v_mfma_f32_32x32x16_bf16 v[96:111], a[216:219], v[208:211], v[96:111]
    ds_read_b64_tr_b16 a[244:245], v27 offset:30912
    ds_read_b64_tr_b16 a[246:247], v27 offset:33984
    v_mfma_f32_32x32x16_bf16 v[112:127], a[220:223], v[208:211], v[112:127]
    s_waitcnt lgkmcnt(6)
    ds_read_b64_tr_b16 a[248:249], v26 offset:30976
    ds_read_b64_tr_b16 a[250:251], v26 offset:34048
    v_mfma_f32_32x32x16_bf16 v[224:239], a[224:227], v[208:211], v[224:239]
    ds_read_b64_tr_b16 a[252:253], v27 offset:31040
    ds_read_b64_tr_b16 a[254:255], v27 offset:34112
    buffer_load_dwordx4 v21, s[16:19], s47 offen offset:3072 lds
    s_add_u32 m0, s3, 4096
    v_mfma_f32_32x32x16_bf16 v[240:255], a[228:231], v[208:211], v[240:255]
    ds_read_b64_tr_b16 a[208:209], v26 offset:36864
    ds_read_b64_tr_b16 a[210:211], v26 offset:39936
    v_mfma_f32_32x32x16_bf16 v[32:47], a[232:235], v[212:215], v[32:47]
    s_waitcnt lgkmcnt(6)
    ds_read_b64_tr_b16 a[212:213], v27 offset:36928
    ds_read_b64_tr_b16 a[214:215], v27 offset:40000
    v_mfma_f32_32x32x16_bf16 v[48:63], a[236:239], v[212:215], v[48:63]
    ds_read_b64_tr_b16 a[216:217], v26 offset:36992
    ds_read_b64_tr_b16 a[218:219], v26 offset:40064
    buffer_load_dwordx4 v22, s[16:19], s47 offen offset:0 lds
    v_mfma_f32_32x32x16_bf16 v[96:111], a[240:243], v[212:215], v[96:111]
    ds_read_b64_tr_b16 a[220:221], v27 offset:37056
    ds_read_b64_tr_b16 a[222:223], v27 offset:40128
    v_mfma_f32_32x32x16_bf16 v[112:127], a[244:247], v[212:215], v[112:127]
    s_waitcnt lgkmcnt(6)
    ds_read_b64_tr_b16 a[224:225], v26 offset:37120
    ds_read_b64_tr_b16 a[226:227], v26 offset:40192
    buffer_store_dwordx4 v[212:215], v17, s[12:15], s48 offen offset:1024 sc1
    v_mfma_f32_32x32x16_bf16 v[224:239], a[248:251], v[212:215], v[224:239]
    ds_read_b64_tr_b16 a[228:229], v27 offset:37184
    ds_read_b64_tr_b16 a[230:231], v27 offset:40256
    buffer_load_dwordx4 v23, s[16:19], s47 offen offset:1024 lds
    s_add_u32 s45, s72, 0
    v_mfma_f32_32x32x16_bf16 v[240:255], a[252:255], v[212:215], v[240:255]
    ds_read_b64_tr_b16 a[232:233], v26 offset:43008
    ds_read_b64_tr_b16 a[234:235], v26 offset:46080
    buffer_load_dwordx4 a[64:67], v17, s[12:15], s45 offen offset:0 sc1
    v_mfma_f32_32x32x16_bf16 v[32:47], a[208:211], v[216:219], v[32:47]
    s_waitcnt lgkmcnt(6)
    ds_read_b64_tr_b16 a[236:237], v27 offset:43072
    ds_read_b64_tr_b16 a[238:239], v27 offset:46144
    v_mfma_f32_32x32x16_bf16 v[48:63], a[212:215], v[216:219], v[48:63]
    ds_read_b64_tr_b16 a[240:241], v26 offset:43136
    ds_read_b64_tr_b16 a[242:243], v26 offset:46208
    buffer_load_dwordx4 a[68:71], v17, s[12:15], s45 offen offset:1024 sc1
    v_mfma_f32_32x32x16_bf16 v[96:111], a[216:219], v[216:219], v[96:111]
    ds_read_b64_tr_b16 a[244:245], v27 offset:43200
    ds_read_b64_tr_b16 a[246:247], v27 offset:46272
    v_mfma_f32_32x32x16_bf16 v[112:127], a[220:223], v[216:219], v[112:127]
    s_waitcnt lgkmcnt(6)
    ds_read_b64_tr_b16 a[248:249], v26 offset:43264
    ds_read_b64_tr_b16 a[250:251], v26 offset:46336
    v_mfma_f32_32x32x16_bf16 v[224:239], a[224:227], v[216:219], v[224:239]
    ds_read_b64_tr_b16 a[252:253], v27 offset:43328
    ds_read_b64_tr_b16 a[254:255], v27 offset:46400
    buffer_load_dwordx4 a[72:75], v17, s[12:15], s45 offen offset:2048 sc1
    v_mfma_f32_32x32x16_bf16 v[240:255], a[228:231], v[216:219], v[240:255]
    s_waitcnt vmcnt(32)
    s_barrier
    ds_read_b64_tr_b16 a[208:209], v28 offset:0
    ds_read_b64_tr_b16 a[210:211], v28 offset:3072
    v_mfma_f32_32x32x16_bf16 v[32:47], a[232:235], v[220:223], v[32:47]
    s_waitcnt lgkmcnt(6)
    ds_read_b64_tr_b16 a[212:213], v29 offset:64
    ds_read_b64_tr_b16 a[214:215], v29 offset:3136
    v_mfma_f32_32x32x16_bf16 v[48:63], a[236:239], v[220:223], v[48:63]
    ds_read_b64_tr_b16 a[216:217], v28 offset:128
    ds_read_b64_tr_b16 a[218:219], v28 offset:3200
    buffer_load_dwordx4 a[76:79], v17, s[12:15], s45 offen offset:3072 sc1
    s_add_u32 m0, s3, 24576
    s_add_u32 s47, s68, 73728
    v_mfma_f32_32x32x16_bf16 v[96:111], a[240:243], v[220:223], v[96:111]
    ds_read_b64_tr_b16 a[220:221], v29 offset:192
    ds_read_b64_tr_b16 a[222:223], v29 offset:3264
    v_mfma_f32_32x32x16_bf16 v[112:127], a[244:247], v[220:223], v[112:127]
    s_waitcnt lgkmcnt(6)
    ds_read_b64_tr_b16 a[224:225], v28 offset:256
    ds_read_b64_tr_b16 a[226:227], v28 offset:3328
    buffer_store_dwordx4 v[216:219], v17, s[12:15], s48 offen offset:2048 sc1
    v_mfma_f32_32x32x16_bf16 v[224:239], a[248:251], v[220:223], v[224:239]
    ds_read_b64_tr_b16 a[228:229], v29 offset:320
    ds_read_b64_tr_b16 a[230:231], v29 offset:3392
    buffer_load_dwordx4 v18, s[16:19], s47 offen offset:0 lds
    v_mfma_f32_32x32x16_bf16 v[240:255], a[252:255], v[220:223], v[240:255]
    ds_read_b64_tr_b16 a[232:233], v28 offset:6144
    ds_read_b64_tr_b16 a[234:235], v28 offset:9216
    buffer_load_dwordx4 v19, s[16:19], s47 offen offset:1024 lds
    v_mfma_f32_32x32x16_bf16 v[32:47], a[208:211], a[16:19], v[32:47]
    s_waitcnt lgkmcnt(6)
    ds_read_b64_tr_b16 a[236:237], v29 offset:6208
    ds_read_b64_tr_b16 a[238:239], v29 offset:9280
    v_mfma_f32_32x32x16_bf16 v[48:63], a[212:215], a[16:19], v[48:63]
    ds_read_b64_tr_b16 a[240:241], v28 offset:6272
    ds_read_b64_tr_b16 a[242:243], v28 offset:9344
    buffer_load_dwordx4 v20, s[16:19], s47 offen offset:2048 lds
    v_mfma_f32_32x32x16_bf16 v[96:111], a[216:219], a[16:19], v[96:111]
    ds_read_b64_tr_b16 a[244:245], v29 offset:6336
    ds_read_b64_tr_b16 a[246:247], v29 offset:9408
    v_mfma_f32_32x32x16_bf16 v[112:127], a[220:223], a[16:19], v[112:127]
    s_waitcnt lgkmcnt(6)
    ds_read_b64_tr_b16 a[248:249], v28 offset:6400
    ds_read_b64_tr_b16 a[250:251], v28 offset:9472
    v_mfma_f32_32x32x16_bf16 v[224:239], a[224:227], a[16:19], v[224:239]
    ds_read_b64_tr_b16 a[252:253], v29 offset:6464
    ds_read_b64_tr_b16 a[254:255], v29 offset:9536
    buffer_load_dwordx4 v21, s[16:19], s47 offen offset:3072 lds
    s_add_u32 m0, s3, 28672
    v_mfma_f32_32x32x16_bf16 v[240:255], a[228:231], a[16:19], v[240:255]
    ds_read_b64_tr_b16 a[208:209], v28 offset:12288
    ds_read_b64_tr_b16 a[210:211], v28 offset:15360
    v_mfma_f32_32x32x16_bf16 v[32:47], a[232:235], a[20:23], v[32:47]
    s_waitcnt lgkmcnt(6)
    ds_read_b64_tr_b16 a[212:213], v29 offset:12352
    ds_read_b64_tr_b16 a[214:215], v29 offset:15424
    v_mfma_f32_32x32x16_bf16 v[48:63], a[236:239], a[20:23], v[48:63]
    ds_read_b64_tr_b16 a[216:217], v28 offset:12416
    ds_read_b64_tr_b16 a[218:219], v28 offset:15488
    buffer_load_dwordx4 v22, s[16:19], s47 offen offset:0 lds
    v_mfma_f32_32x32x16_bf16 v[96:111], a[240:243], a[20:23], v[96:111]
    ds_read_b64_tr_b16 a[220:221], v29 offset:12480
    ds_read_b64_tr_b16 a[222:223], v29 offset:15552
    v_mfma_f32_32x32x16_bf16 v[112:127], a[244:247], a[20:23], v[112:127]
    s_waitcnt lgkmcnt(6)
    ds_read_b64_tr_b16 a[224:225], v28 offset:12544
    ds_read_b64_tr_b16 a[226:227], v28 offset:15616
    buffer_store_dwordx4 v[220:223], v17, s[12:15], s48 offen offset:3072 sc1
    s_add_u32 s48, s48, 4096
    v_mfma_f32_32x32x16_bf16 v[224:239], a[248:251], a[20:23], v[224:239]
    ds_read_b64_tr_b16 a[228:229], v29 offset:12608
    ds_read_b64_tr_b16 a[230:231], v29 offset:15680
    buffer_load_dwordx4 v23, s[16:19], s47 offen offset:1024 lds
    s_add_u32 s45, s72, 4096
    v_mfma_f32_32x32x16_bf16 v[240:255], a[252:255], a[20:23], v[240:255]
    ds_read_b64_tr_b16 a[232:233], v28 offset:18432
    ds_read_b64_tr_b16 a[234:235], v28 offset:21504
    buffer_load_dwordx4 a[80:83], v17, s[12:15], s45 offen offset:0 sc1
    v_mfma_f32_32x32x16_bf16 v[32:47], a[208:211], a[24:27], v[32:47]
    s_waitcnt lgkmcnt(6)
    ds_read_b64_tr_b16 a[236:237], v29 offset:18496
    ds_read_b64_tr_b16 a[238:239], v29 offset:21568
    v_mfma_f32_32x32x16_bf16 v[48:63], a[212:215], a[24:27], v[48:63]
    ds_read_b64_tr_b16 a[240:241], v28 offset:18560
    ds_read_b64_tr_b16 a[242:243], v28 offset:21632
    buffer_load_dwordx4 a[84:87], v17, s[12:15], s45 offen offset:1024 sc1
    v_mfma_f32_32x32x16_bf16 v[96:111], a[216:219], a[24:27], v[96:111]
    ds_read_b64_tr_b16 a[244:245], v29 offset:18624
    ds_read_b64_tr_b16 a[246:247], v29 offset:21696
    v_mfma_f32_32x32x16_bf16 v[112:127], a[220:223], a[24:27], v[112:127]
    s_waitcnt lgkmcnt(6)
    ds_read_b64_tr_b16 a[248:249], v28 offset:18688
    ds_read_b64_tr_b16 a[250:251], v28 offset:21760
    v_mfma_f32_32x32x16_bf16 v[224:239], a[224:227], a[24:27], v[224:239]
    ds_read_b64_tr_b16 a[252:253], v29 offset:18752
    ds_read_b64_tr_b16 a[254:255], v29 offset:21824
    buffer_load_dwordx4 a[88:91], v17, s[12:15], s45 offen offset:2048 sc1
    v_mfma_f32_32x32x16_bf16 v[240:255], a[228:231], a[24:27], v[240:255]
    s_waitcnt vmcnt(34)
    s_barrier
    ds_read_b64_tr_b16 a[208:209], v28 offset:24576
    ds_read_b64_tr_b16 a[210:211], v28 offset:27648
    v_mfma_f32_32x32x16_bf16 v[32:47], a[232:235], a[28:31], v[32:47]
    s_waitcnt lgkmcnt(6)
    ds_read_b64_tr_b16 a[212:213], v29 offset:24640
    ds_read_b64_tr_b16 a[214:215], v29 offset:27712
    s_mul_i32 s53, s39, 192
    s_mul_i32 s85, s38, 48
    s_add_u32 s53, s53, s85
    s_mul_i32 s85, s53, 7282
    s_lshr_b32 s85, s85, 16
    v_add_u32 v64, s85, v1
    v_min_u32 v64, 63, v64
    s_lshl_b32 s85, s37, 2
    s_add_u32 s85, s85, s36
    v_mov_b32 v65, s85
    v_cmp_lt_u32 vcc, 6, v1
    s_lshl_b32 s52, s85, 5
    s_mov_b32 s75, 0
    v_cndmask_b32 v64, v64, v65, vcc
    v_lshlrev_b32 v64, 4, v64
    v_mfma_f32_32x32x16_bf16 v[48:63], a[236:239], a[28:31], v[48:63]
    ds_read_b64_tr_b16 a[216:217], v28 offset:24704
    ds_read_b64_tr_b16 a[218:219], v28 offset:27776
    buffer_load_dwordx4 a[92:95], v17, s[12:15], s45 offen offset:3072 sc1
    v_mfma_f32_32x32x16_bf16 v[96:111], a[240:243], a[28:31], v[96:111]
    ds_read_b64_tr_b16 a[220:221], v29 offset:24768
    ds_read_b64_tr_b16 a[222:223], v29 offset:27840
    v_lshrrev_b32 v65, 2, v1
    v_lshlrev_b32 v65, 12, v65
    v_and_b32 v74, 3, v1
    v_lshl_add_u32 v65, v74, 4, v65
    v_and_b32 v74, 31, v1
    v_lshlrev_b32 v75, 2, v74
    v_mfma_f32_32x32x16_bf16 v[112:127], a[244:247], a[28:31], v[112:127]
    s_waitcnt lgkmcnt(6)
    ds_read_b64_tr_b16 a[224:225], v28 offset:24832
    ds_read_b64_tr_b16 a[226:227], v28 offset:27904
    v_mov_b32 v68, 0
    v_mov_b32 v69, 0
    v_mov_b32 v70, 0
    v_mov_b32 v71, 0
    ds_write_b128 v15, v[68:71]
    v_mfma_f32_32x32x16_bf16 v[224:239], a[248:251], a[28:31], v[224:239]
    ds_read_b64_tr_b16 a[228:229], v29 offset:24896
    ds_read_b64_tr_b16 a[230:231], v29 offset:27968
    s_lshl_b32 s85, s36, 8
    s_add_u32 m0, s85, 157696
    s_and_b32 s85, s42, 0xffffff80
    s_add_u32 s85, s85, 8192
    buffer_load_dword v2, s[12:15], s85 offen sc1 lds
    v_mfma_f32_32x32x16_bf16 v[240:255], a[252:255], a[28:31], v[240:255]
    ds_read_b64_tr_b16 a[232:233], v28 offset:30720
    ds_read_b64_tr_b16 a[234:235], v28 offset:33792
    s_add_u32 m0, s3, 73728
    s_add_u32 s47, s68, 147456
    buffer_load_dwordx4 v18, s[16:19], s47 offen offset:0 lds
    v_mfma_f32_32x32x16_bf16 v[32:47], a[208:211], a[32:35], v[32:47]
    s_waitcnt lgkmcnt(7)
    ds_read_b64_tr_b16 a[236:237], v29 offset:30784
    ds_read_b64_tr_b16 a[238:239], v29 offset:33856
    v_mfma_f32_32x32x16_bf16 v[48:63], a[212:215], a[32:35], v[48:63]
    ds_read_b64_tr_b16 a[240:241], v28 offset:30848
    ds_read_b64_tr_b16 a[242:243], v28 offset:33920
    buffer_load_dwordx4 v19, s[16:19], s47 offen offset:1024 lds
    v_mfma_f32_32x32x16_bf16 v[96:111], a[216:219], a[32:35], v[96:111]
    ds_read_b64_tr_b16 a[244:245], v29 offset:30912
    ds_read_b64_tr_b16 a[246:247], v29 offset:33984
    v_mfma_f32_32x32x16_bf16 v[112:127], a[220:223], a[32:35], v[112:127]
    s_waitcnt lgkmcnt(6)
    ds_read_b64_tr_b16 a[248:249], v28 offset:30976
    ds_read_b64_tr_b16 a[250:251], v28 offset:34048
    v_mfma_f32_32x32x16_bf16 v[224:239], a[224:227], a[32:35], v[224:239]
    ds_read_b64_tr_b16 a[252:253], v29 offset:31040
    ds_read_b64_tr_b16 a[254:255], v29 offset:34112
    buffer_load_dwordx4 v20, s[16:19], s47 offen offset:2048 lds
    v_mfma_f32_32x32x16_bf16 v[240:255], a[228:231], a[32:35], v[240:255]
    ds_read_b64_tr_b16 a[208:209], v28 offset:36864
    ds_read_b64_tr_b16 a[210:211], v28 offset:39936
    v_mfma_f32_32x32x16_bf16 v[32:47], a[232:235], a[36:39], v[32:47]
    s_waitcnt lgkmcnt(6)
    ds_read_b64_tr_b16 a[212:213], v29 offset:36928
    ds_read_b64_tr_b16 a[214:215], v29 offset:40000
    buffer_load_dwordx4 v21, s[16:19], s47 offen offset:3072 lds
    s_add_u32 m0, s3, 77824
    v_mfma_f32_32x32x16_bf16 v[48:63], a[236:239], a[36:39], v[48:63]
    ds_read_b64_tr_b16 a[216:217], v28 offset:36992
    ds_read_b64_tr_b16 a[218:219], v28 offset:40064
    buffer_load_dwordx4 v22, s[16:19], s47 offen offset:0 lds
    v_mfma_f32_32x32x16_bf16 v[96:111], a[240:243], a[36:39], v[96:111]
    ds_read_b64_tr_b16 a[220:221], v29 offset:37056
    ds_read_b64_tr_b16 a[222:223], v29 offset:40128
    v_mfma_f32_32x32x16_bf16 v[112:127], a[244:247], a[36:39], v[112:127]
    s_waitcnt lgkmcnt(6)
    ds_read_b64_tr_b16 a[224:225], v28 offset:37120
    ds_read_b64_tr_b16 a[226:227], v28 offset:40192
    v_mfma_f32_32x32x16_bf16 v[224:239], a[248:251], a[36:39], v[224:239]
    ds_read_b64_tr_b16 a[228:229], v29 offset:37184
    ds_read_b64_tr_b16 a[230:231], v29 offset:40256
    buffer_load_dwordx4 v23, s[16:19], s47 offen offset:1024 lds
    s_add_u32 s45, s72, 8192
    v_mfma_f32_32x32x16_bf16 v[240:255], a[252:255], a[36:39], v[240:255]
    ds_read_b64_tr_b16 a[232:233], v28 offset:43008
    ds_read_b64_tr_b16 a[234:235], v28 offset:46080
    buffer_load_dwordx4 a[96:99], v17, s[12:15], s45 offen offset:0 sc1
    v_mfma_f32_32x32x16_bf16 v[32:47], a[208:211], a[40:43], v[32:47]
    s_waitcnt lgkmcnt(6)
    ds_read_b64_tr_b16 a[236:237], v29 offset:43072
    ds_read_b64_tr_b16 a[238:239], v29 offset:46144
    v_mfma_f32_32x32x16_bf16 v[48:63], a[212:215], a[40:43], v[48:63]
    ds_read_b64_tr_b16 a[240:241], v28 offset:43136
    ds_read_b64_tr_b16 a[242:243], v28 offset:46208
    buffer_load_dwordx4 a[100:103], v17, s[12:15], s45 offen offset:1024 sc1
    v_mfma_f32_32x32x16_bf16 v[96:111], a[216:219], a[40:43], v[96:111]
    ds_read_b64_tr_b16 a[244:245], v29 offset:43200
    ds_read_b64_tr_b16 a[246:247], v29 offset:46272
    v_mfma_f32_32x32x16_bf16 v[112:127], a[220:223], a[40:43], v[112:127]
    s_waitcnt lgkmcnt(6)
    ds_read_b64_tr_b16 a[248:249], v28 offset:43264
    ds_read_b64_tr_b16 a[250:251], v28 offset:46336
    v_mfma_f32_32x32x16_bf16 v[224:239], a[224:227], a[40:43], v[224:239]
    ds_read_b64_tr_b16 a[252:253], v29 offset:43328
    ds_read_b64_tr_b16 a[254:255], v29 offset:46400
    buffer_load_dwordx4 a[104:107], v17, s[12:15], s45 offen offset:2048 sc1
    v_mfma_f32_32x32x16_bf16 v[240:255], a[228:231], a[40:43], v[240:255]
    s_waitcnt vmcnt(34)
    s_barrier
    ds_read_b64_tr_b16 a[208:209], v26 offset:0
    ds_read_b64_tr_b16 a[210:211], v26 offset:3072
    v_mfma_f32_32x32x16_bf16 v[32:47], a[232:235], a[44:47], v[32:47]
    s_waitcnt lgkmcnt(6)
    ds_read_b64_tr_b16 a[212:213], v27 offset:64
    ds_read_b64_tr_b16 a[214:215], v27 offset:3136
    v_mfma_f32_32x32x16_bf16 v[48:63], a[236:239], a[44:47], v[48:63]
    ds_read_b64_tr_b16 a[216:217], v26 offset:128
    ds_read_b64_tr_b16 a[218:219], v26 offset:3200
    buffer_load_dwordx4 a[108:111], v17, s[12:15], s45 offen offset:3072 sc1
    s_add_u32 m0, s3, 98304
    s_add_u32 s47, s67, 221184
    v_mfma_f32_32x32x16_bf16 v[96:111], a[240:243], a[44:47], v[96:111]
    ds_read_b64_tr_b16 a[220:221], v27 offset:192
    ds_read_b64_tr_b16 a[222:223], v27 offset:3264
    v_mfma_f32_32x32x16_bf16 v[112:127], a[244:247], a[44:47], v[112:127]
    s_waitcnt lgkmcnt(6)
    ds_read_b64_tr_b16 a[224:225], v26 offset:256
    ds_read_b64_tr_b16 a[226:227], v26 offset:3328
    v_mfma_f32_32x32x16_bf16 v[224:239], a[248:251], a[44:47], v[224:239]
    ds_read_b64_tr_b16 a[228:229], v27 offset:320
    ds_read_b64_tr_b16 a[230:231], v27 offset:3392
    buffer_load_dwordx4 v18, s[16:19], s47 offen offset:0 lds
    v_mfma_f32_32x32x16_bf16 v[240:255], a[252:255], a[44:47], v[240:255]
    ds_read_b64_tr_b16 a[232:233], v26 offset:6144
    ds_read_b64_tr_b16 a[234:235], v26 offset:9216
    buffer_load_dwordx4 v19, s[16:19], s47 offen offset:1024 lds
    v_mfma_f32_32x32x16_bf16 v[32:47], a[208:211], a[48:51], v[32:47]
    s_waitcnt lgkmcnt(6)
    ds_read_b64_tr_b16 a[236:237], v27 offset:6208
    ds_read_b64_tr_b16 a[238:239], v27 offset:9280
    v_mfma_f32_32x32x16_bf16 v[48:63], a[212:215], a[48:51], v[48:63]
    ds_read_b64_tr_b16 a[240:241], v26 offset:6272
    ds_read_b64_tr_b16 a[242:243], v26 offset:9344
    buffer_load_dwordx4 v20, s[16:19], s47 offen offset:2048 lds
    v_mfma_f32_32x32x16_bf16 v[96:111], a[216:219], a[48:51], v[96:111]
    ds_read_b64_tr_b16 a[244:245], v27 offset:6336
    ds_read_b64_tr_b16 a[246:247], v27 offset:9408
    v_mfma_f32_32x32x16_bf16 v[112:127], a[220:223], a[48:51], v[112:127]
    s_waitcnt lgkmcnt(6)
    ds_read_b64_tr_b16 a[248:249], v26 offset:6400
    ds_read_b64_tr_b16 a[250:251], v26 offset:9472
    v_mfma_f32_32x32x16_bf16 v[224:239], a[224:227], a[48:51], v[224:239]
    ds_read_b64_tr_b16 a[252:253], v27 offset:6464
    ds_read_b64_tr_b16 a[254:255], v27 offset:9536
    buffer_load_dwordx4 v21, s[16:19], s47 offen offset:3072 lds
    s_add_u32 m0, s3, 102400
    v_mfma_f32_32x32x16_bf16 v[240:255], a[228:231], a[48:51], v[240:255]
    ds_read_b64_tr_b16 a[208:209], v26 offset:12288
    ds_read_b64_tr_b16 a[210:211], v26 offset:15360
    v_mfma_f32_32x32x16_bf16 v[32:47], a[232:235], a[52:55], v[32:47]
    s_waitcnt lgkmcnt(6)
    ds_read_b64_tr_b16 a[212:213], v27 offset:12352
    ds_read_b64_tr_b16 a[214:215], v27 offset:15424
    v_mfma_f32_32x32x16_bf16 v[48:63], a[236:239], a[52:55], v[48:63]
    ds_read_b64_tr_b16 a[216:217], v26 offset:12416
    ds_read_b64_tr_b16 a[218:219], v26 offset:15488
    buffer_load_dwordx4 v22, s[16:19], s47 offen offset:0 lds
    v_mfma_f32_32x32x16_bf16 v[96:111], a[240:243], a[52:55], v[96:111]
    ds_read_b64_tr_b16 a[220:221], v27 offset:12480
    ds_read_b64_tr_b16 a[222:223], v27 offset:15552
    v_mfma_f32_32x32x16_bf16 v[112:127], a[244:247], a[52:55], v[112:127]
    s_waitcnt lgkmcnt(6)
    ds_read_b64_tr_b16 a[224:225], v26 offset:12544
    ds_read_b64_tr_b16 a[226:227], v26 offset:15616
    v_mfma_f32_32x32x16_bf16 v[224:239], a[248:251], a[52:55], v[224:239]
    ds_read_b64_tr_b16 a[228:229], v27 offset:12608
    ds_read_b64_tr_b16 a[230:231], v27 offset:15680
    buffer_load_dwordx4 v23, s[16:19], s47 offen offset:1024 lds
    v_mfma_f32_32x32x16_bf16 v[240:255], a[252:255], a[52:55], v[240:255]
    ds_read_b64_tr_b16 a[232:233], v26 offset:18432
    ds_read_b64_tr_b16 a[234:235], v26 offset:21504
    v_mfma_f32_32x32x16_bf16 v[32:47], a[208:211], a[56:59], v[32:47]
    s_waitcnt lgkmcnt(6)
    ds_read_b64_tr_b16 a[236:237], v27 offset:18496
    ds_read_b64_tr_b16 a[238:239], v27 offset:21568
    v_mfma_f32_32x32x16_bf16 v[48:63], a[212:215], a[56:59], v[48:63]
    ds_read_b64_tr_b16 a[240:241], v26 offset:18560
    ds_read_b64_tr_b16 a[242:243], v26 offset:21632
    ds_read_b32 v6, v3
    v_mfma_f32_32x32x16_bf16 v[96:111], a[216:219], a[56:59], v[96:111]
    ds_read_b64_tr_b16 a[244:245], v27 offset:18624
    ds_read_b64_tr_b16 a[246:247], v27 offset:21696
    v_mfma_f32_32x32x16_bf16 v[112:127], a[220:223], a[56:59], v[112:127]
    s_waitcnt lgkmcnt(7)
    ds_read_b64_tr_b16 a[248:249], v26 offset:18688
    ds_read_b64_tr_b16 a[250:251], v26 offset:21760
    v_mfma_f32_32x32x16_bf16 v[224:239], a[224:227], a[56:59], v[224:239]
    ds_read_b64_tr_b16 a[252:253], v27 offset:18752
    ds_read_b64_tr_b16 a[254:255], v27 offset:21824
    v_mfma_f32_32x32x16_bf16 v[240:255], a[228:231], a[56:59], v[240:255]
    s_waitcnt vmcnt(22)
    s_barrier
    s_waitcnt lgkmcnt(6)
    v_readlane_b32 s85, v6, s79
    s_movk_i32 s83, 8192
    s_mov_b32 s84, s79
    s_cmp_eq_u32 s85, 2
    s_cbranch_scc1 L_chk_28
    s_call_b64 s[54:55], L_poll
L_chk_28:
    v_readlane_b32 s85, v6, s80
    s_movk_i32 s83, 8192
    s_mov_b32 s84, s80
    s_cmp_eq_u32 s85, 2
    s_cbranch_scc1 L_chk_29
    s_call_b64 s[54:55], L_poll
L_chk_29:
    ds_read_b64_tr_b16 a[208:209], v24 offset:0
    ds_read_b64_tr_b16 a[210:211], v24 offset:3072
    v_mfma_f32_32x32x16_bf16 v[32:47], a[232:235], a[60:63], v[32:47]
    s_waitcnt lgkmcnt(6)
    ds_read_b64_tr_b16 a[212:213], v25 offset:64
    ds_read_b64_tr_b16 a[214:215], v25 offset:3136
    v_mov_b32 v31, 3
    s_add_u32 s44, s42, 16384
    buffer_store_dword v31, off, s[12:15], s44 sc1
    v_mfma_f32_32x32x16_bf16 v[48:63], a[236:239], a[60:63], v[48:63]
    ds_read_b64_tr_b16 a[216:217], v24 offset:128
    ds_read_b64_tr_b16 a[218:219], v24 offset:3200
    s_add_u32 m0, s3, 122880
    s_add_u32 s47, s68, 221184
    buffer_load_dwordx4 v18, s[16:19], s47 offen offset:0 lds
    v_mfma_f32_32x32x16_bf16 v[96:111], a[240:243], a[60:63], v[96:111]
    ds_read_b64_tr_b16 a[220:221], v25 offset:192
    ds_read_b64_tr_b16 a[222:223], v25 offset:3264
    buffer_load_dwordx4 v19, s[16:19], s47 offen offset:1024 lds
    v_mfma_f32_32x32x16_bf16 v[112:127], a[244:247], a[60:63], v[112:127]
    s_waitcnt lgkmcnt(6)
    ds_read_b64_tr_b16 a[224:225], v24 offset:256
    ds_read_b64_tr_b16 a[226:227], v24 offset:3328
    buffer_load_dwordx4 v20, s[16:19], s47 offen offset:2048 lds
    v_mfma_f32_32x32x16_bf16 v[224:239], a[248:251], a[60:63], v[224:239]
    ds_read_b64_tr_b16 a[228:229], v25 offset:320
    ds_read_b64_tr_b16 a[230:231], v25 offset:3392
    buffer_load_dwordx4 v21, s[16:19], s47 offen offset:3072 lds
    s_add_u32 m0, s3, 126976
    v_mfma_f32_32x32x16_bf16 v[240:255], a[252:255], a[60:63], v[240:255]
    ds_read_b64_tr_b16 a[232:233], v24 offset:6144
    ds_read_b64_tr_b16 a[234:235], v24 offset:9216
    buffer_load_dwordx4 v22, s[16:19], s47 offen offset:0 lds
    v_mfma_f32_32x32x16_bf16 v[32:47], a[208:211], a[64:67], v[32:47]
    s_waitcnt lgkmcnt(6)
    ds_read_b64_tr_b16 a[236:237], v25 offset:6208
    ds_read_b64_tr_b16 a[238:239], v25 offset:9280
    v_mfma_f32_32x32x16_bf16 v[48:63], a[212:215], a[64:67], v[48:63]
    ds_read_b64_tr_b16 a[240:241], v24 offset:6272
    ds_read_b64_tr_b16 a[242:243], v24 offset:9344
    buffer_load_dwordx4 v23, s[16:19], s47 offen offset:1024 lds
    s_add_u32 s45, s71, 12288
    v_mfma_f32_32x32x16_bf16 v[96:111], a[216:219], a[64:67], v[96:111]
    ds_read_b64_tr_b16 a[244:245], v25 offset:6336
    ds_read_b64_tr_b16 a[246:247], v25 offset:9408
    v_mfma_f32_32x32x16_bf16 v[112:127], a[220:223], a[64:67], v[112:127]
    s_waitcnt lgkmcnt(6)
    ds_read_b64_tr_b16 a[248:249], v24 offset:6400
    ds_read_b64_tr_b16 a[250:251], v24 offset:9472
    v_mfma_f32_32x32x16_bf16 v[224:239], a[224:227], a[64:67], v[224:239]
    ds_read_b64_tr_b16 a[252:253], v25 offset:6464
    ds_read_b64_tr_b16 a[254:255], v25 offset:9536
    buffer_load_dwordx4 a[112:115], v17, s[12:15], s45 offen offset:0 sc1
    v_mfma_f32_32x32x16_bf16 v[240:255], a[228:231], a[64:67], v[240:255]
    ds_read_b64_tr_b16 a[208:209], v24 offset:12288
    ds_read_b64_tr_b16 a[210:211], v24 offset:15360
    v_mfma_f32_32x32x16_bf16 v[32:47], a[232:235], a[68:71], v[32:47]
    s_waitcnt lgkmcnt(6)
    ds_read_b64_tr_b16 a[212:213], v25 offset:12352
    ds_read_b64_tr_b16 a[214:215], v25 offset:15424
    buffer_load_dwordx4 a[116:119], v17, s[12:15], s45 offen offset:1024 sc1
    v_mfma_f32_32x32x16_bf16 v[48:63], a[236:239], a[68:71], v[48:63]
    ds_read_b64_tr_b16 a[216:217], v24 offset:12416
    ds_read_b64_tr_b16 a[218:219], v24 offset:15488
    buffer_load_dwordx4 a[120:123], v17, s[12:15], s45 offen offset:2048 sc1
    v_mfma_f32_32x32x16_bf16 v[96:111], a[240:243], a[68:71], v[96:111]
    ds_read_b64_tr_b16 a[220:221], v25 offset:12480
    ds_read_b64_tr_b16 a[222:223], v25 offset:15552
    v_mfma_f32_32x32x16_bf16 v[112:127], a[244:247], a[68:71], v[112:127]
    s_waitcnt lgkmcnt(6)
    ds_read_b64_tr_b16 a[224:225], v24 offset:12544
    ds_read_b64_tr_b16 a[226:227], v24 offset:15616
    v_mfma_f32_32x32x16_bf16 v[224:239], a[248:251], a[68:71], v[224:239]
    ds_read_b64_tr_b16 a[228:229], v25 offset:12608
    ds_read_b64_tr_b16 a[230:231], v25 offset:15680
    buffer_load_dwordx4 a[124:127], v17, s[12:15], s45 offen offset:3072 sc1
    s_add_u32 s45, s72, 12288
    v_mfma_f32_32x32x16_bf16 v[240:255], a[252:255], a[68:71], v[240:255]
    ds_read_b64_tr_b16 a[232:233], v24 offset:18432
    ds_read_b64_tr_b16 a[234:235], v24 offset:21504
    buffer_load_dwordx4 a[128:131], v17, s[12:15], s45 offen offset:0 sc1
    v_mfma_f32_32x32x16_bf16 v[32:47], a[208:211], a[72:75], v[32:47]
    s_waitcnt lgkmcnt(6)
    ds_read_b64_tr_b16 a[236:237], v25 offset:18496
    ds_read_b64_tr_b16 a[238:239], v25 offset:21568
    v_mfma_f32_32x32x16_bf16 v[48:63], a[212:215], a[72:75], v[48:63]
    ds_read_b64_tr_b16 a[240:241], v24 offset:18560
    ds_read_b64_tr_b16 a[242:243], v24 offset:21632
    buffer_load_dwordx4 a[132:135], v17, s[12:15], s45 offen offset:1024 sc1
    v_mfma_f32_32x32x16_bf16 v[96:111], a[216:219], a[72:75], v[96:111]
    ds_read_b64_tr_b16 a[244:245], v25 offset:18624
    ds_read_b64_tr_b16 a[246:247], v25 offset:21696
    v_mfma_f32_32x32x16_bf16 v[112:127], a[220:223], a[72:75], v[112:127]
    s_waitcnt lgkmcnt(6)
    ds_read_b64_tr_b16 a[248:249], v24 offset:18688
    ds_read_b64_tr_b16 a[250:251], v24 offset:21760
    v_mfma_f32_32x32x16_bf16 v[224:239], a[224:227], a[72:75], v[224:239]
    ds_read_b64_tr_b16 a[252:253], v25 offset:18752
    ds_read_b64_tr_b16 a[254:255], v25 offset:21824
    buffer_load_dwordx4 a[136:139], v17, s[12:15], s45 offen offset:2048 sc1
    v_mfma_f32_32x32x16_bf16 v[240:255], a[228:231], a[72:75], v[240:255]
    s_waitcnt vmcnt(31)
    s_barrier
    ds_read_b64_tr_b16 a[208:209], v24 offset:24576
    ds_read_b64_tr_b16 a[210:211], v24 offset:27648
    v_mfma_f32_32x32x16_bf16 v[32:47], a[232:235], a[76:79], v[32:47]
    s_waitcnt lgkmcnt(6)
    ds_read_b64_tr_b16 a[212:213], v25 offset:24640
    ds_read_b64_tr_b16 a[214:215], v25 offset:27712
    v_mfma_f32_32x32x16_bf16 v[48:63], a[236:239], a[76:79], v[48:63]
    ds_read_b64_tr_b16 a[216:217], v24 offset:24704
    ds_read_b64_tr_b16 a[218:219], v24 offset:27776
    buffer_load_dwordx4 a[140:143], v17, s[12:15], s45 offen offset:3072 sc1
    v_mfma_f32_32x32x16_bf16 v[96:111], a[240:243], a[76:79], v[96:111]
    ds_read_b64_tr_b16 a[220:221], v25 offset:24768
    ds_read_b64_tr_b16 a[222:223], v25 offset:27840
    v_mfma_f32_32x32x16_bf16 v[112:127], a[244:247], a[76:79], v[112:127]
    s_waitcnt lgkmcnt(6)
    ds_read_b64_tr_b16 a[224:225], v24 offset:24832
    ds_read_b64_tr_b16 a[226:227], v24 offset:27904
    v_mfma_f32_32x32x16_bf16 v[224:239], a[248:251], a[76:79], v[224:239]
    ds_read_b64_tr_b16 a[228:229], v25 offset:24896
    ds_read_b64_tr_b16 a[230:231], v25 offset:27968
    s_lshl_b32 s85, s36, 8
    s_add_u32 m0, s85, 157696
    s_and_b32 s85, s42, 0xffffff80
    s_add_u32 s85, s85, 16384
    buffer_load_dword v2, s[12:15], s85 offen sc1 lds
    v_mfma_f32_32x32x16_bf16 v[240:255], a[252:255], a[76:79], v[240:255]
    ds_read_b64_tr_b16 a[232:233], v24 offset:30720
    ds_read_b64_tr_b16 a[234:235], v24 offset:33792
    s_add_u32 m0, s3, 49152
    s_add_u32 s47, s67, 294912
    buffer_load_dwordx4 v18, s[16:19], s47 offen offset:0 lds
    v_mfma_f32_32x32x16_bf16 v[32:47], a[208:211], a[80:83], v[32:47]
    s_waitcnt lgkmcnt(6)
    ds_read_b64_tr_b16 a[236:237], v25 offset:30784
    ds_read_b64_tr_b16 a[238:239], v25 offset:33856
    v_mfma_f32_32x32x16_bf16 v[48:63], a[212:215], a[80:83], v[48:63]
    ds_read_b64_tr_b16 a[240:241], v24 offset:30848
    ds_read_b64_tr_b16 a[242:243], v24 offset:33920
    buffer_load_dwordx4 v19, s[16:19], s47 offen offset:1024 lds
    v_mfma_f32_32x32x16_bf16 v[96:111], a[216:219], a[80:83], v[96:111]
    ds_read_b64_tr_b16 a[244:245], v25 offset:30912
    ds_read_b64_tr_b16 a[246:247], v25 offset:33984
    v_mfma_f32_32x32x16_bf16 v[112:127], a[220:223], a[80:83], v[112:127]
    s_waitcnt lgkmcnt(6)
    ds_read_b64_tr_b16 a[248:249], v24 offset:30976
    ds_read_b64_tr_b16 a[250:251], v24 offset:34048
    v_mfma_f32_32x32x16_bf16 v[224:239], a[224:227], a[80:83], v[224:239]
    ds_read_b64_tr_b16 a[252:253], v25 offset:31040
    ds_read_b64_tr_b16 a[254:255], v25 offset:34112
    buffer_load_dwordx4 v20, s[16:19], s47 offen offset:2048 lds
    v_mfma_f32_32x32x16_bf16 v[240:255], a[228:231], a[80:83], v[240:255]
    ds_read_b64_tr_b16 a[208:209], v24 offset:36864
    ds_read_b64_tr_b16 a[210:211], v24 offset:39936
    v_mfma_f32_32x32x16_bf16 v[32:47], a[232:235], a[84:87], v[32:47]
    s_waitcnt lgkmcnt(6)
    ds_read_b64_tr_b16 a[212:213], v25 offset:36928
    ds_read_b64_tr_b16 a[214:215], v25 offset:40000
    buffer_load_dwordx4 v21, s[16:19], s47 offen offset:3072 lds
    s_add_u32 m0, s3, 53248
    v_mfma_f32_32x32x16_bf16 v[48:63], a[236:239], a[84:87], v[48:63]
    ds_read_b64_tr_b16 a[216:217], v24 offset:36992
    ds_read_b64_tr_b16 a[218:219], v24 offset:40064
    buffer_load_dwordx4 v22, s[16:19], s47 offen offset:0 lds
    v_mfma_f32_32x32x16_bf16 v[96:111], a[240:243], a[84:87], v[96:111]
    ds_read_b64_tr_b16 a[220:221], v25 offset:37056
    ds_read_b64_tr_b16 a[222:223], v25 offset:40128
    v_mfma_f32_32x32x16_bf16 v[112:127], a[244:247], a[84:87], v[112:127]
    s_waitcnt lgkmcnt(6)
    ds_read_b64_tr_b16 a[224:225], v24 offset:37120
    ds_read_b64_tr_b16 a[226:227], v24 offset:40192
    v_mfma_f32_32x32x16_bf16 v[224:239], a[248:251], a[84:87], v[224:239]
    ds_read_b64_tr_b16 a[228:229], v25 offset:37184
    ds_read_b64_tr_b16 a[230:231], v25 offset:40256
    buffer_load_dwordx4 v23, s[16:19], s47 offen offset:1024 lds
    s_add_u32 s45, s71, 16384
    v_mfma_f32_32x32x16_bf16 v[240:255], a[252:255], a[84:87], v[240:255]
    ds_read_b64_tr_b16 a[232:233], v24 offset:43008
    ds_read_b64_tr_b16 a[234:235], v24 offset:46080
    buffer_load_dwordx4 a[144:147], v17, s[12:15], s45 offen offset:0 sc1
    v_mfma_f32_32x32x16_bf16 v[32:47], a[208:211], a[88:91], v[32:47]
    s_waitcnt lgkmcnt(6)
    ds_read_b64_tr_b16 a[236:237], v25 offset:43072
    ds_read_b64_tr_b16 a[238:239], v25 offset:46144
    v_mfma_f32_32x32x16_bf16 v[48:63], a[212:215], a[88:91], v[48:63]
    ds_read_b64_tr_b16 a[240:241], v24 offset:43136
    ds_read_b64_tr_b16 a[242:243], v24 offset:46208
    buffer_load_dwordx4 a[148:151], v17, s[12:15], s45 offen offset:1024 sc1
    v_mfma_f32_32x32x16_bf16 v[96:111], a[216:219], a[88:91], v[96:111]
    ds_read_b64_tr_b16 a[244:245], v25 offset:43200
    ds_read_b64_tr_b16 a[246:247], v25 offset:46272
    v_mfma_f32_32x32x16_bf16 v[112:127], a[220:223], a[88:91], v[112:127]
    s_waitcnt lgkmcnt(6)
    ds_read_b64_tr_b16 a[248:249], v24 offset:43264
    ds_read_b64_tr_b16 a[250:251], v24 offset:46336
    v_mfma_f32_32x32x16_bf16 v[224:239], a[224:227], a[88:91], v[224:239]
    ds_read_b64_tr_b16 a[252:253], v25 offset:43328
    ds_read_b64_tr_b16 a[254:255], v25 offset:46400
    buffer_load_dwordx4 a[152:155], v17, s[12:15], s45 offen offset:2048 sc1
    v_mfma_f32_32x32x16_bf16 v[240:255], a[228:231], a[88:91], v[240:255]
    s_waitcnt vmcnt(31)
    s_barrier
    ds_read_b64_tr_b16 a[208:209], v26 offset:24576
    ds_read_b64_tr_b16 a[210:211], v26 offset:27648
    v_mfma_f32_32x32x16_bf16 v[32:47], a[232:235], a[92:95], v[32:47]
    s_waitcnt lgkmcnt(6)
    ds_read_b64_tr_b16 a[212:213], v27 offset:24640
    ds_read_b64_tr_b16 a[214:215], v27 offset:27712
    v_mfma_f32_32x32x16_bf16 v[48:63], a[236:239], a[92:95], v[48:63]
    ds_read_b64_tr_b16 a[216:217], v26 offset:24704
    ds_read_b64_tr_b16 a[218:219], v26 offset:27776
    buffer_load_dwordx4 a[156:159], v17, s[12:15], s45 offen offset:3072 sc1
    s_add_u32 m0, s3, 0
    s_add_u32 s47, s68, 294912
    v_mfma_f32_32x32x16_bf16 v[96:111], a[240:243], a[92:95], v[96:111]
    ds_read_b64_tr_b16 a[220:221], v27 offset:24768
    ds_read_b64_tr_b16 a[222:223], v27 offset:27840
    v_mfma_f32_32x32x16_bf16 v[112:127], a[244:247], a[92:95], v[112:127]
    s_waitcnt lgkmcnt(6)
    ds_read_b64_tr_b16 a[224:225], v26 offset:24832
    ds_read_b64_tr_b16 a[226:227], v26 offset:27904
    v_mfma_f32_32x32x16_bf16 v[224:239], a[248:251], a[92:95], v[224:239]
    ds_read_b64_tr_b16 a[228:229], v27 offset:24896
    ds_read_b64_tr_b16 a[230:231], v27 offset:27968
    buffer_load_dwordx4 v18, s[16:19], s47 offen offset:0 lds
    v_mfma_f32_32x32x16_bf16 v[240:255], a[252:255], a[92:95], v[240:255]
    ds_read_b64_tr_b16 a[232:233], v26 offset:30720
    ds_read_b64_tr_b16 a[234:235], v26 offset:33792
    buffer_load_dwordx4 v19, s[16:19], s47 offen offset:1024 lds
    v_mfma_f32_32x32x16_bf16 v[32:47], a[208:211], a[96:99], v[32:47]
    s_waitcnt lgkmcnt(6)
    ds_read_b64_tr_b16 a[236:237], v27 offset:30784
    ds_read_b64_tr_b16 a[238:239], v27 offset:33856
    v_mfma_f32_32x32x16_bf16 v[48:63], a[212:215], a[96:99], v[48:63]
    ds_read_b64_tr_b16 a[240:241], v26 offset:30848
    ds_read_b64_tr_b16 a[242:243], v26 offset:33920
    buffer_load_dwordx4 v20, s[16:19], s47 offen offset:2048 lds
    v_mfma_f32_32x32x16_bf16 v[96:111], a[216:219], a[96:99], v[96:111]
    ds_read_b64_tr_b16 a[244:245], v27 offset:30912
    ds_read_b64_tr_b16 a[246:247], v27 offset:33984
    v_mfma_f32_32x32x16_bf16 v[112:127], a[220:223], a[96:99], v[112:127]
    s_waitcnt lgkmcnt(6)
    ds_read_b64_tr_b16 a[248:249], v26 offset:30976
    ds_read_b64_tr_b16 a[250:251], v26 offset:34048
    v_mfma_f32_32x32x16_bf16 v[224:239], a[224:227], a[96:99], v[224:239]
    ds_read_b64_tr_b16 a[252:253], v27 offset:31040
    ds_read_b64_tr_b16 a[254:255], v27 offset:34112
    buffer_load_dwordx4 v21, s[16:19], s47 offen offset:3072 lds
    s_add_u32 m0, s3, 4096
    v_mfma_f32_32x32x16_bf16 v[240:255], a[228:231], a[96:99], v[240:255]
    ds_read_b64_tr_b16 a[208:209], v26 offset:36864
    ds_read_b64_tr_b16 a[210:211], v26 offset:39936
    v_mfma_f32_32x32x16_bf16 v[32:47], a[232:235], a[100:103], v[32:47]
    s_waitcnt lgkmcnt(6)
    ds_read_b64_tr_b16 a[212:213], v27 offset:36928
    ds_read_b64_tr_b16 a[214:215], v27 offset:40000
    v_mfma_f32_32x32x16_bf16 v[48:63], a[236:239], a[100:103], v[48:63]
    ds_read_b64_tr_b16 a[216:217], v26 offset:36992
    ds_read_b64_tr_b16 a[218:219], v26 offset:40064
    buffer_load_dwordx4 v22, s[16:19], s47 offen offset:0 lds
    v_mfma_f32_32x32x16_bf16 v[96:111], a[240:243], a[100:103], v[96:111]
    ds_read_b64_tr_b16 a[220:221], v27 offset:37056
    ds_read_b64_tr_b16 a[222:223], v27 offset:40128
    v_mfma_f32_32x32x16_bf16 v[112:127], a[244:247], a[100:103], v[112:127]
    s_waitcnt lgkmcnt(6)
    ds_read_b64_tr_b16 a[224:225], v26 offset:37120
    ds_read_b64_tr_b16 a[226:227], v26 offset:40192
    v_mfma_f32_32x32x16_bf16 v[224:239], a[248:251], a[100:103], v[224:239]
    ds_read_b64_tr_b16 a[228:229], v27 offset:37184
    ds_read_b64_tr_b16 a[230:231], v27 offset:40256
    buffer_load_dwordx4 v23, s[16:19], s47 offen offset:1024 lds
    s_add_u32 s45, s72, 16384
    v_mfma_f32_32x32x16_bf16 v[240:255], a[252:255], a[100:103], v[240:255]
    ds_read_b64_tr_b16 a[232:233], v26 offset:43008
    ds_read_b64_tr_b16 a[234:235], v26 offset:46080
    buffer_load_dwordx4 a[160:163], v17, s[12:15], s45 offen offset:0 sc1
    v_mfma_f32_32x32x16_bf16 v[32:47], a[208:211], a[104:107], v[32:47]
    s_waitcnt lgkmcnt(6)
    ds_read_b64_tr_b16 a[236:237], v27 offset:43072
    ds_read_b64_tr_b16 a[238:239], v27 offset:46144
    v_mfma_f32_32x32x16_bf16 v[48:63], a[212:215], a[104:107], v[48:63]
    ds_read_b64_tr_b16 a[240:241], v26 offset:43136
    ds_read_b64_tr_b16 a[242:243], v26 offset:46208
    ds_read_b32 v6, v3
    buffer_load_dwordx4 a[164:167], v17, s[12:15], s45 offen offset:1024 sc1
    v_mfma_f32_32x32x16_bf16 v[96:111], a[216:219], a[104:107], v[96:111]
    ds_read_b64_tr_b16 a[244:245], v27 offset:43200
    ds_read_b64_tr_b16 a[246:247], v27 offset:46272
    v_mfma_f32_32x32x16_bf16 v[112:127], a[220:223], a[104:107], v[112:127]
    s_waitcnt lgkmcnt(7)
    ds_read_b64_tr_b16 a[248:249], v26 offset:43264
    ds_read_b64_tr_b16 a[250:251], v26 offset:46336
    v_mfma_f32_32x32x16_bf16 v[224:239], a[224:227], a[104:107], v[224:239]
    ds_read_b64_tr_b16 a[252:253], v27 offset:43328
    ds_read_b64_tr_b16 a[254:255], v27 offset:46400
    buffer_load_dwordx4 a[168:171], v17, s[12:15], s45 offen offset:2048 sc1
    v_mfma_f32_32x32x16_bf16 v[240:255], a[228:231], a[104:107], v[240:255]
    s_waitcnt vmcnt(24)
    s_barrier
    s_waitcnt lgkmcnt(6)
    v_readlane_b32 s85, v6, s79
    s_movk_i32 s83, 16384
    s_mov_b32 s84, s79
    s_cmp_eq_u32 s85, 3
    s_cbranch_scc1 L_chk_30
    s_call_b64 s[54:55], L_poll
L_chk_30:
    v_readlane_b32 s85, v6, s80
    s_movk_i32 s83, 16384
    s_mov_b32 s84, s80
    s_cmp_eq_u32 s85, 3
    s_cbranch_scc1 L_chk_31
    s_call_b64 s[54:55], L_poll
L_chk_31:
    ds_read_b64_tr_b16 a[208:209], v28 offset:0
    ds_read_b64_tr_b16 a[210:211], v28 offset:3072
    v_mfma_f32_32x32x16_bf16 v[32:47], a[232:235], a[108:111], v[32:47]
    s_waitcnt lgkmcnt(6)
    ds_read_b64_tr_b16 a[212:213], v29 offset:64
    ds_read_b64_tr_b16 a[214:215], v29 offset:3136
    buffer_load_dwordx4 a[172:175], v17, s[12:15], s45 offen offset:3072 sc1
    s_add_u32 m0, s3, 24576
    s_add_u32 s47, s67, 368640
    v_mfma_f32_32x32x16_bf16 v[48:63], a[236:239], a[108:111], v[48:63]
    ds_read_b64_tr_b16 a[216:217], v28 offset:128
    ds_read_b64_tr_b16 a[218:219], v28 offset:3200
    buffer_load_dwordx4 v18, s[16:19], s47 offen offset:0 lds
    v_mfma_f32_32x32x16_bf16 v[96:111], a[240:243], a[108:111], v[96:111]
    ds_read_b64_tr_b16 a[220:221], v29 offset:192
    ds_read_b64_tr_b16 a[222:223], v29 offset:3264
    buffer_load_dwordx4 v19, s[16:19], s47 offen offset:1024 lds
    v_mfma_f32_32x32x16_bf16 v[112:127], a[244:247], a[108:111], v[112:127]
    s_waitcnt lgkmcnt(6)
    ds_read_b64_tr_b16 a[224:225], v28 offset:256
    ds_read_b64_tr_b16 a[226:227], v28 offset:3328
    buffer_load_dwordx4 v20, s[16:19], s47 offen offset:2048 lds
    v_mfma_f32_32x32x16_bf16 v[224:239], a[248:251], a[108:111], v[224:239]
    ds_read_b64_tr_b16 a[228:229], v29 offset:320
    ds_read_b64_tr_b16 a[230:231], v29 offset:3392
    buffer_load_dwordx4 v21, s[16:19], s47 offen offset:3072 lds
    s_add_u32 m0, s3, 28672
    v_mfma_f32_32x32x16_bf16 v[240:255], a[252:255], a[108:111], v[240:255]
    ds_read_b64_tr_b16 a[232:233], v28 offset:6144
    ds_read_b64_tr_b16 a[234:235], v28 offset:9216
    buffer_load_dwordx4 v22, s[16:19], s47 offen offset:0 lds
    v_mfma_f32_32x32x16_bf16 v[32:47], a[208:211], a[112:115], v[32:47]
    s_waitcnt lgkmcnt(6)
    ds_read_b64_tr_b16 a[236:237], v29 offset:6208
    ds_read_b64_tr_b16 a[238:239], v29 offset:9280
    v_mfma_f32_32x32x16_bf16 v[48:63], a[212:215], a[112:115], v[48:63]
    ds_read_b64_tr_b16 a[240:241], v28 offset:6272
    ds_read_b64_tr_b16 a[242:243], v28 offset:9344
    buffer_load_dwordx4 v23, s[16:19], s47 offen offset:1024 lds
    s_add_u32 s45, s71, 20480
    v_mfma_f32_32x32x16_bf16 v[96:111], a[216:219], a[112:115], v[96:111]
    ds_read_b64_tr_b16 a[244:245], v29 offset:6336
    ds_read_b64_tr_b16 a[246:247], v29 offset:9408
    v_mfma_f32_32x32x16_bf16 v[112:127], a[220:223], a[112:115], v[112:127]
    s_waitcnt lgkmcnt(6)
    ds_read_b64_tr_b16 a[248:249], v28 offset:6400
    ds_read_b64_tr_b16 a[250:251], v28 offset:9472
    v_mfma_f32_32x32x16_bf16 v[224:239], a[224:227], a[112:115], v[224:239]
    ds_read_b64_tr_b16 a[252:253], v29 offset:6464
    ds_read_b64_tr_b16 a[254:255], v29 offset:9536
    buffer_load_dwordx4 a[176:179], v17, s[12:15], s45 offen offset:0 sc1
    v_mfma_f32_32x32x16_bf16 v[240:255], a[228:231], a[112:115], v[240:255]
    ds_read_b64_tr_b16 a[208:209], v28 offset:12288
    ds_read_b64_tr_b16 a[210:211], v28 offset:15360
    v_mfma_f32_32x32x16_bf16 v[32:47], a[232:235], a[116:119], v[32:47]
    s_waitcnt lgkmcnt(6)
    ds_read_b64_tr_b16 a[212:213], v29 offset:12352
    ds_read_b64_tr_b16 a[214:215], v29 offset:15424
    buffer_load_dwordx4 a[180:183], v17, s[12:15], s45 offen offset:1024 sc1
    v_mfma_f32_32x32x16_bf16 v[48:63], a[236:239], a[116:119], v[48:63]
    ds_read_b64_tr_b16 a[216:217], v28 offset:12416
    ds_read_b64_tr_b16 a[218:219], v28 offset:15488
    buffer_load_dwordx4 a[184:187], v17, s[12:15], s45 offen offset:2048 sc1
    v_mfma_f32_32x32x16_bf16 v[96:111], a[240:243], a[116:119], v[96:111]
    ds_read_b64_tr_b16 a[220:221], v29 offset:12480
    ds_read_b64_tr_b16 a[222:223], v29 offset:15552
    v_mfma_f32_32x32x16_bf16 v[112:127], a[244:247], a[116:119], v[112:127]
    s_waitcnt lgkmcnt(6)
    ds_read_b64_tr_b16 a[224:225], v28 offset:12544
    ds_read_b64_tr_b16 a[226:227], v28 offset:15616
    v_mfma_f32_32x32x16_bf16 v[224:239], a[248:251], a[116:119], v[224:239]
    ds_read_b64_tr_b16 a[228:229], v29 offset:12608
    ds_read_b64_tr_b16 a[230:231], v29 offset:15680
    buffer_load_dwordx4 a[188:191], v17, s[12:15], s45 offen offset:3072 sc1
    s_add_u32 s45, s72, 20480
    v_mfma_f32_32x32x16_bf16 v[240:255], a[252:255], a[116:119], v[240:255]
    ds_read_b64_tr_b16 a[232:233], v28 offset:18432
    ds_read_b64_tr_b16 a[234:235], v28 offset:21504
    buffer_load_dwordx4 a[192:195], v17, s[12:15], s45 offen offset:0 sc1
    v_mfma_f32_32x32x16_bf16 v[32:47], a[208:211], a[120:123], v[32:47]
    s_waitcnt lgkmcnt(6)
    ds_read_b64_tr_b16 a[236:237], v29 offset:18496
    ds_read_b64_tr_b16 a[238:239], v29 offset:21568
    v_mfma_f32_32x32x16_bf16 v[48:63], a[212:215], a[120:123], v[48:63]
    ds_read_b64_tr_b16 a[240:241], v28 offset:18560
    ds_read_b64_tr_b16 a[242:243], v28 offset:21632
    buffer_load_dwordx4 a[196:199], v17, s[12:15], s45 offen offset:1024 sc1
    v_mfma_f32_32x32x16_bf16 v[96:111], a[216:219], a[120:123], v[96:111]
    ds_read_b64_tr_b16 a[244:245], v29 offset:18624
    ds_read_b64_tr_b16 a[246:247], v29 offset:21696
    v_mfma_f32_32x32x16_bf16 v[112:127], a[220:223], a[120:123], v[112:127]
    s_waitcnt lgkmcnt(6)
    ds_read_b64_tr_b16 a[248:249], v28 offset:18688
    ds_read_b64_tr_b16 a[250:251], v28 offset:21760
    v_mfma_f32_32x32x16_bf16 v[224:239], a[224:227], a[120:123], v[224:239]
    ds_read_b64_tr_b16 a[252:253], v29 offset:18752
    ds_read_b64_tr_b16 a[254:255], v29 offset:21824
    buffer_load_dwordx4 a[200:203], v17, s[12:15], s45 offen offset:2048 sc1
    v_mfma_f32_32x32x16_bf16 v[240:255], a[228:231], a[120:123], v[240:255]
    s_waitcnt vmcnt(34)
    s_barrier
    ds_read_b64_tr_b16 a[208:209], v28 offset:24576
    ds_read_b64_tr_b16 a[210:211], v28 offset:27648
    v_mfma_f32_32x32x16_bf16 v[32:47], a[232:235], a[124:127], v[32:47]
    s_waitcnt lgkmcnt(6)
    ds_read_b64_tr_b16 a[212:213], v29 offset:24640
    ds_read_b64_tr_b16 a[214:215], v29 offset:27712
    v_mfma_f32_32x32x16_bf16 v[48:63], a[236:239], a[124:127], v[48:63]
    ds_read_b64_tr_b16 a[216:217], v28 offset:24704
    ds_read_b64_tr_b16 a[218:219], v28 offset:27776
    buffer_load_dwordx4 a[204:207], v17, s[12:15], s45 offen offset:3072 sc1
    s_add_u32 m0, s3, 73728
    s_add_u32 s47, s68, 368640
    v_mfma_f32_32x32x16_bf16 v[96:111], a[240:243], a[124:127], v[96:111]
    ds_read_b64_tr_b16 a[220:221], v29 offset:24768
    ds_read_b64_tr_b16 a[222:223], v29 offset:27840
    v_mfma_f32_32x32x16_bf16 v[112:127], a[244:247], a[124:127], v[112:127]
    s_waitcnt lgkmcnt(6)
    ds_read_b64_tr_b16 a[224:225], v28 offset:24832
    ds_read_b64_tr_b16 a[226:227], v28 offset:27904
    v_mfma_f32_32x32x16_bf16 v[224:239], a[248:251], a[124:127], v[224:239]
    ds_read_b64_tr_b16 a[228:229], v29 offset:24896
    ds_read_b64_tr_b16 a[230:231], v29 offset:27968
    buffer_load_dwordx4 v18, s[16:19], s47 offen offset:0 lds
    v_mfma_f32_32x32x16_bf16 v[240:255], a[252:255], a[124:127], v[240:255]
    ds_read_b64_tr_b16 a[232:233], v28 offset:30720
    ds_read_b64_tr_b16 a[234:235], v28 offset:33792
    buffer_load_dwordx4 v19, s[16:19], s47 offen offset:1024 lds
    v_mfma_f32_32x32x16_bf16 v[32:47], a[208:211], a[128:131], v[32:47]
    s_waitcnt lgkmcnt(6)
    ds_read_b64_tr_b16 a[236:237], v29 offset:30784
    ds_read_b64_tr_b16 a[238:239], v29 offset:33856
    v_mfma_f32_32x32x16_bf16 v[48:63], a[212:215], a[128:131], v[48:63]
    ds_read_b64_tr_b16 a[240:241], v28 offset:30848
    ds_read_b64_tr_b16 a[242:243], v28 offset:33920
    buffer_load_dwordx4 v20, s[16:19], s47 offen offset:2048 lds
    v_mfma_f32_32x32x16_bf16 v[96:111], a[216:219], a[128:131], v[96:111]
    ds_read_b64_tr_b16 a[244:245], v29 offset:30912
    ds_read_b64_tr_b16 a[246:247], v29 offset:33984
    v_mfma_f32_32x32x16_bf16 v[112:127], a[220:223], a[128:131], v[112:127]
    s_waitcnt lgkmcnt(6)
    ds_read_b64_tr_b16 a[248:249], v28 offset:30976
    ds_read_b64_tr_b16 a[250:251], v28 offset:34048
    v_mfma_f32_32x32x16_bf16 v[224:239], a[224:227], a[128:131], v[224:239]
    ds_read_b64_tr_b16 a[252:253], v29 offset:31040
    ds_read_b64_tr_b16 a[254:255], v29 offset:34112
    buffer_load_dwordx4 v21, s[16:19], s47 offen offset:3072 lds
    s_add_u32 m0, s3, 77824
    v_mfma_f32_32x32x16_bf16 v[240:255], a[228:231], a[128:131], v[240:255]
    ds_read_b64_tr_b16 a[208:209], v28 offset:36864
    ds_read_b64_tr_b16 a[210:211], v28 offset:39936
    v_mfma_f32_32x32x16_bf16 v[32:47], a[232:235], a[132:135], v[32:47]
    s_waitcnt lgkmcnt(6)
    ds_read_b64_tr_b16 a[212:213], v29 offset:36928
    ds_read_b64_tr_b16 a[214:215], v29 offset:40000
    v_mfma_f32_32x32x16_bf16 v[48:63], a[236:239], a[132:135], v[48:63]
    ds_read_b64_tr_b16 a[216:217], v28 offset:36992
    ds_read_b64_tr_b16 a[218:219], v28 offset:40064
    buffer_load_dwordx4 v22, s[16:19], s47 offen offset:0 lds
    v_mfma_f32_32x32x16_bf16 v[96:111], a[240:243], a[132:135], v[96:111]
    ds_read_b64_tr_b16 a[220:221], v29 offset:37056
    ds_read_b64_tr_b16 a[222:223], v29 offset:40128
    v_mfma_f32_32x32x16_bf16 v[112:127], a[244:247], a[132:135], v[112:127]
    s_waitcnt lgkmcnt(6)
    ds_read_b64_tr_b16 a[224:225], v28 offset:37120
    ds_read_b64_tr_b16 a[226:227], v28 offset:40192
    v_mfma_f32_32x32x16_bf16 v[224:239], a[248:251], a[132:135], v[224:239]
    ds_read_b64_tr_b16 a[228:229], v29 offset:37184
    ds_read_b64_tr_b16 a[230:231], v29 offset:40256
    buffer_load_dwordx4 v23, s[16:19], s47 offen offset:1024 lds
    v_mfma_f32_32x32x16_bf16 v[240:255], a[252:255], a[132:135], v[240:255]
    ds_read_b64_tr_b16 a[232:233], v28 offset:43008
    ds_read_b64_tr_b16 a[234:235], v28 offset:46080
    v_mfma_f32_32x32x16_bf16 v[32:47], a[208:211], a[136:139], v[32:47]
    s_waitcnt lgkmcnt(6)
    ds_read_b64_tr_b16 a[236:237], v29 offset:43072
    ds_read_b64_tr_b16 a[238:239], v29 offset:46144
    v_mfma_f32_32x32x16_bf16 v[48:63], a[212:215], a[136:139], v[48:63]
    ds_read_b64_tr_b16 a[240:241], v28 offset:43136
    ds_read_b64_tr_b16 a[242:243], v28 offset:46208
    v_mfma_f32_32x32x16_bf16 v[96:111], a[216:219], a[136:139], v[96:111]
    ds_read_b64_tr_b16 a[244:245], v29 offset:43200
    ds_read_b64_tr_b16 a[246:247], v29 offset:46272
    v_mfma_f32_32x32x16_bf16 v[112:127], a[220:223], a[136:139], v[112:127]
    s_waitcnt lgkmcnt(6)
    ds_read_b64_tr_b16 a[248:249], v28 offset:43264
    ds_read_b64_tr_b16 a[250:251], v28 offset:46336
    v_mfma_f32_32x32x16_bf16 v[224:239], a[224:227], a[136:139], v[224:239]
    ds_read_b64_tr_b16 a[252:253], v29 offset:43328
    ds_read_b64_tr_b16 a[254:255], v29 offset:46400
    v_mfma_f32_32x32x16_bf16 v[240:255], a[228:231], a[136:139], v[240:255]
    s_waitcnt vmcnt(30)
    s_barrier
    ds_read_b64_tr_b16 a[208:209], v26 offset:0
    ds_read_b64_tr_b16 a[210:211], v26 offset:3072
    s_mul_i32 s83, s36, 3072
    s_add_u32 s83, s83, 27262976
    s_add_u32 s85, s38, 1
    s_and_b32 s85, s85, 3
    s_add_u32 s84, s82, s85
    s_lshl_b32 s84, s84, 2
    s_add_u32 s84, s84, s38
    s_mul_i32 s84, s84, 12288
    s_add_u32 s66, s84, s83
    s_add_u32 s84, s82, s38
    s_lshl_b32 s84, s84, 2
    s_add_u32 s84, s84, s85
    s_mul_i32 s84, s84, 12288
    s_add_u32 s70, s84, s83
    v_mfma_f32_32x32x16_bf16 v[32:47], a[232:235], a[140:143], v[32:47]
    s_waitcnt lgkmcnt(6)
    ds_read_b64_tr_b16 a[212:213], v27 offset:64
    ds_read_b64_tr_b16 a[214:215], v27 offset:3136
    s_add_u32 s85, s38, 2
    s_and_b32 s85, s85, 3
    s_add_u32 s84, s82, s85
    s_lshl_b32 s84, s84, 2
    s_add_u32 s84, s84, s38
    s_mul_i32 s84, s84, 12288
    s_add_u32 s67, s84, s83
    s_add_u32 s84, s82, s38
    s_lshl_b32 s84, s84, 2
    s_add_u32 s84, s84, s85
    s_mul_i32 s84, s84, 12288
    s_add_u32 s71, s84, s83
    s_add_u32 s85, s38, 3
    s_and_b32 s85, s85, 3
    s_add_u32 s84, s82, s85
    s_lshl_b32 s84, s84, 2
    s_add_u32 s84, s84, s38
    s_mul_i32 s84, s84, 12288
    s_add_u32 s68, s84, s83
    s_add_u32 s84, s82, s38
    s_lshl_b32 s84, s84, 2
    s_add_u32 s84, s84, s85
    s_mul_i32 s84, s84, 12288
    s_add_u32 s72, s84, s83
    v_mfma_f32_32x32x16_bf16 v[48:63], a[236:239], a[140:143], v[48:63]
    ds_read_b64_tr_b16 a[216:217], v26 offset:128
    ds_read_b64_tr_b16 a[218:219], v26 offset:3200
    v_min_u32 v77, 2, v1
    s_add_u32 s85, s38, 1
    v_add_u32 v77, s85, v77
    v_and_b32 v77, 3, v77
    s_lshl_b32 s85, s38, 2
    s_lshl_b32 s84, s36, 7
    s_add_u32 s85, s85, s84
    v_lshlrev_b32 v76, 9, v77
    v_add_u32 v76, s85, v76
    s_lshl_b32 s85, s38, 9
    s_add_u32 s85, s85, s84
    v_lshlrev_b32 v77, 2, v77
    v_add_u32 v77, s85, v77
    v_mfma_f32_32x32x16_bf16 v[96:111], a[240:243], a[140:143], v[96:111]
    ds_read_b64_tr_b16 a[220:221], v27 offset:192
    ds_read_b64_tr_b16 a[222:223], v27 offset:3264
    v_mfma_f32_32x32x16_bf16 v[112:127], a[244:247], a[140:143], v[112:127]
    s_waitcnt lgkmcnt(6)
    ds_read_b64_tr_b16 a[224:225], v26 offset:256
    ds_read_b64_tr_b16 a[226:227], v26 offset:3328
    v_mfma_f32_32x32x16_bf16 v[224:239], a[248:251], a[140:143], v[224:239]
    ds_read_b64_tr_b16 a[228:229], v27 offset:320
    ds_read_b64_tr_b16 a[230:231], v27 offset:3392
    v_mfma_f32_32x32x16_bf16 v[240:255], a[252:255], a[140:143], v[240:255]
    ds_read_b64_tr_b16 a[232:233], v26 offset:6144
    ds_read_b64_tr_b16 a[234:235], v26 offset:9216
    v_mfma_f32_32x32x16_bf16 v[32:47], a[208:211], a[144:147], v[32:47]
    s_waitcnt lgkmcnt(6)
    ds_read_b64_tr_b16 a[236:237], v27 offset:6208
    ds_read_b64_tr_b16 a[238:239], v27 offset:9280
    v_mfma_f32_32x32x16_bf16 v[48:63], a[212:215], a[144:147], v[48:63]
    ds_read_b64_tr_b16 a[240:241], v26 offset:6272
    ds_read_b64_tr_b16 a[242:243], v26 offset:9344
    v_mfma_f32_32x32x16_bf16 v[96:111], a[216:219], a[144:147], v[96:111]
    ds_read_b64_tr_b16 a[244:245], v27 offset:6336
    ds_read_b64_tr_b16 a[246:247], v27 offset:9408
    v_mfma_f32_32x32x16_bf16 v[112:127], a[220:223], a[144:147], v[112:127]
    s_waitcnt lgkmcnt(6)
    ds_read_b64_tr_b16 a[248:249], v26 offset:6400
    ds_read_b64_tr_b16 a[250:251], v26 offset:9472
    v_mfma_f32_32x32x16_bf16 v[224:239], a[224:227], a[144:147], v[224:239]
    ds_read_b64_tr_b16 a[252:253], v27 offset:6464
    ds_read_b64_tr_b16 a[254:255], v27 offset:9536
    v_mfma_f32_32x32x16_bf16 v[240:255], a[228:231], a[144:147], v[240:255]
    ds_read_b64_tr_b16 a[208:209], v26 offset:12288
    ds_read_b64_tr_b16 a[210:211], v26 offset:15360
    v_mfma_f32_32x32x16_bf16 v[32:47], a[232:235], a[148:151], v[32:47]
    s_waitcnt lgkmcnt(6)
    ds_read_b64_tr_b16 a[212:213], v27 offset:12352
    ds_read_b64_tr_b16 a[214:215], v27 offset:15424
    v_mfma_f32_32x32x16_bf16 v[48:63], a[236:239], a[148:151], v[48:63]
    ds_read_b64_tr_b16 a[216:217], v26 offset:12416
    ds_read_b64_tr_b16 a[218:219], v26 offset:15488
    v_mfma_f32_32x32x16_bf16 v[96:111], a[240:243], a[148:151], v[96:111]
    ds_read_b64_tr_b16 a[220:221], v27 offset:12480
    ds_read_b64_tr_b16 a[222:223], v27 offset:15552
    v_mfma_f32_32x32x16_bf16 v[112:127], a[244:247], a[148:151], v[112:127]
    s_waitcnt lgkmcnt(6)
    ds_read_b64_tr_b16 a[224:225], v26 offset:12544
    ds_read_b64_tr_b16 a[226:227], v26 offset:15616
    v_mfma_f32_32x32x16_bf16 v[224:239], a[248:251], a[148:151], v[224:239]
    ds_read_b64_tr_b16 a[228:229], v27 offset:12608
    ds_read_b64_tr_b16 a[230:231], v27 offset:15680
    v_mfma_f32_32x32x16_bf16 v[240:255], a[252:255], a[148:151], v[240:255]
    ds_read_b64_tr_b16 a[232:233], v26 offset:18432
    ds_read_b64_tr_b16 a[234:235], v26 offset:21504
    v_mfma_f32_32x32x16_bf16 v[32:47], a[208:211], a[152:155], v[32:47]
    s_waitcnt lgkmcnt(6)
    ds_read_b64_tr_b16 a[236:237], v27 offset:18496
    ds_read_b64_tr_b16 a[238:239], v27 offset:21568
    v_mfma_f32_32x32x16_bf16 v[48:63], a[212:215], a[152:155], v[48:63]
    ds_read_b64_tr_b16 a[240:241], v26 offset:18560
    ds_read_b64_tr_b16 a[242:243], v26 offset:21632
    v_mfma_f32_32x32x16_bf16 v[96:111], a[216:219], a[152:155], v[96:111]
    ds_read_b64_tr_b16 a[244:245], v27 offset:18624
    ds_read_b64_tr_b16 a[246:247], v27 offset:21696
    v_mfma_f32_32x32x16_bf16 v[112:127], a[220:223], a[152:155], v[112:127]
    s_waitcnt lgkmcnt(6)
    ds_read_b64_tr_b16 a[248:249], v26 offset:18688
    ds_read_b64_tr_b16 a[250:251], v26 offset:21760
    v_mfma_f32_32x32x16_bf16 v[224:239], a[224:227], a[152:155], v[224:239]
    ds_read_b64_tr_b16 a[252:253], v27 offset:18752
    ds_read_b64_tr_b16 a[254:255], v27 offset:21824
    v_mfma_f32_32x32x16_bf16 v[240:255], a[228:231], a[152:155], v[240:255]
    s_waitcnt vmcnt(0)
    s_barrier
    ds_read_b64_tr_b16 a[208:209], v24 offset:0
    ds_read_b64_tr_b16 a[210:211], v24 offset:3072
    v_mfma_f32_32x32x16_bf16 v[32:47], a[232:235], a[156:159], v[32:47]
    s_waitcnt lgkmcnt(6)
    ds_read_b64_tr_b16 a[212:213], v24 offset:6144
    ds_read_b64_tr_b16 a[214:215], v24 offset:9216
    v_mfma_f32_32x32x16_bf16 v[48:63], a[236:239], a[156:159], v[48:63]
    ds_read_b64_tr_b16 a[216:217], v24 offset:12288
    ds_read_b64_tr_b16 a[218:219], v24 offset:15360
    v_mfma_f32_32x32x16_bf16 v[96:111], a[240:243], a[156:159], v[96:111]
    ds_read_b64_tr_b16 a[220:221], v24 offset:18432
    ds_read_b64_tr_b16 a[222:223], v24 offset:21504
    v_mfma_f32_32x32x16_bf16 v[112:127], a[244:247], a[156:159], v[112:127]
    s_waitcnt lgkmcnt(6)
    ds_read_b64_tr_b16 a[224:225], v24 offset:24576
    ds_read_b64_tr_b16 a[226:227], v24 offset:27648
    v_mfma_f32_32x32x16_bf16 v[224:239], a[248:251], a[156:159], v[224:239]
    ds_read_b64_tr_b16 a[228:229], v24 offset:30720
    ds_read_b64_tr_b16 a[230:231], v24 offset:33792
    v_mfma_f32_32x32x16_bf16 v[240:255], a[252:255], a[156:159], v[240:255]
    ds_read_b64_tr_b16 a[232:233], v24 offset:36864
    ds_read_b64_tr_b16 a[234:235], v24 offset:39936
    v_mfma_f32_32x32x16_bf16 v[32:47], a[208:211], a[160:163], v[32:47]
    s_waitcnt lgkmcnt(6)
    ds_read_b64_tr_b16 a[236:237], v24 offset:43008
    ds_read_b64_tr_b16 a[238:239], v24 offset:46080
    v_mfma_f32_32x32x16_bf16 v[32:47], a[212:215], a[164:167], v[32:47]
    ds_read_b64_tr_b16 a[240:241], v26 offset:24576
    ds_read_b64_tr_b16 a[242:243], v26 offset:27648
    v_mfma_f32_32x32x16_bf16 v[32:47], a[216:219], a[168:171], v[32:47]
    ds_read_b64_tr_b16 a[244:245], v26 offset:30720
    ds_read_b64_tr_b16 a[246:247], v26 offset:33792
    v_mfma_f32_32x32x16_bf16 v[32:47], a[220:223], a[172:175], v[32:47]
    s_waitcnt lgkmcnt(6)
    ds_read_b64_tr_b16 a[248:249], v26 offset:36864
    ds_read_b64_tr_b16 a[250:251], v26 offset:39936
    v_mfma_f32_32x32x16_bf16 v[32:47], a[224:227], a[176:179], v[32:47]
    ds_read_b64_tr_b16 a[252:253], v26 offset:43008
    ds_read_b64_tr_b16 a[254:255], v26 offset:46080
    v_mfma_f32_32x32x16_bf16 v[32:47], a[228:231], a[180:183], v[32:47]
    ds_read_b64_tr_b16 a[208:209], v25 offset:64
    ds_read_b64_tr_b16 a[210:211], v25 offset:3136
    v_mfma_f32_32x32x16_bf16 v[32:47], a[232:235], a[184:187], v[32:47]
    s_waitcnt lgkmcnt(6)
    ds_read_b64_tr_b16 a[212:213], v25 offset:6208
    ds_read_b64_tr_b16 a[214:215], v25 offset:9280
    v_mfma_f32_32x32x16_bf16 v[32:47], a[236:239], a[188:191], v[32:47]
    ds_read_b64_tr_b16 a[216:217], v25 offset:12352
    ds_read_b64_tr_b16 a[218:219], v25 offset:15424
    v_mfma_f32_32x32x16_bf16 v[32:47], a[240:243], a[192:195], v[32:47]
    ds_read_b64_tr_b16 a[220:221], v25 offset:18496
    ds_read_b64_tr_b16 a[222:223], v25 offset:21568
    v_mfma_f32_32x32x16_bf16 v[32:47], a[244:247], a[196:199], v[32:47]
    s_waitcnt lgkmcnt(6)
    ds_read_b64_tr_b16 a[224:225], v25 offset:24640
    ds_read_b64_tr_b16 a[226:227], v25 offset:27712
    v_mfma_f32_32x32x16_bf16 v[32:47], a[248:251], a[200:203], v[32:47]
    ds_read_b64_tr_b16 a[228:229], v25 offset:30784
    ds_read_b64_tr_b16 a[230:231], v25 offset:33856
    v_mfma_f32_32x32x16_bf16 v[32:47], a[252:255], a[204:207], v[32:47]
    ds_read_b64_tr_b16 a[232:233], v25 offset:36928
    ds_read_b64_tr_b16 a[234:235], v25 offset:40000
    v_mfma_f32_32x32x16_bf16 v[48:63], a[208:211], a[160:163], v[48:63]
    s_waitcnt lgkmcnt(6)
    ds_read_b64_tr_b16 a[236:237], v25 offset:43072
    ds_read_b64_tr_b16 a[238:239], v25 offset:46144
    v_mfma_f32_32x32x16_bf16 v[48:63], a[212:215], a[164:167], v[48:63]
    ds_read_b64_tr_b16 a[240:241], v27 offset:24640
    ds_read_b64_tr_b16 a[242:243], v27 offset:27712
    s_add_u32 m0, s51, 147456
    s_mov_b32 s85, 37818368
    buffer_load_dwordx4 v64, s[12:15], s85 offen sc1 lds
    v_mfma_f32_32x32x16_bf16 v[48:63], a[216:219], a[168:171], v[48:63]
    ds_read_b64_tr_b16 a[244:245], v27 offset:30784
    ds_read_b64_tr_b16 a[246:247], v27 offset:33856
    v_cvt_pk_bf16_f32 v144, v32, v33
    v_cvt_pk_bf16_f32 v145, v34, v35
    v_cvt_pk_bf16_f32 v146, v36, v37
    v_cvt_pk_bf16_f32 v147, v38, v39
    v_mfma_f32_32x32x16_bf16 v[48:63], a[220:223], a[172:175], v[48:63]
    s_waitcnt lgkmcnt(6)
    ds_read_b64_tr_b16 a[248:249], v27 offset:36928
    ds_read_b64_tr_b16 a[250:251], v27 offset:40000
    v_permlane32_swap_b32 v144, v146
    v_permlane32_swap_b32 v145, v147
    buffer_store_dwordx4 v[144:147], v17, s[12:15], s66 offen offset:0 sc1
    v_mfma_f32_32x32x16_bf16 v[48:63], a[224:227], a[176:179], v[48:63]
    ds_read_b64_tr_b16 a[252:253], v27 offset:43072
    ds_read_b64_tr_b16 a[254:255], v27 offset:46144
    v_cvt_pk_bf16_f32 v148, v40, v41
    v_cvt_pk_bf16_f32 v149, v42, v43
    v_cvt_pk_bf16_f32 v150, v44, v45
    v_cvt_pk_bf16_f32 v151, v46, v47
    v_mfma_f32_32x32x16_bf16 v[48:63], a[228:231], a[180:183], v[48:63]
    ds_read_b64_tr_b16 a[208:209], v24 offset:128
    ds_read_b64_tr_b16 a[210:211], v24 offset:3200
    v_permlane32_swap_b32 v148, v150
    v_permlane32_swap_b32 v149, v151
    buffer_store_dwordx4 v[148:151], v17, s[12:15], s66 offen offset:1024 sc1
    v_mfma_f32_32x32x16_bf16 v[48:63], a[232:235], a[184:187], v[48:63]
    s_waitcnt lgkmcnt(6)
    ds_read_b64_tr_b16 a[212:213], v24 offset:6272
    ds_read_b64_tr_b16 a[214:215], v24 offset:9344
    v_mfma_f32_32x32x16_bf16 v[48:63], a[236:239], a[188:191], v[48:63]
    ds_read_b64_tr_b16 a[216:217], v24 offset:12416
    ds_read_b64_tr_b16 a[218:219], v24 offset:15488
    v_mfma_f32_32x32x16_bf16 v[48:63], a[240:243], a[192:195], v[48:63]
    ds_read_b64_tr_b16 a[220:221], v24 offset:18560
    ds_read_b64_tr_b16 a[222:223], v24 offset:21632
    v_mfma_f32_32x32x16_bf16 v[48:63], a[244:247], a[196:199], v[48:63]
    s_waitcnt lgkmcnt(6)
    ds_read_b64_tr_b16 a[224:225], v24 offset:24704
    ds_read_b64_tr_b16 a[226:227], v24 offset:27776
    v_mfma_f32_32x32x16_bf16 v[48:63], a[248:251], a[200:203], v[48:63]
    ds_read_b64_tr_b16 a[228:229], v24 offset:30848
    ds_read_b64_tr_b16 a[230:231], v24 offset:33920
    v_mfma_f32_32x32x16_bf16 v[48:63], a[252:255], a[204:207], v[48:63]
    ds_read_b64_tr_b16 a[232:233], v24 offset:36992
    ds_read_b64_tr_b16 a[234:235], v24 offset:40064
    v_mfma_f32_32x32x16_bf16 v[96:111], a[208:211], a[160:163], v[96:111]
    s_waitcnt lgkmcnt(6)
    ds_read_b64_tr_b16 a[236:237], v24 offset:43136
    ds_read_b64_tr_b16 a[238:239], v24 offset:46208
    v_mfma_f32_32x32x16_bf16 v[96:111], a[212:215], a[164:167], v[96:111]
    ds_read_b64_tr_b16 a[240:241], v26 offset:24704
    ds_read_b64_tr_b16 a[242:243], v26 offset:27776
    v_mfma_f32_32x32x16_bf16 v[96:111], a[216:219], a[168:171], v[96:111]
    ds_read_b64_tr_b16 a[244:245], v26 offset:30848
    ds_read_b64_tr_b16 a[246:247], v26 offset:33920
    v_cvt_pk_bf16_f32 v152, v48, v49
    v_cvt_pk_bf16_f32 v153, v50, v51
    v_cvt_pk_bf16_f32 v154, v52, v53
    v_cvt_pk_bf16_f32 v155, v54, v55
    v_mfma_f32_32x32x16_bf16 v[96:111], a[220:223], a[172:175], v[96:111]
    s_waitcnt lgkmcnt(6)
    ds_read_b64_tr_b16 a[248:249], v26 offset:36992
    ds_read_b64_tr_b16 a[250:251], v26 offset:40064
    v_permlane32_swap_b32 v152, v154
    v_permlane32_swap_b32 v153, v155
    buffer_store_dwordx4 v[152:155], v17, s[12:15], s66 offen offset:2048 sc1
    v_mfma_f32_32x32x16_bf16 v[96:111], a[224:227], a[176:179], v[96:111]
    ds_read_b64_tr_b16 a[252:253], v26 offset:43136
    ds_read_b64_tr_b16 a[254:255], v26 offset:46208
    v_cvt_pk_bf16_f32 v156, v56, v57
    v_cvt_pk_bf16_f32 v157, v58, v59
    v_cvt_pk_bf16_f32 v158, v60, v61
    v_cvt_pk_bf16_f32 v159, v62, v63
    v_mfma_f32_32x32x16_bf16 v[96:111], a[228:231], a[180:183], v[96:111]
    ds_read_b64_tr_b16 a[208:209], v25 offset:192
    ds_read_b64_tr_b16 a[210:211], v25 offset:3264
    v_permlane32_swap_b32 v156, v158
    v_permlane32_swap_b32 v157, v159
    buffer_store_dwordx4 v[156:159], v17, s[12:15], s67 offen offset:0 sc1
    v_mfma_f32_32x32x16_bf16 v[96:111], a[232:235], a[184:187], v[96:111]
    s_waitcnt lgkmcnt(6)
    ds_read_b64_tr_b16 a[212:213], v25 offset:6336
    ds_read_b64_tr_b16 a[214:215], v25 offset:9408
    v_mfma_f32_32x32x16_bf16 v[96:111], a[236:239], a[188:191], v[96:111]
    ds_read_b64_tr_b16 a[216:217], v25 offset:12480
    ds_read_b64_tr_b16 a[218:219], v25 offset:15552
    v_mfma_f32_32x32x16_bf16 v[96:111], a[240:243], a[192:195], v[96:111]
    ds_read_b64_tr_b16 a[220:221], v25 offset:18624
    ds_read_b64_tr_b16 a[222:223], v25 offset:21696
    v_mfma_f32_32x32x16_bf16 v[96:111], a[244:247], a[196:199], v[96:111]
    s_waitcnt lgkmcnt(6)
    ds_read_b64_tr_b16 a[224:225], v25 offset:24768
    ds_read_b64_tr_b16 a[226:227], v25 offset:27840
    v_mfma_f32_32x32x16_bf16 v[96:111], a[248:251], a[200:203], v[96:111]
    ds_read_b64_tr_b16 a[228:229], v25 offset:30912
    ds_read_b64_tr_b16 a[230:231], v25 offset:33984
    v_mfma_f32_32x32x16_bf16 v[96:111], a[252:255], a[204:207], v[96:111]
    ds_read_b64_tr_b16 a[232:233], v25 offset:37056
    ds_read_b64_tr_b16 a[234:235], v25 offset:40128
    v_mfma_f32_32x32x16_bf16 v[112:127], a[208:211], a[160:163], v[112:127]
    s_waitcnt lgkmcnt(6)
    ds_read_b64_tr_b16 a[236:237], v25 offset:43200
    ds_read_b64_tr_b16 a[238:239], v25 offset:46272
    v_mfma_f32_32x32x16_bf16 v[112:127], a[212:215], a[164:167], v[112:127]
    ds_read_b64_tr_b16 a[240:241], v27 offset:24768
    ds_read_b64_tr_b16 a[242:243], v27 offset:27840
    v_mfma_f32_32x32x16_bf16 v[112:127], a[216:219], a[168:171], v[112:127]
    ds_read_b64_tr_b16 a[244:245], v27 offset:30912
    ds_read_b64_tr_b16 a[246:247], v27 offset:33984
    v_cvt_pk_bf16_f32 v160, v96, v97
    v_cvt_pk_bf16_f32 v161, v98, v99
    v_cvt_pk_bf16_f32 v162, v100, v101
    v_cvt_pk_bf16_f32 v163, v102, v103
    v_mfma_f32_32x32x16_bf16 v[112:127], a[220:223], a[172:175], v[112:127]
    s_waitcnt lgkmcnt(6)
    ds_read_b64_tr_b16 a[248:249], v27 offset:37056
    ds_read_b64_tr_b16 a[250:251], v27 offset:40128
    v_permlane32_swap_b32 v160, v162
    v_permlane32_swap_b32 v161, v163
    buffer_store_dwordx4 v[160:163], v17, s[12:15], s67 offen offset:1024 sc1
    v_mfma_f32_32x32x16_bf16 v[112:127], a[224:227], a[176:179], v[112:127]
    ds_read_b64_tr_b16 a[252:253], v27 offset:43200
    ds_read_b64_tr_b16 a[254:255], v27 offset:46272
    ds_read_b128 v[68:71], v15
    v_cvt_pk_bf16_f32 v164, v104, v105
    v_cvt_pk_bf16_f32 v165, v106, v107
    v_cvt_pk_bf16_f32 v166, v108, v109
    v_mfma_f32_32x32x16_bf16 v[112:127], a[228:231], a[180:183], v[112:127]
    ds_read_b64_tr_b16 a[208:209], v24 offset:256
    ds_read_b64_tr_b16 a[210:211], v24 offset:3328
    v_cvt_pk_bf16_f32 v167, v110, v111
    v_mfma_f32_32x32x16_bf16 v[112:127], a[232:235], a[184:187], v[112:127]
    s_waitcnt lgkmcnt(7)
    ds_read_b64_tr_b16 a[212:213], v24 offset:6400
    ds_read_b64_tr_b16 a[214:215], v24 offset:9472
    v_permlane32_swap_b32 v164, v166
    v_permlane32_swap_b32 v165, v167
    buffer_store_dwordx4 v[164:167], v17, s[12:15], s67 offen offset:2048 sc1
    v_mfma_f32_32x32x16_bf16 v[112:127], a[236:239], a[188:191], v[112:127]
    ds_read_b64_tr_b16 a[216:217], v24 offset:12544
    ds_read_b64_tr_b16 a[218:219], v24 offset:15616
    v_mfma_f32_32x32x16_bf16 v[112:127], a[240:243], a[192:195], v[112:127]
    s_waitcnt lgkmcnt(6)
    v_and_b32 v68, v68, v69
    v_and_b32 v70, v70, v71
    v_and_b32 v68, v68, v70
    v_cmp_ne_u32 vcc, 1, v68
    s_nop 0
    s_cbranch_vccnz L_ynot
    s_lshl_b32 s44, s53, 12
    s_lshl_b32 s43, s52, 1
    s_add_u32 s44, s44, s43
    s_add_u32 s44, s44, 24117248
    s_mul_i32 s85, s36, 3072
    s_add_u32 m0, s85, 98304
    s_lshl_b32 s43, s52, 2
    buffer_load_dwordx4 v65, s[12:15], s44 offen sc1 lds
    s_add_u32 m0, s85, 99328
    s_add_u32 s44, s44, 65536
    buffer_load_dwordx4 v65, s[12:15], s44 offen sc1 lds
    s_add_u32 m0, s85, 100352
    s_add_u32 s44, s44, 65536
    buffer_load_dwordx4 v65, s[12:15], s44 offen sc1 lds
    s_add_u32 s43, s43, 37879808
    buffer_load_dword v72, v75, s[12:15], s43 offen sc1
    s_mov_b32 s75, 1
L_ynot:
    ds_read_b64_tr_b16 a[220:221], v24 offset:18688
    ds_read_b64_tr_b16 a[222:223], v24 offset:21760
    v_mfma_f32_32x32x16_bf16 v[112:127], a[244:247], a[196:199], v[112:127]
    s_waitcnt lgkmcnt(6)
    ds_read_b64_tr_b16 a[224:225], v24 offset:24832
    ds_read_b64_tr_b16 a[226:227], v24 offset:27904
    v_mfma_f32_32x32x16_bf16 v[112:127], a[248:251], a[200:203], v[112:127]
    ds_read_b64_tr_b16 a[228:229], v24 offset:30976
    ds_read_b64_tr_b16 a[230:231], v24 offset:34048
    v_mfma_f32_32x32x16_bf16 v[112:127], a[252:255], a[204:207], v[112:127]
    ds_read_b64_tr_b16 a[232:233], v24 offset:37120
    ds_read_b64_tr_b16 a[234:235], v24 offset:40192
    v_mfma_f32_32x32x16_bf16 v[224:239], a[208:211], a[160:163], v[224:239]
    s_waitcnt lgkmcnt(6)
    ds_read_b64_tr_b16 a[236:237], v24 offset:43264
    ds_read_b64_tr_b16 a[238:239], v24 offset:46336
    v_mfma_f32_32x32x16_bf16 v[224:239], a[212:215], a[164:167], v[224:239]
    ds_read_b64_tr_b16 a[240:241], v26 offset:24832
    ds_read_b64_tr_b16 a[242:243], v26 offset:27904
    v_mfma_f32_32x32x16_bf16 v[224:239], a[216:219], a[168:171], v[224:239]
    ds_read_b64_tr_b16 a[244:245], v26 offset:30976
    ds_read_b64_tr_b16 a[246:247], v26 offset:34048
    v_cvt_pk_bf16_f32 v168, v112, v113
    v_cvt_pk_bf16_f32 v169, v114, v115
    v_cvt_pk_bf16_f32 v170, v116, v117
    v_cvt_pk_bf16_f32 v171, v118, v119
    v_mfma_f32_32x32x16_bf16 v[224:239], a[220:223], a[172:175], v[224:239]
    s_waitcnt lgkmcnt(6)
    ds_read_b64_tr_b16 a[248:249], v26 offset:37120
    ds_read_b64_tr_b16 a[250:251], v26 offset:40192
    v_permlane32_swap_b32 v168, v170
    v_permlane32_swap_b32 v169, v171
    buffer_store_dwordx4 v[168:171], v17, s[12:15], s68 offen offset:0 sc1
    v_mfma_f32_32x32x16_bf16 v[224:239], a[224:227], a[176:179], v[224:239]
    ds_read_b64_tr_b16 a[252:253], v26 offset:43264
    ds_read_b64_tr_b16 a[254:255], v26 offset:46336
    v_cvt_pk_bf16_f32 v172, v120, v121
    v_cvt_pk_bf16_f32 v173, v122, v123
    v_cvt_pk_bf16_f32 v174, v124, v125
    v_cvt_pk_bf16_f32 v175, v126, v127
    v_mfma_f32_32x32x16_bf16 v[224:239], a[228:231], a[180:183], v[224:239]
    ds_read_b64_tr_b16 a[208:209], v25 offset:320
    ds_read_b64_tr_b16 a[210:211], v25 offset:3392
    v_permlane32_swap_b32 v172, v174
    v_permlane32_swap_b32 v173, v175
    buffer_store_dwordx4 v[172:175], v17, s[12:15], s68 offen offset:1024 sc1
    v_mfma_f32_32x32x16_bf16 v[224:239], a[232:235], a[184:187], v[224:239]
    s_waitcnt lgkmcnt(6)
    ds_read_b64_tr_b16 a[212:213], v25 offset:6464
    ds_read_b64_tr_b16 a[214:215], v25 offset:9536
    v_mfma_f32_32x32x16_bf16 v[224:239], a[236:239], a[188:191], v[224:239]
    ds_read_b64_tr_b16 a[216:217], v25 offset:12608
    ds_read_b64_tr_b16 a[218:219], v25 offset:15680
    v_mfma_f32_32x32x16_bf16 v[224:239], a[240:243], a[192:195], v[224:239]
    ds_read_b64_tr_b16 a[220:221], v25 offset:18752
    ds_read_b64_tr_b16 a[222:223], v25 offset:21824
    v_mfma_f32_32x32x16_bf16 v[224:239], a[244:247], a[196:199], v[224:239]
    s_waitcnt lgkmcnt(6)
    ds_read_b64_tr_b16 a[224:225], v25 offset:24896
    ds_read_b64_tr_b16 a[226:227], v25 offset:27968
    v_mfma_f32_32x32x16_bf16 v[224:239], a[248:251], a[200:203], v[224:239]
    ds_read_b64_tr_b16 a[228:229], v25 offset:31040
    ds_read_b64_tr_b16 a[230:231], v25 offset:34112
    v_mfma_f32_32x32x16_bf16 v[224:239], a[252:255], a[204:207], v[224:239]
    ds_read_b64_tr_b16 a[232:233], v25 offset:37184
    ds_read_b64_tr_b16 a[234:235], v25 offset:40256
    v_mfma_f32_32x32x16_bf16 v[240:255], a[208:211], a[160:163], v[240:255]
    s_waitcnt lgkmcnt(6)
    ds_read_b64_tr_b16 a[236:237], v25 offset:43328
    ds_read_b64_tr_b16 a[238:239], v25 offset:46400
    v_mfma_f32_32x32x16_bf16 v[240:255], a[212:215], a[164:167], v[240:255]
    ds_read_b64_tr_b16 a[240:241], v27 offset:24896
    ds_read_b64_tr_b16 a[242:243], v27 offset:27968
    v_mfma_f32_32x32x16_bf16 v[240:255], a[216:219], a[168:171], v[240:255]
    ds_read_b64_tr_b16 a[244:245], v27 offset:31040
    ds_read_b64_tr_b16 a[246:247], v27 offset:34112
    v_cvt_pk_bf16_f32 v176, v224, v225
    v_cvt_pk_bf16_f32 v177, v226, v227
    v_cvt_pk_bf16_f32 v178, v228, v229
    v_cvt_pk_bf16_f32 v179, v230, v231
    v_mfma_f32_32x32x16_bf16 v[240:255], a[220:223], a[172:175], v[240:255]
    s_waitcnt lgkmcnt(6)
    ds_read_b64_tr_b16 a[248:249], v27 offset:37184
    ds_read_b64_tr_b16 a[250:251], v27 offset:40256
    v_permlane32_swap_b32 v176, v178
    v_permlane32_swap_b32 v177, v179
    buffer_store_dwordx4 v[176:179], v17, s[12:15], s68 offen offset:2048 sc1
    v_mfma_f32_32x32x16_bf16 v[240:255], a[224:227], a[176:179], v[240:255]
    ds_read_b64_tr_b16 a[252:253], v27 offset:43328
    ds_read_b64_tr_b16 a[254:255], v27 offset:46400
    v_permlane32_swap_b32 v232, v236
    v_permlane32_swap_b32 v233, v237
    v_permlane32_swap_b32 v234, v238
    v_permlane32_swap_b32 v235, v239
    v_mfma_f32_32x32x16_bf16 v[240:255], a[228:231], a[180:183], v[240:255]
    v_mfma_f32_32x32x16_bf16 v[240:255], a[232:235], a[184:187], v[240:255]
    s_waitcnt lgkmcnt(4)
    v_mfma_f32_32x32x16_bf16 v[240:255], a[236:239], a[188:191], v[240:255]
    v_mfma_f32_32x32x16_bf16 v[240:255], a[240:243], a[192:195], v[240:255]
    v_mov_b32 v31, 1
    s_waitcnt vmcnt(3)
    s_mov_b64 exec, 3
    buffer_store_dword v31, v76, s[12:15], s74 offen sc1
    s_mov_b64 exec, -1
    v_mfma_f32_32x32x16_bf16 v[240:255], a[244:247], a[196:199], v[240:255]
    s_waitcnt lgkmcnt(0)
    v_mfma_f32_32x32x16_bf16 v[240:255], a[248:251], a[200:203], v[240:255]
    v_mfma_f32_32x32x16_bf16 v[240:255], a[252:255], a[204:207], v[240:255]
    v_mov_b32 v31, 1
    s_waitcnt vmcnt(1)
    s_mov_b64 exec, 4
    buffer_store_dword v31, v76, s[12:15], s74 offen sc1
    s_mov_b64 exec, -1
    s_cmp_lg_u32 s75, 0
    s_cbranch_scc1 L_py_out
    s_mov_b32 s43, 0x20000
    s_mov_b32 s44, 37818368
L_py:
    buffer_load_dwordx4 v[68:71], v64, s[12:15], s44 offen sc1
    s_waitcnt vmcnt(0)
    v_and_b32 v68, v68, v69
    v_and_b32 v70, v70, v71
    v_and_b32 v68, v68, v70
    v_cmp_ne_u32 vcc, 1, v68
    s_sub_u32 s43, s43, 1
    s_cbranch_scc1 L_py_go
    s_sleep 1
    s_cbranch_vccnz L_py
L_py_go:
    s_lshl_b32 s44, s53, 12
    s_lshl_b32 s43, s52, 1
    s_add_u32 s44, s44, s43
    s_add_u32 s44, s44, 24117248
    s_mul_i32 s85, s36, 3072
    s_add_u32 m0, s85, 98304
    s_lshl_b32 s43, s52, 2
    buffer_load_dwordx4 v65, s[12:15], s44 offen sc1 lds
    s_add_u32 m0, s85, 99328
    s_add_u32 s44, s44, 65536
    buffer_load_dwordx4 v65, s[12:15], s44 offen sc1 lds
    s_add_u32 m0, s85, 100352
    s_add_u32 s44, s44, 65536
    buffer_load_dwordx4 v65, s[12:15], s44 offen sc1 lds
    s_add_u32 s43, s43, 37879808
    buffer_load_dword v72, v75, s[12:15], s43 offen sc1
    s_waitcnt vmcnt(0)
L_py_out:
    buffer_load_dword v36, v77, s[12:15], s74 offen sc1
    s_mul_i32 s45, s36, 3072
    v_lshrrev_b32 v35, 2, v1
    v_and_b32 v35, 3, v35
    v_lshrrev_b32 v38, 5, v1
    v_lshl_add_u32 v35, v38, 3, v35
    v_lshlrev_b32 v35, 6, v35
    v_and_b32 v37, 16, v1
    v_lshl_add_u32 v35, v37, 1, v35
    v_and_b32 v37, 3, v1
    v_lshl_add_u32 v35, v37, 3, v35
    s_add_u32 s43, s45, 98304
    v_add_u32 v35, s43, v35
    ds_read_b64_tr_b16 v[112:113], v35 offset:0
    ds_read_b64_tr_b16 v[114:115], v35 offset:256
    ds_read_b64_tr_b16 v[116:117], v35 offset:1024
    ds_read_b64_tr_b16 v[118:119], v35 offset:1280
    ds_read_b64_tr_b16 v[120:121], v35 offset:2048
    ds_read_b64_tr_b16 v[122:123], v35 offset:2304
    v_permlane32_swap_b32 v240, v244
    v_permlane32_swap_b32 v241, v245
    v_permlane32_swap_b32 v242, v246
    v_permlane32_swap_b32 v243, v247
    v_permlane32_swap_b32 v248, v252
    v_permlane32_swap_b32 v249, v253
    v_permlane32_swap_b32 v250, v254
    v_permlane32_swap_b32 v251, v255
    v_mul_u32_u24 v40, 1152, v74
    v_lshl_add_u32 v40, v38, 4, v40
    s_mul_i32 s44, s52, 1152
    s_lshl_b32 s43, s53, 1
    s_add_u32 s84, s44, s43
    v_sub_f32 v73, 1.0, v72
    v_mov_b32 v46, 0x3f80
    v_mov_b32 v47, 0x3f800000
    s_waitcnt lgkmcnt(0)
    v_lshlrev_b32 v192, 16, v112
    v_and_b32 v193, 0xffff0000, v112
    v_pk_mul_f32 v[232:233], v[232:233], v[72:73] op_sel:[0,1] op_sel_hi:[1,1]
    v_pk_fma_f32 v[192:193], v[192:193], v[72:73], v[232:233] op_sel_hi:[1,0,1]
    v_lshlrev_b32 v194, 16, v113
    v_and_b32 v195, 0xffff0000, v113
    v_pk_mul_f32 v[234:235], v[234:235], v[72:73] op_sel:[0,1] op_sel_hi:[1,1]
    v_pk_fma_f32 v[194:195], v[194:195], v[72:73], v[234:235] op_sel_hi:[1,0,1]
    v_lshlrev_b32 v196, 16, v114
    v_and_b32 v197, 0xffff0000, v114
    v_pk_mul_f32 v[236:237], v[236:237], v[72:73] op_sel:[0,1] op_sel_hi:[1,1]
    v_pk_fma_f32 v[196:197], v[196:197], v[72:73], v[236:237] op_sel_hi:[1,0,1]
    v_lshlrev_b32 v198, 16, v115
    v_and_b32 v199, 0xffff0000, v115
    v_pk_mul_f32 v[238:239], v[238:239], v[72:73] op_sel:[0,1] op_sel_hi:[1,1]
    v_pk_fma_f32 v[198:199], v[198:199], v[72:73], v[238:239] op_sel_hi:[1,0,1]
    v_lshlrev_b32 v200, 16, v116
    v_and_b32 v201, 0xffff0000, v116
    v_pk_mul_f32 v[240:241], v[240:241], v[72:73] op_sel:[0,1] op_sel_hi:[1,1]
    v_pk_fma_f32 v[200:201], v[200:201], v[72:73], v[240:241] op_sel_hi:[1,0,1]
    v_lshlrev_b32 v202, 16, v117
    v_and_b32 v203, 0xffff0000, v117
    v_pk_mul_f32 v[242:243], v[242:243], v[72:73] op_sel:[0,1] op_sel_hi:[1,1]
    v_pk_fma_f32 v[202:203], v[202:203], v[72:73], v[242:243] op_sel_hi:[1,0,1]
    v_lshlrev_b32 v204, 16, v118
    v_and_b32 v205, 0xffff0000, v118
    v_pk_mul_f32 v[244:245], v[244:245], v[72:73] op_sel:[0,1] op_sel_hi:[1,1]
    v_pk_fma_f32 v[204:205], v[204:205], v[72:73], v[244:245] op_sel_hi:[1,0,1]
    v_lshlrev_b32 v206, 16, v119
    v_and_b32 v207, 0xffff0000, v119
    v_pk_mul_f32 v[246:247], v[246:247], v[72:73] op_sel:[0,1] op_sel_hi:[1,1]
    v_pk_fma_f32 v[206:207], v[206:207], v[72:73], v[246:247] op_sel_hi:[1,0,1]
    v_lshlrev_b32 v208, 16, v120
    v_and_b32 v209, 0xffff0000, v120
    v_pk_mul_f32 v[248:249], v[248:249], v[72:73] op_sel:[0,1] op_sel_hi:[1,1]
    v_pk_fma_f32 v[208:209], v[208:209], v[72:73], v[248:249] op_sel_hi:[1,0,1]
    v_lshlrev_b32 v210, 16, v121
    v_and_b32 v211, 0xffff0000, v121
    v_pk_mul_f32 v[250:251], v[250:251], v[72:73] op_sel:[0,1] op_sel_hi:[1,1]
    v_pk_fma_f32 v[210:211], v[210:211], v[72:73], v[250:251] op_sel_hi:[1,0,1]
    v_lshlrev_b32 v212, 16, v122
    v_and_b32 v213, 0xffff0000, v122
    v_pk_mul_f32 v[252:253], v[252:253], v[72:73] op_sel:[0,1] op_sel_hi:[1,1]
    v_pk_fma_f32 v[212:213], v[212:213], v[72:73], v[252:253] op_sel_hi:[1,0,1]
    v_lshlrev_b32 v214, 16, v123
    v_and_b32 v215, 0xffff0000, v123
    v_pk_mul_f32 v[254:255], v[254:255], v[72:73] op_sel:[0,1] op_sel_hi:[1,1]
    v_pk_fma_f32 v[214:215], v[214:215], v[72:73], v[254:255] op_sel_hi:[1,0,1]
    s_mov_b32 s43, 0x20000
L_pe:
    s_waitcnt vmcnt(0)
    v_cmp_ne_u32 vcc, 1, v36
    s_sub_u32 s43, s43, 1
    s_cbranch_scc1 L_pe_out
    s_and_b32 vcc_lo, vcc_lo, 6
    s_cbranch_scc0 L_pe_out
    buffer_load_dword v36, v77, s[12:15], s74 offen sc1
    s_branch L_pe
L_pe_out:
    v_cmp_ne_u32 vcc, 1, v36
    s_nop 0
    s_and_b32 vcc_lo, vcc_lo, 1
    s_cbranch_scc0 L_all
    buffer_load_dwordx4 v[148:151], v17, s[12:15], s71 offen offset:0 sc1
    buffer_load_dwordx4 v[152:155], v17, s[12:15], s72 offen offset:0 sc1
    buffer_load_dwordx4 v[160:163], v17, s[12:15], s71 offen offset:1024 sc1
    buffer_load_dwordx4 v[164:167], v17, s[12:15], s72 offen offset:1024 sc1
    buffer_load_dwordx4 v[172:175], v17, s[12:15], s71 offen offset:2048 sc1
    buffer_load_dwordx4 v[176:179], v17, s[12:15], s72 offen offset:2048 sc1
    buffer_load_dword v36, v77, s[12:15], s74 offen sc1
    s_waitcnt vmcnt(5)
    v_lshlrev_b32 v48, 16, v148
    v_and_b32 v49, 0xffff0000, v148
    v_lshlrev_b32 v50, 16, v149
    v_and_b32 v51, 0xffff0000, v149
    v_lshlrev_b32 v52, 16, v150
    v_and_b32 v53, 0xffff0000, v150
    v_lshlrev_b32 v54, 16, v151
    v_and_b32 v55, 0xffff0000, v151
    v_dot2c_f32_bf16 v48, v152, v46
    v_dot2c_f32_bf16 v49, v152, v47
    v_dot2c_f32_bf16 v50, v153, v46
    v_dot2c_f32_bf16 v51, v153, v47
    v_dot2c_f32_bf16 v52, v154, v46
    v_dot2c_f32_bf16 v53, v154, v47
    v_dot2c_f32_bf16 v54, v155, v46
    v_dot2c_f32_bf16 v55, v155, v47
    s_nop 1
    v_pk_fma_f32 v[192:193], v[48:49], v[72:73], v[192:193] op_sel:[0,1,0] op_sel_hi:[1,1,1]
    v_pk_fma_f32 v[194:195], v[50:51], v[72:73], v[194:195] op_sel:[0,1,0] op_sel_hi:[1,1,1]
    v_pk_fma_f32 v[196:197], v[52:53], v[72:73], v[196:197] op_sel:[0,1,0] op_sel_hi:[1,1,1]
    v_pk_fma_f32 v[198:199], v[54:55], v[72:73], v[198:199] op_sel:[0,1,0] op_sel_hi:[1,1,1]
    s_waitcnt vmcnt(3)
    v_lshlrev_b32 v48, 16, v160
    v_and_b32 v49, 0xffff0000, v160
    v_lshlrev_b32 v50, 16, v161
    v_and_b32 v51, 0xffff0000, v161
    v_lshlrev_b32 v52, 16, v162
    v_and_b32 v53, 0xffff0000, v162
    v_lshlrev_b32 v54, 16, v163
    v_and_b32 v55, 0xffff0000, v163
    v_dot2c_f32_bf16 v48, v164, v46
    v_dot2c_f32_bf16 v49, v164, v47
    v_dot2c_f32_bf16 v50, v165, v46
    v_dot2c_f32_bf16 v51, v165, v47
    v_dot2c_f32_bf16 v52, v166, v46
    v_dot2c_f32_bf16 v53, v166, v47
    v_dot2c_f32_bf16 v54, v167, v46
    v_dot2c_f32_bf16 v55, v167, v47
    s_nop 1
    v_pk_fma_f32 v[200:201], v[48:49], v[72:73], v[200:201] op_sel:[0,1,0] op_sel_hi:[1,1,1]
    v_pk_fma_f32 v[202:203], v[50:51], v[72:73], v[202:203] op_sel:[0,1,0] op_sel_hi:[1,1,1]
    v_pk_fma_f32 v[204:205], v[52:53], v[72:73], v[204:205] op_sel:[0,1,0] op_sel_hi:[1,1,1]
    v_pk_fma_f32 v[206:207], v[54:55], v[72:73], v[206:207] op_sel:[0,1,0] op_sel_hi:[1,1,1]
    s_waitcnt vmcnt(1)
    v_lshlrev_b32 v48, 16, v172
    v_and_b32 v49, 0xffff0000, v172
    v_lshlrev_b32 v50, 16, v173
    v_and_b32 v51, 0xffff0000, v173
    v_lshlrev_b32 v52, 16, v174
    v_and_b32 v53, 0xffff0000, v174
    v_lshlrev_b32 v54, 16, v175
    v_and_b32 v55, 0xffff0000, v175
    v_dot2c_f32_bf16 v48, v176, v46
    v_dot2c_f32_bf16 v49, v176, v47
    v_dot2c_f32_bf16 v50, v177, v46
    v_dot2c_f32_bf16 v51, v177, v47
    v_dot2c_f32_bf16 v52, v178, v46
    v_dot2c_f32_bf16 v53, v178, v47
    v_dot2c_f32_bf16 v54, v179, v46
    v_dot2c_f32_bf16 v55, v179, v47
    s_nop 1
    v_pk_fma_f32 v[208:209], v[48:49], v[72:73], v[208:209] op_sel:[0,1,0] op_sel_hi:[1,1,1]
    v_pk_fma_f32 v[210:211], v[50:51], v[72:73], v[210:211] op_sel:[0,1,0] op_sel_hi:[1,1,1]
    v_pk_fma_f32 v[212:213], v[52:53], v[72:73], v[212:213] op_sel:[0,1,0] op_sel_hi:[1,1,1]
    v_pk_fma_f32 v[214:215], v[54:55], v[72:73], v[214:215] op_sel:[0,1,0] op_sel_hi:[1,1,1]
L_pl:
    s_waitcnt vmcnt(0)
    v_cmp_ne_u32 vcc, 1, v36
    s_sub_u32 s43, s43, 1
    s_cbranch_scc1 L_pl_out
    s_and_b32 vcc_lo, vcc_lo, 1
    s_cbranch_scc0 L_pl_out
    buffer_load_dword v36, v77, s[12:15], s74 offen sc1
    s_branch L_pl
L_pl_out:
    buffer_load_dwordx4 v[144:147], v17, s[12:15], s70 offen offset:0 sc1
    buffer_load_dwordx4 v[156:159], v17, s[12:15], s70 offen offset:1024 sc1
    buffer_load_dwordx4 v[168:171], v17, s[12:15], s70 offen offset:2048 sc1
    s_waitcnt vmcnt(2)
    v_lshlrev_b32 v48, 16, v144
    v_and_b32 v49, 0xffff0000, v144
    v_lshlrev_b32 v50, 16, v145
    v_and_b32 v51, 0xffff0000, v145
    v_lshlrev_b32 v52, 16, v146
    v_and_b32 v53, 0xffff0000, v146
    v_lshlrev_b32 v54, 16, v147
    v_and_b32 v55, 0xffff0000, v147
    v_pk_fma_f32 v[192:193], v[48:49], v[72:73], v[192:193] op_sel:[0,1,0] op_sel_hi:[1,1,1]
    v_pk_fma_f32 v[194:195], v[50:51], v[72:73], v[194:195] op_sel:[0,1,0] op_sel_hi:[1,1,1]
    v_pk_fma_f32 v[196:197], v[52:53], v[72:73], v[196:197] op_sel:[0,1,0] op_sel_hi:[1,1,1]
    v_pk_fma_f32 v[198:199], v[54:55], v[72:73], v[198:199] op_sel:[0,1,0] op_sel_hi:[1,1,1]
    v_cvt_pk_bf16_f32 v96, v192, v193
    v_cvt_pk_bf16_f32 v97, v194, v195
    v_cvt_pk_bf16_f32 v98, v196, v197
    v_cvt_pk_bf16_f32 v99, v198, v199
    buffer_store_dwordx4 v[96:99], v40, s[24:27], s84 offen offset:0
    s_waitcnt vmcnt(2)
    v_lshlrev_b32 v48, 16, v156
    v_and_b32 v49, 0xffff0000, v156
    v_lshlrev_b32 v50, 16, v157
    v_and_b32 v51, 0xffff0000, v157
    v_lshlrev_b32 v52, 16, v158
    v_and_b32 v53, 0xffff0000, v158
    v_lshlrev_b32 v54, 16, v159
    v_and_b32 v55, 0xffff0000, v159
    v_pk_fma_f32 v[200:201], v[48:49], v[72:73], v[200:201] op_sel:[0,1,0] op_sel_hi:[1,1,1]
    v_pk_fma_f32 v[202:203], v[50:51], v[72:73], v[202:203] op_sel:[0,1,0] op_sel_hi:[1,1,1]
    v_pk_fma_f32 v[204:205], v[52:53], v[72:73], v[204:205] op_sel:[0,1,0] op_sel_hi:[1,1,1]
    v_pk_fma_f32 v[206:207], v[54:55], v[72:73], v[206:207] op_sel:[0,1,0] op_sel_hi:[1,1,1]
    v_cvt_pk_bf16_f32 v100, v200, v201
    v_cvt_pk_bf16_f32 v101, v202, v203
    v_cvt_pk_bf16_f32 v102, v204, v205
    v_cvt_pk_bf16_f32 v103, v206, v207
    buffer_store_dwordx4 v[100:103], v40, s[24:27], s84 offen offset:32
    s_waitcnt vmcnt(2)
    v_lshlrev_b32 v48, 16, v168
    v_and_b32 v49, 0xffff0000, v168
    v_lshlrev_b32 v50, 16, v169
    v_and_b32 v51, 0xffff0000, v169
    v_lshlrev_b32 v52, 16, v170
    v_and_b32 v53, 0xffff0000, v170
    v_lshlrev_b32 v54, 16, v171
    v_and_b32 v55, 0xffff0000, v171
    v_pk_fma_f32 v[208:209], v[48:49], v[72:73], v[208:209] op_sel:[0,1,0] op_sel_hi:[1,1,1]
    v_pk_fma_f32 v[210:211], v[50:51], v[72:73], v[210:211] op_sel:[0,1,0] op_sel_hi:[1,1,1]
    v_pk_fma_f32 v[212:213], v[52:53], v[72:73], v[212:213] op_sel:[0,1,0] op_sel_hi:[1,1,1]
    v_pk_fma_f32 v[214:215], v[54:55], v[72:73], v[214:215] op_sel:[0,1,0] op_sel_hi:[1,1,1]
    v_cvt_pk_bf16_f32 v104, v208, v209
    v_cvt_pk_bf16_f32 v105, v210, v211
    v_cvt_pk_bf16_f32 v106, v212, v213
    v_cvt_pk_bf16_f32 v107, v214, v215
    buffer_store_dwordx4 v[104:107], v40, s[24:27], s84 offen offset:64
    s_branch L_fin
L_all:
    buffer_load_dwordx4 v[144:147], v17, s[12:15], s70 offen offset:0 sc1
    buffer_load_dwordx4 v[148:151], v17, s[12:15], s71 offen offset:0 sc1
    buffer_load_dwordx4 v[152:155], v17, s[12:15], s72 offen offset:0 sc1
    buffer_load_dwordx4 v[156:159], v17, s[12:15], s70 offen offset:1024 sc1
    buffer_load_dwordx4 v[160:163], v17, s[12:15], s71 offen offset:1024 sc1
    buffer_load_dwordx4 v[164:167], v17, s[12:15], s72 offen offset:1024 sc1
    buffer_load_dwordx4 v[168:171], v17, s[12:15], s70 offen offset:2048 sc1
    buffer_load_dwordx4 v[172:175], v17, s[12:15], s71 offen offset:2048 sc1
    buffer_load_dwordx4 v[176:179], v17, s[12:15], s72 offen offset:2048 sc1
    s_waitcnt vmcnt(6)
    v_lshlrev_b32 v48, 16, v148
    v_and_b32 v49, 0xffff0000, v148
    v_lshlrev_b32 v50, 16, v149
    v_and_b32 v51, 0xffff0000, v149
    v_lshlrev_b32 v52, 16, v150
    v_and_b32 v53, 0xffff0000, v150
    v_lshlrev_b32 v54, 16, v151
    v_and_b32 v55, 0xffff0000, v151
    v_dot2c_f32_bf16 v48, v152, v46
    v_dot2c_f32_bf16 v49, v152, v47
    v_dot2c_f32_bf16 v50, v153, v46
    v_dot2c_f32_bf16 v51, v153, v47
    v_dot2c_f32_bf16 v52, v154, v46
    v_dot2c_f32_bf16 v53, v154, v47
    v_dot2c_f32_bf16 v54, v155, v46
    v_dot2c_f32_bf16 v55, v155, v47
    s_nop 1
    v_pk_fma_f32 v[192:193], v[48:49], v[72:73], v[192:193] op_sel:[0,1,0] op_sel_hi:[1,1,1]
    v_pk_fma_f32 v[194:195], v[50:51], v[72:73], v[194:195] op_sel:[0,1,0] op_sel_hi:[1,1,1]
    v_pk_fma_f32 v[196:197], v[52:53], v[72:73], v[196:197] op_sel:[0,1,0] op_sel_hi:[1,1,1]
    v_pk_fma_f32 v[198:199], v[54:55], v[72:73], v[198:199] op_sel:[0,1,0] op_sel_hi:[1,1,1]
    v_lshlrev_b32 v48, 16, v144
    v_and_b32 v49, 0xffff0000, v144
    v_lshlrev_b32 v50, 16, v145
    v_and_b32 v51, 0xffff0000, v145
    v_lshlrev_b32 v52, 16, v146
    v_and_b32 v53, 0xffff0000, v146
    v_lshlrev_b32 v54, 16, v147
    v_and_b32 v55, 0xffff0000, v147
    v_pk_fma_f32 v[192:193], v[48:49], v[72:73], v[192:193] op_sel:[0,1,0] op_sel_hi:[1,1,1]
    v_pk_fma_f32 v[194:195], v[50:51], v[72:73], v[194:195] op_sel:[0,1,0] op_sel_hi:[1,1,1]
    v_pk_fma_f32 v[196:197], v[52:53], v[72:73], v[196:197] op_sel:[0,1,0] op_sel_hi:[1,1,1]
    v_pk_fma_f32 v[198:199], v[54:55], v[72:73], v[198:199] op_sel:[0,1,0] op_sel_hi:[1,1,1]
    v_cvt_pk_bf16_f32 v96, v192, v193
    v_cvt_pk_bf16_f32 v97, v194, v195
    v_cvt_pk_bf16_f32 v98, v196, v197
    v_cvt_pk_bf16_f32 v99, v198, v199
    buffer_store_dwordx4 v[96:99], v40, s[24:27], s84 offen offset:0
    s_waitcnt vmcnt(4)
    v_lshlrev_b32 v48, 16, v160
    v_and_b32 v49, 0xffff0000, v160
    v_lshlrev_b32 v50, 16, v161
    v_and_b32 v51, 0xffff0000, v161
    v_lshlrev_b32 v52, 16, v162
    v_and_b32 v53, 0xffff0000, v162
    v_lshlrev_b32 v54, 16, v163
    v_and_b32 v55, 0xffff0000, v163
    v_dot2c_f32_bf16 v48, v164, v46
    v_dot2c_f32_bf16 v49, v164, v47
    v_dot2c_f32_bf16 v50, v165, v46
    v_dot2c_f32_bf16 v51, v165, v47
    v_dot2c_f32_bf16 v52, v166, v46
    v_dot2c_f32_bf16 v53, v166, v47
    v_dot2c_f32_bf16 v54, v167, v46
    v_dot2c_f32_bf16 v55, v167, v47
    s_nop 1
    v_pk_fma_f32 v[200:201], v[48:49], v[72:73], v[200:201] op_sel:[0,1,0] op_sel_hi:[1,1,1]
    v_pk_fma_f32 v[202:203], v[50:51], v[72:73], v[202:203] op_sel:[0,1,0] op_sel_hi:[1,1,1]
    v_pk_fma_f32 v[204:205], v[52:53], v[72:73], v[204:205] op_sel:[0,1,0] op_sel_hi:[1,1,1]
    v_pk_fma_f32 v[206:207], v[54:55], v[72:73], v[206:207] op_sel:[0,1,0] op_sel_hi:[1,1,1]
    v_lshlrev_b32 v48, 16, v156
    v_and_b32 v49, 0xffff0000, v156
    v_lshlrev_b32 v50, 16, v157
    v_and_b32 v51, 0xffff0000, v157
    v_lshlrev_b32 v52, 16, v158
    v_and_b32 v53, 0xffff0000, v158
    v_lshlrev_b32 v54, 16, v159
    v_and_b32 v55, 0xffff0000, v159
    v_pk_fma_f32 v[200:201], v[48:49], v[72:73], v[200:201] op_sel:[0,1,0] op_sel_hi:[1,1,1]
    v_pk_fma_f32 v[202:203], v[50:51], v[72:73], v[202:203] op_sel:[0,1,0] op_sel_hi:[1,1,1]
    v_pk_fma_f32 v[204:205], v[52:53], v[72:73], v[204:205] op_sel:[0,1,0] op_sel_hi:[1,1,1]
    v_pk_fma_f32 v[206:207], v[54:55], v[72:73], v[206:207] op_sel:[0,1,0] op_sel_hi:[1,1,1]
    v_cvt_pk_bf16_f32 v100, v200, v201
    v_cvt_pk_bf16_f32 v101, v202, v203
    v_cvt_pk_bf16_f32 v102, v204, v205
    v_cvt_pk_bf16_f32 v103, v206, v207
    buffer_store_dwordx4 v[100:103], v40, s[24:27], s84 offen offset:32
    s_waitcnt vmcnt(2)
    v_lshlrev_b32 v48, 16, v172
    v_and_b32 v49, 0xffff0000, v172
    v_lshlrev_b32 v50, 16, v173
    v_and_b32 v51, 0xffff0000, v173
    v_lshlrev_b32 v52, 16, v174
    v_and_b32 v53, 0xffff0000, v174
    v_lshlrev_b32 v54, 16, v175
    v_and_b32 v55, 0xffff0000, v175
    v_dot2c_f32_bf16 v48, v176, v46
    v_dot2c_f32_bf16 v49, v176, v47
    v_dot2c_f32_bf16 v50, v177, v46
    v_dot2c_f32_bf16 v51, v177, v47
    v_dot2c_f32_bf16 v52, v178, v46
    v_dot2c_f32_bf16 v53, v178, v47
    v_dot2c_f32_bf16 v54, v179, v46
    v_dot2c_f32_bf16 v55, v179, v47
    s_nop 1
    v_pk_fma_f32 v[208:209], v[48:49], v[72:73], v[208:209] op_sel:[0,1,0] op_sel_hi:[1,1,1]
    v_pk_fma_f32 v[210:211], v[50:51], v[72:73], v[210:211] op_sel:[0,1,0] op_sel_hi:[1,1,1]
    v_pk_fma_f32 v[212:213], v[52:53], v[72:73], v[212:213] op_sel:[0,1,0] op_sel_hi:[1,1,1]
    v_pk_fma_f32 v[214:215], v[54:55], v[72:73], v[214:215] op_sel:[0,1,0] op_sel_hi:[1,1,1]
    v_lshlrev_b32 v48, 16, v168
    v_and_b32 v49, 0xffff0000, v168
    v_lshlrev_b32 v50, 16, v169
    v_and_b32 v51, 0xffff0000, v169
    v_lshlrev_b32 v52, 16, v170
    v_and_b32 v53, 0xffff0000, v170
    v_lshlrev_b32 v54, 16, v171
    v_and_b32 v55, 0xffff0000, v171
    v_pk_fma_f32 v[208:209], v[48:49], v[72:73], v[208:209] op_sel:[0,1,0] op_sel_hi:[1,1,1]
    v_pk_fma_f32 v[210:211], v[50:51], v[72:73], v[210:211] op_sel:[0,1,0] op_sel_hi:[1,1,1]
    v_pk_fma_f32 v[212:213], v[52:53], v[72:73], v[212:213] op_sel:[0,1,0] op_sel_hi:[1,1,1]
    v_pk_fma_f32 v[214:215], v[54:55], v[72:73], v[214:215] op_sel:[0,1,0] op_sel_hi:[1,1,1]
    v_cvt_pk_bf16_f32 v104, v208, v209
    v_cvt_pk_bf16_f32 v105, v210, v211
    v_cvt_pk_bf16_f32 v106, v212, v213
    v_cvt_pk_bf16_f32 v107, v214, v215
    buffer_store_dwordx4 v[104:107], v40, s[24:27], s84 offen offset:64
L_fin:
    s_endpgm
L_conv:
    s_load_dwordx2 s[4:5], s[0:1], 0
    s_load_dwordx2 s[32:33], s[0:1], 64
    s_load_dwordx2 s[12:13], s[0:1], 112
    s_load_dwordx2 s[16:17], s[0:1], 80
    s_load_dwordx2 s[28:29], s[0:1], 104
    s_getpc_b64 s[54:55]
L_cpf_pc:
    s_sub_u32 s54, s54, L_cpf_pc-L_start
    s_subb_u32 s55, s55, 0
    v_lshrrev_b32 v2, 6, v0
    s_lshr_b32 s3, s2, 5
    s_lshl_b32 s3, s3, 2
    v_add_u32 v2, s3, v2
    v_and_b32 v2, 7, v2
    v_lshlrev_b32 v2, 13, v2
    v_and_b32 v3, 63, v0
    v_lshl_add_u32 v2, v3, 7, v2
    v_min_u32 v2, L_codeend-L_start-4, v2
    v_and_b32 v2, -4, v2
    global_load_dword a255, v2, s[54:55]
    s_and_b32 s3, s2, 7
    s_lshr_b32 s38, s3, 1
    s_and_b32 s3, s3, 1
    s_lshl_b32 s3, s3, 3
    s_lshr_b32 s40, s2, 5
    s_add_u32 s37, s40, s3
    s_lshr_b32 s39, s2, 3
    s_and_b32 s39, s39, 3
    v_lshrrev_b32 v2, 6, v0
    v_and_b32 v1, 63, v0
    v_readfirstlane_b32 s36, v2
    v_lshlrev_b32 v17, 4, v1
    s_lshl_b32 s43, s37, 2
    s_add_u32 s43, s43, s38
    s_lshl_b32 s48, s43, 2
    s_lshl_b32 s42, s43, 3
    s_add_u32 s42, s42, s39
    s_lshl_b32 s42, s42, 2
    s_add_u32 s42, s42, s36
    s_lshl_b32 s42, s42, 2
    s_add_u32 s42, s42, 37748736
    s_add_u32 s48, s48, s36
    s_mul_i32 s48, s48, 73728
    s_mul_i32 s43, s39, 24576
    s_add_u32 s48, s48, s43
    v_mov_b32 v31, 0
    s_waitcnt lgkmcnt(0)
    s_mov_b32 s6, 0x240000
    s_mov_b32 s7, 0x00020000
    s_mov_b32 s14, 0x10000000
    s_mov_b32 s15, 0x00020000
    s_mov_b32 s18, 0x510000
    s_mov_b32 s19, 0x00020000
    s_mov_b32 s30, 0x100
    s_mov_b32 s31, 0x00020000
    s_mov_b32 s34, s12
    s_mov_b32 s35, s13
    s_and_b32 s43, s42, 0xffffff80
    v_lshrrev_b32 v2, 4, v1
    v_lshlrev_b32 v2, 13, v2
    v_and_b32 v3, 15, v1
    v_lshl_add_u32 v2, v3, 2, v2
    v_add_u32 v2, s43, v2
    s_mul_i32 s43, s37, 12
    s_add_u32 s43, s43, s38
    s_lshl_b32 s43, s43, 9
    s_add_u32 s43, s43, 38010880
    v_min_u32 v4, 47, v1
    v_lshrrev_b32 v4, 4, v4
    v_lshlrev_b32 v4, 11, v4
    v_lshrrev_b32 v5, 2, v3
    v_lshl_add_u32 v4, v5, 7, v4
    v_and_b32 v3, 3, v3
    v_lshl_add_u32 v3, v3, 2, v4
    s_cmp_lg_u32 s36, 0
    s_cbranch_scc1 L_nz
    buffer_store_dword v31, v2, s[12:15], 0 offen sc1
    buffer_store_dword v31, v3, s[12:15], s43 offen sc1
L_nz:
    s_lshr_b32 s42, s42, 7
    s_and_b32 s42, s42, 63
    s_lshl_b32 s42, s42, 2
    s_add_u32 s42, s42, s36
    s_lshl_b32 s42, s42, 2
    s_add_u32 s42, s42, 37814272
    s_cmp_lg_u32 s36, 0
    s_cbranch_scc1 L_nz3
    v_and_b32 v2, 4, v1
    v_lshlrev_b32 v2, 10, v2
    v_and_b32 v3, 3, v1
    v_lshl_add_u32 v2, v3, 2, v2
    buffer_store_dword v31, v2, s[12:15], s42 offen sc1
L_nz3:
    s_load_dwordx2 s[68:69], s[0:1], 8
    s_load_dwordx2 s[72:73], s[0:1], 16
    s_load_dwordx2 s[20:21], s[0:1], 24
    s_load_dwordx2 s[24:25], s[0:1], 32
    s_load_dwordx2 s[76:77], s[0:1], 40
    s_load_dwordx2 s[80:81], s[0:1], 48
    s_load_dwordx2 s[84:85], s[0:1], 88
    s_lshl_b32 s56, s37, 2
    s_add_u32 s56, s56, s38
    s_mul_i32 s56, s56, 9
    s_mul_i32 s57, s36, 40960
    s_mov_b32 s70, 147456
    s_mov_b32 s71, 0x00020000
    s_mov_b32 s74, 147456
    s_mov_b32 s75, 0x00020000
    s_mov_b32 s22, 147456
    s_mov_b32 s23, 0x00020000
    s_mov_b32 s26, 147456
    s_mov_b32 s27, 0x00020000
    s_mov_b32 s78, 1152
    s_mov_b32 s79, 0x00020000
    s_mov_b32 s82, 1152
    s_mov_b32 s83, 0x00020000
    v_lshlrev_b32 v236, 2, v1
    v_min_u32 v237, 8, v1
    v_add_u32 v237, s56, v237
    v_lshlrev_b32 v237, 1, v237
    s_add_u32 s43, s56, s36
    s_lshl_b32 s43, s43, 8
    s_add_u32 s44, s56, 8
    s_lshl_b32 s44, s44, 8
    s_lshl_b32 s52, s37, 7
    s_lshl_b32 s45, s38, 5
    s_add_u32 s52, s52, s45
    v_lshrrev_b32 v240, 3, v1
    v_and_b32 v241, 7, v1
    v_add_u32 v242, s52, v240
    v_mul_u32_u24 v242, 1152, v242
    v_lshrrev_b32 v243, 1, v240
    v_xor_b32 v243, v243, v241
    v_lshl_add_u32 v2, v243, 4, v242
    v_xor_b32 v3, 64, v2
    v_add_u32 v3, 8192, v3
    s_lshl_b32 s52, s52, 1
    s_waitcnt lgkmcnt(0)
    buffer_load_dword v100, v236, s[68:71], s44 offen offset:0
    buffer_load_dword v101, v236, s[72:75], s44 offen offset:0
    buffer_load_dword v102, v236, s[20:23], s44 offen offset:0
    buffer_load_dword v103, v236, s[24:27], s44 offen offset:0
    buffer_load_dword v104, v236, s[68:71], s43 offen offset:0
    buffer_load_dword v105, v236, s[72:75], s43 offen offset:0
    buffer_load_dword v106, v236, s[20:23], s43 offen offset:0
    buffer_load_dword v107, v236, s[24:27], s43 offen offset:0
    buffer_load_dword v108, v236, s[68:71], s43 offen offset:1024
    buffer_load_dword v109, v236, s[72:75], s43 offen offset:1024
    buffer_load_dword v110, v236, s[20:23], s43 offen offset:1024
    buffer_load_dword v111, v236, s[24:27], s43 offen offset:1024
    buffer_load_ushort v4, v237, s[76:79], 0 offen
    buffer_load_ushort v5, v237, s[80:83], 0 offen
    s_getpc_b64 s[54:55]
L_kg_pc:
    s_add_u32 s54, s54, L_atab-L_kg_pc
    s_addc_u32 s55, s55, 0
    v_and_b32 v238, 48, v1
    global_load_dwordx4 v[52:55], v238, s[54:55] offset:0
    global_load_dwordx4 v[56:59], v238, s[54:55] offset:64
    global_load_dwordx4 v[60:63], v238, s[54:55] offset:128
    s_cmp_eq_u32 s36, 0
    s_cbranch_scc1 L_xp_skip
    s_mov_b32 s80, s84
    s_mov_b32 s81, s85
    s_mul_i32 s53, s36, 3
    s_sub_u32 s53, s53, 3
    s_add_u32 m0, s57, 8960
    s_add_u32 s47, s53, 0
    s_lshl_b32 s47, s47, 7
    buffer_load_dwordx4 v2, s[4:7], s47 offen offset:0 lds
    buffer_load_dwordx4 v3, s[4:7], s47 offen offset:1024 lds
    s_add_u32 s47, s47, 16384
    buffer_load_dwordx4 v2, s[4:7], s47 offen offset:2048 lds
    buffer_load_dwordx4 v3, s[4:7], s47 offen offset:3072 lds
    s_add_u32 m0, s57, 13056
    s_add_u32 s47, s53, 1
    s_lshl_b32 s47, s47, 7
    buffer_load_dwordx4 v2, s[4:7], s47 offen offset:0 lds
    buffer_load_dwordx4 v3, s[4:7], s47 offen offset:1024 lds
    s_add_u32 s47, s47, 16384
    buffer_load_dwordx4 v2, s[4:7], s47 offen offset:2048 lds
    buffer_load_dwordx4 v3, s[4:7], s47 offen offset:3072 lds
    s_add_u32 m0, s57, 17152
    s_add_u32 s47, s53, 2
    s_lshl_b32 s47, s47, 7
    buffer_load_dwordx4 v2, s[4:7], s47 offen offset:0 lds
    buffer_load_dwordx4 v3, s[4:7], s47 offen offset:1024 lds
    s_add_u32 s47, s47, 16384
    buffer_load_dwordx4 v2, s[4:7], s47 offen offset:2048 lds
    buffer_load_dwordx4 v3, s[4:7], s47 offen offset:3072 lds
    v_and_b32 v239, 1, v1
    v_lshlrev_b32 v239, 6, v239
    s_lshl_b32 s47, s53, 7
    buffer_load_dwordx4 v[180:183], v239, s[80:83], s47 offen offset:0
    buffer_load_dwordx4 v[184:187], v239, s[80:83], s47 offen offset:16
    buffer_load_dwordx4 v[188:191], v239, s[80:83], s47 offen offset:32
    buffer_load_dwordx4 v[192:195], v239, s[80:83], s47 offen offset:48
    buffer_load_dwordx4 v[196:199], v239, s[80:83], s47 offen offset:128
    buffer_load_dwordx4 v[200:203], v239, s[80:83], s47 offen offset:144
    buffer_load_dwordx4 v[204:207], v239, s[80:83], s47 offen offset:160
    buffer_load_dwordx4 v[208:211], v239, s[80:83], s47 offen offset:176
    buffer_load_dwordx4 v[212:215], v239, s[80:83], s47 offen offset:256
    buffer_load_dwordx4 v[216:219], v239, s[80:83], s47 offen offset:272
    buffer_load_dwordx4 v[220:223], v239, s[80:83], s47 offen offset:288
    buffer_load_dwordx4 v[224:227], v239, s[80:83], s47 offen offset:304
L_xp_skip:
    s_mul_i32 s43, s38, 2304
    s_add_u32 s8, s32, s43
    s_addc_u32 s9, s33, 0
    s_mov_b32 s10, 5301504
    s_mov_b32 s11, 0x00020000
    v_mul_u32_u24 v6, 9216, v1
    s_lshl_b32 s46, s40, 2
    s_add_u32 s46, s46, s36
    s_mul_i32 s43, s46, 57
    s_lshr_b32 s43, s43, 9
    s_mul_i32 s44, s43, 9
    s_sub_u32 s44, s46, s44
    s_mul_i32 s44, s44, 589824
    s_mul_i32 s43, s43, 768
    s_add_u32 s44, s44, s43
    s_add_u32 s44, s44, 128
    s_cmp_lt_u32 s46, 27
    s_cselect_b32 s44, s44, 0x40000000
    buffer_load_dword a199, v6, s[8:11], s44 offen
    s_mul_i32 s43, s38, 1327104
    s_add_u32 s72, s16, s43
    s_addc_u32 s73, s17, 0
    s_mov_b32 s74, 1327104
    s_mov_b32 s75, 0x00020000
    v_lshlrev_b32 v6, 7, v1
    s_lshl_b32 s46, s40, 2
    s_add_u32 s46, s46, s36
    s_mul_i32 s43, s46, 57
    s_lshr_b32 s43, s43, 9
    s_mul_i32 s43, s43, 368640
    s_lshl_b32 s44, s46, 13
    s_add_u32 s81, s43, s44
    s_lshr_b32 s43, s37, 3
    s_mul_i32 s44, s43, 73728
    s_add_u32 s44, s44, s81
    s_add_u32 s76, s44, 73728
    s_add_u32 s77, s44, 221184
    s_add_u32 s78, s81, 368640
    s_cmp_eq_u32 s43, 0
    s_cselect_b32 s78, s78, s81
    s_mov_b32 s60, 0x3fb8aa3b
    s_mov_b32 s61, 0x32a57060
    s_mov_b32 s62, 0x3f317218
    s_add_u32 s43, s57, 8960
    v_lshrrev_b32 v240, 1, v1
    v_and_b32 v241, 1, v1
    v_lshlrev_b32 v241, 3, v241
    v_add_u32 v241, s43, v241
    v_xor_b32 v32, 0, v240
    v_lshl_add_u32 v32, v32, 4, v241
    v_xor_b32 v33, 33, v240
    v_lshl_add_u32 v33, v33, 4, v241
    v_xor_b32 v34, 66, v240
    v_lshl_add_u32 v34, v34, 4, v241
    v_xor_b32 v35, 99, v240
    v_lshl_add_u32 v35, v35, 4, v241
    v_xor_b32 v36, 132, v240
    v_lshl_add_u32 v36, v36, 4, v241
    v_xor_b32 v37, 165, v240
    v_lshl_add_u32 v37, v37, 4, v241
    v_xor_b32 v38, 198, v240
    v_lshl_add_u32 v38, v38, 4, v241
    v_xor_b32 v39, 231, v240
    v_lshl_add_u32 v39, v39, 4, v241
    v_xor_b32 v40, 264, v240
    v_lshl_add_u32 v40, v40, 4, v241
    v_xor_b32 v41, 297, v240
    v_lshl_add_u32 v41, v41, 4, v241
    v_xor_b32 v42, 330, v240
    v_lshl_add_u32 v42, v42, 4, v241
    v_xor_b32 v43, 363, v240
    v_lshl_add_u32 v43, v43, 4, v241
    v_xor_b32 v44, 396, v240
    v_lshl_add_u32 v44, v44, 4, v241
    v_xor_b32 v45, 429, v240
    v_lshl_add_u32 v45, v45, 4, v241
    v_xor_b32 v46, 462, v240
    v_lshl_add_u32 v46, v46, 4, v241
    v_xor_b32 v47, 495, v240
    v_lshl_add_u32 v47, v47, 4, v241
    v_and_b32 v242, 15, v1
    v_lshrrev_b32 v243, 4, v1
    v_xor_b32 v243, v243, v242
    v_lshlrev_b32 v244, 9, v242
    v_add_u32 v244, s43, v244
    v_xor_b32 v48, 0, v243
    v_lshl_add_u32 v48, v48, 4, v244
    v_xor_b32 v49, 4, v243
    v_lshl_add_u32 v49, v49, 4, v244
    v_xor_b32 v50, 8, v243
    v_lshl_add_u32 v50, v50, 4, v244
    v_xor_b32 v51, 12, v243
    v_lshl_add_u32 v51, v51, 4, v244
    s_add_u32 s44, s57, 17920
    v_lshlrev_b32 v245, 3, v1
    v_sub_u32 v245, 2047, v245
    v_subrev_u32 v64, 0, v245
    v_subrev_u32 v65, 1, v245
    v_subrev_u32 v66, 2, v245
    v_subrev_u32 v67, 3, v245
    v_subrev_u32 v68, 4, v245
    v_subrev_u32 v69, 5, v245
    v_subrev_u32 v70, 6, v245
    v_subrev_u32 v71, 7, v245
    v_subrev_u32 v72, 8, v245
    v_cvt_f32_u32 v64, v64
    v_cvt_f32_u32 v65, v65
    v_cvt_f32_u32 v66, v66
    v_cvt_f32_u32 v67, v67
    v_cvt_f32_u32 v68, v68
    v_cvt_f32_u32 v69, v69
    v_cvt_f32_u32 v70, v70
    v_cvt_f32_u32 v71, v71
    v_cvt_f32_u32 v72, v72
    v_subrev_u32 v73, 512, v245
    v_subrev_u32 v74, 513, v245
    v_subrev_u32 v75, 514, v245
    v_subrev_u32 v76, 515, v245
    v_subrev_u32 v77, 516, v245
    v_subrev_u32 v78, 517, v245
    v_subrev_u32 v79, 518, v245
    v_subrev_u32 v80, 519, v245
    v_subrev_u32 v81, 520, v245
    v_cvt_f32_u32 v73, v73
    v_cvt_f32_u32 v74, v74
    v_cvt_f32_u32 v75, v75
    v_cvt_f32_u32 v76, v76
    v_cvt_f32_u32 v77, v77
    v_cvt_f32_u32 v78, v78
    v_cvt_f32_u32 v79, v79
    v_cvt_f32_u32 v80, v80
    v_cvt_f32_u32 v81, v81
    v_subrev_u32 v82, 1024, v245
    v_subrev_u32 v83, 1025, v245
    v_subrev_u32 v84, 1026, v245
    v_subrev_u32 v85, 1027, v245
    v_subrev_u32 v86, 1028, v245
    v_subrev_u32 v87, 1029, v245
    v_subrev_u32 v88, 1030, v245
    v_subrev_u32 v89, 1031, v245
    v_subrev_u32 v90, 1032, v245
    v_cvt_f32_u32 v82, v82
    v_cvt_f32_u32 v83, v83
    v_cvt_f32_u32 v84, v84
    v_cvt_f32_u32 v85, v85
    v_cvt_f32_u32 v86, v86
    v_cvt_f32_u32 v87, v87
    v_cvt_f32_u32 v88, v88
    v_cvt_f32_u32 v89, v89
    v_cvt_f32_u32 v90, v90
    v_subrev_u32 v91, 1536, v245
    v_subrev_u32 v92, 1537, v245
    v_subrev_u32 v93, 1538, v245
    v_subrev_u32 v94, 1539, v245
    v_subrev_u32 v95, 1540, v245
    v_subrev_u32 v96, 1541, v245
    v_subrev_u32 v97, 1542, v245
    v_subrev_u32 v98, 1543, v245
    v_subrev_u32 v99, 1544, v245
    v_max_i32 v99, 0, v99
    v_cvt_f32_u32 v91, v91
    v_cvt_f32_u32 v92, v92
    v_cvt_f32_u32 v93, v93
    v_cvt_f32_u32 v94, v94
    v_cvt_f32_u32 v95, v95
    v_cvt_f32_u32 v96, v96
    v_cvt_f32_u32 v97, v97
    v_cvt_f32_u32 v98, v98
    v_cvt_f32_u32 v99, v99
    v_cvt_pk_bf16_f32 v65, v64, v65
    v_cvt_pk_bf16_f32 v67, v66, v67
    v_cvt_pk_bf16_f32 v69, v68, v69
    v_cvt_pk_bf16_f32 v71, v70, v71
    v_cvt_pk_bf16_f32 v73, v72, v73
    v_cvt_pk_bf16_f32 v75, v74, v75
    v_cvt_pk_bf16_f32 v77, v76, v77
    v_cvt_pk_bf16_f32 v79, v78, v79
    v_cvt_pk_bf16_f32 v81, v80, v81
    v_cvt_pk_bf16_f32 v83, v82, v83
    v_cvt_pk_bf16_f32 v85, v84, v85
    v_cvt_pk_bf16_f32 v87, v86, v87
    v_cvt_pk_bf16_f32 v89, v88, v89
    v_cvt_pk_bf16_f32 v91, v90, v91
    v_cvt_pk_bf16_f32 v93, v92, v93
    v_cvt_pk_bf16_f32 v95, v94, v95
    v_cvt_pk_bf16_f32 v97, v96, v97
    v_cvt_pk_bf16_f32 v99, v98, v99
    v_lshlrev_b32 v64, 16, v65
    v_and_b32 v65, 0xffff0000, v65
    v_lshlrev_b32 v66, 16, v67
    v_and_b32 v67, 0xffff0000, v67
    v_lshlrev_b32 v68, 16, v69
    v_and_b32 v69, 0xffff0000, v69
    v_lshlrev_b32 v70, 16, v71
    v_and_b32 v71, 0xffff0000, v71
    v_lshlrev_b32 v72, 16, v73
    v_and_b32 v73, 0xffff0000, v73
    v_lshlrev_b32 v74, 16, v75
    v_and_b32 v75, 0xffff0000, v75
    v_lshlrev_b32 v76, 16, v77
    v_and_b32 v77, 0xffff0000, v77
    v_lshlrev_b32 v78, 16, v79
    v_and_b32 v79, 0xffff0000, v79
    v_lshlrev_b32 v80, 16, v81
    v_and_b32 v81, 0xffff0000, v81
    v_lshlrev_b32 v82, 16, v83
    v_and_b32 v83, 0xffff0000, v83
    v_lshlrev_b32 v84, 16, v85
    v_and_b32 v85, 0xffff0000, v85
    v_lshlrev_b32 v86, 16, v87
    v_and_b32 v87, 0xffff0000, v87
    v_lshlrev_b32 v88, 16, v89
    v_and_b32 v89, 0xffff0000, v89
    v_lshlrev_b32 v90, 16, v91
    v_and_b32 v91, 0xffff0000, v91
    v_lshlrev_b32 v92, 16, v93
    v_and_b32 v93, 0xffff0000, v93
    v_lshlrev_b32 v94, 16, v95
    v_and_b32 v95, 0xffff0000, v95
    v_lshlrev_b32 v96, 16, v97
    v_and_b32 v97, 0xffff0000, v97
    v_lshlrev_b32 v98, 16, v99
    v_and_b32 v99, 0xffff0000, v99
    v_cvt_u32_f32 v64, v64
    v_cvt_u32_f32 v65, v65
    v_cvt_u32_f32 v66, v66
    v_cvt_u32_f32 v67, v67
    v_cvt_u32_f32 v68, v68
    v_cvt_u32_f32 v69, v69
    v_cvt_u32_f32 v70, v70
    v_cvt_u32_f32 v71, v71
    v_cvt_u32_f32 v72, v72
    v_cvt_u32_f32 v73, v73
    v_cvt_u32_f32 v74, v74
    v_cvt_u32_f32 v75, v75
    v_cvt_u32_f32 v76, v76
    v_cvt_u32_f32 v77, v77
    v_cvt_u32_f32 v78, v78
    v_cvt_u32_f32 v79, v79
    v_cvt_u32_f32 v80, v80
    v_cvt_u32_f32 v81, v81
    v_cvt_u32_f32 v82, v82
    v_cvt_u32_f32 v83, v83
    v_cvt_u32_f32 v84, v84
    v_cvt_u32_f32 v85, v85
    v_cvt_u32_f32 v86, v86
    v_cvt_u32_f32 v87, v87
    v_cvt_u32_f32 v88, v88
    v_cvt_u32_f32 v89, v89
    v_cvt_u32_f32 v90, v90
    v_cvt_u32_f32 v91, v91
    v_cvt_u32_f32 v92, v92
    v_cvt_u32_f32 v93, v93
    v_cvt_u32_f32 v94, v94
    v_cvt_u32_f32 v95, v95
    v_cvt_u32_f32 v96, v96
    v_cvt_u32_f32 v97, v97
    v_cvt_u32_f32 v98, v98
    v_cvt_u32_f32 v99, v99
    v_lshrrev_b32 v246, 5, v64
    v_add_lshl_u32 v64, v64, v246, 2
    v_lshrrev_b32 v247, 5, v65
    v_add_lshl_u32 v65, v65, v247, 2
    v_lshrrev_b32 v246, 5, v66
    v_add_lshl_u32 v66, v66, v246, 2
    v_lshrrev_b32 v247, 5, v67
    v_add_lshl_u32 v67, v67, v247, 2
    v_lshrrev_b32 v246, 5, v68
    v_add_lshl_u32 v68, v68, v246, 2
    v_lshrrev_b32 v247, 5, v69
    v_add_lshl_u32 v69, v69, v247, 2
    v_lshrrev_b32 v246, 5, v70
    v_add_lshl_u32 v70, v70, v246, 2
    v_lshrrev_b32 v247, 5, v71
    v_add_lshl_u32 v71, v71, v247, 2
    v_lshrrev_b32 v246, 5, v72
    v_add_lshl_u32 v72, v72, v246, 2
    v_lshrrev_b32 v247, 5, v73
    v_add_lshl_u32 v73, v73, v247, 2
    v_lshrrev_b32 v246, 5, v74
    v_add_lshl_u32 v74, v74, v246, 2
    v_lshrrev_b32 v247, 5, v75
    v_add_lshl_u32 v75, v75, v247, 2
    v_lshrrev_b32 v246, 5, v76
    v_add_lshl_u32 v76, v76, v246, 2
    v_lshrrev_b32 v247, 5, v77
    v_add_lshl_u32 v77, v77, v247, 2
    v_lshrrev_b32 v246, 5, v78
    v_add_lshl_u32 v78, v78, v246, 2
    v_lshrrev_b32 v247, 5, v79
    v_add_lshl_u32 v79, v79, v247, 2
    v_lshrrev_b32 v246, 5, v80
    v_add_lshl_u32 v80, v80, v246, 2
    v_lshrrev_b32 v247, 5, v81
    v_add_lshl_u32 v81, v81, v247, 2
    v_lshrrev_b32 v246, 5, v82
    v_add_lshl_u32 v82, v82, v246, 2
    v_lshrrev_b32 v247, 5, v83
    v_add_lshl_u32 v83, v83, v247, 2
    v_lshrrev_b32 v246, 5, v84
    v_add_lshl_u32 v84, v84, v246, 2
    v_lshrrev_b32 v247, 5, v85
    v_add_lshl_u32 v85, v85, v247, 2
    v_lshrrev_b32 v246, 5, v86
    v_add_lshl_u32 v86, v86, v246, 2
    v_lshrrev_b32 v247, 5, v87
    v_add_lshl_u32 v87, v87, v247, 2
    v_lshrrev_b32 v246, 5, v88
    v_add_lshl_u32 v88, v88, v246, 2
    v_lshrrev_b32 v247, 5, v89
    v_add_lshl_u32 v89, v89, v247, 2
    v_lshrrev_b32 v246, 5, v90
    v_add_lshl_u32 v90, v90, v246, 2
    v_lshrrev_b32 v247, 5, v91
    v_add_lshl_u32 v91, v91, v247, 2
    v_lshrrev_b32 v246, 5, v92
    v_add_lshl_u32 v92, v92, v246, 2
    v_lshrrev_b32 v247, 5, v93
    v_add_lshl_u32 v93, v93, v247, 2
    v_lshrrev_b32 v246, 5, v94
    v_add_lshl_u32 v94, v94, v246, 2
    v_lshrrev_b32 v247, 5, v95
    v_add_lshl_u32 v95, v95, v247, 2
    v_lshrrev_b32 v246, 5, v96
    v_add_lshl_u32 v96, v96, v246, 2
    v_lshrrev_b32 v247, 5, v97
    v_add_lshl_u32 v97, v97, v247, 2
    v_lshrrev_b32 v246, 5, v98
    v_add_lshl_u32 v98, v98, v246, 2
    v_lshrrev_b32 v247, 5, v99
    v_add_lshl_u32 v99, v99, v247, 2
    v_add_u32 v64, s44, v64
    v_add_u32 v65, s44, v65
    v_add_u32 v66, s44, v66
    v_add_u32 v67, s44, v67
    v_add_u32 v68, s44, v68
    v_add_u32 v69, s44, v69
    v_add_u32 v70, s44, v70
    v_add_u32 v71, s44, v71
    v_add_u32 v72, s44, v72
    v_add_u32 v73, s44, v73
    v_add_u32 v74, s44, v74
    v_add_u32 v75, s44, v75
    v_add_u32 v76, s44, v76
    v_add_u32 v77, s44, v77
    v_add_u32 v78, s44, v78
    v_add_u32 v79, s44, v79
    v_add_u32 v80, s44, v80
    v_add_u32 v81, s44, v81
    v_add_u32 v82, s44, v82
    v_add_u32 v83, s44, v83
    v_add_u32 v84, s44, v84
    v_add_u32 v85, s44, v85
    v_add_u32 v86, s44, v86
    v_add_u32 v87, s44, v87
    v_add_u32 v88, s44, v88
    v_add_u32 v89, s44, v89
    v_add_u32 v90, s44, v90
    v_add_u32 v91, s44, v91
    v_add_u32 v92, s44, v92
    v_add_u32 v93, s44, v93
    v_add_u32 v94, s44, v94
    v_add_u32 v95, s44, v95
    v_add_u32 v96, s44, v96
    v_add_u32 v97, s44, v97
    v_add_u32 v98, s44, v98
    v_add_u32 v99, s44, v99
    s_add_u32 s45, s44, 9184
    v_mov_b32 v9, s45
    v_cmp_eq_u32 vcc, 63, v1
    v_add_u32 v7, 16, v17
    v_mov_b32 v26, 64
    v_cndmask_b32 v99, v99, v9, vcc
    v_add_u32 v246, 256, v242
    v_cmp_eq_u32 vcc, 0, v242
    v_mov_b32 v25, v17
    v_and_b32 v247, 16, v1
    v_cndmask_b32 v246, v246, v242, vcc
    v_lshlrev_b32 v246, 4, v246
    v_mul_u32_u24 v247, 280, v247
    v_add_u32 v8, v246, v247
    s_waitcnt vmcnt(1)
    v_lshlrev_b32 v242, 3, v242
    v_add_u32 v52, v52, v242
    v_add_u32 v53, v53, v242
    v_add_u32 v54, v54, v242
    v_add_u32 v55, v55, v242
    v_add_u32 v56, v56, v242
    v_add_u32 v57, v57, v242
    v_add_u32 v58, v58, v242
    v_add_u32 v59, v59, v242
    v_add_u32 v60, v60, v242
    v_add_u32 v61, v61, v242
    v_add_u32 v62, v62, v242
    v_add_u32 v63, v63, v242
    v_lshrrev_b32 v246, 5, v52
    v_add_lshl_u32 v52, v52, v246, 2
    v_lshrrev_b32 v247, 5, v53
    v_add_lshl_u32 v53, v53, v247, 2
    v_lshrrev_b32 v246, 5, v54
    v_add_lshl_u32 v54, v54, v246, 2
    v_lshrrev_b32 v247, 5, v55
    v_add_lshl_u32 v55, v55, v247, 2
    v_lshrrev_b32 v246, 5, v56
    v_add_lshl_u32 v56, v56, v246, 2
    v_lshrrev_b32 v247, 5, v57
    v_add_lshl_u32 v57, v57, v247, 2
    v_lshrrev_b32 v246, 5, v58
    v_add_lshl_u32 v58, v58, v246, 2
    v_lshrrev_b32 v247, 5, v59
    v_add_lshl_u32 v59, v59, v247, 2
    v_lshrrev_b32 v246, 5, v60
    v_add_lshl_u32 v60, v60, v246, 2
    v_lshrrev_b32 v247, 5, v61
    v_add_lshl_u32 v61, v61, v247, 2
    v_lshrrev_b32 v246, 5, v62
    v_add_lshl_u32 v62, v62, v246, 2
    v_lshrrev_b32 v247, 5, v63
    v_add_lshl_u32 v63, v63, v247, 2
    v_add_u32 v52, s44, v52
    v_add_u32 v53, s44, v53
    v_add_u32 v54, s44, v54
    v_add_u32 v55, s44, v55
    v_add_u32 v56, s44, v56
    v_add_u32 v57, s44, v57
    v_add_u32 v58, s44, v58
    v_add_u32 v59, s44, v59
    v_add_u32 v60, s44, v60
    v_add_u32 v61, s44, v61
    v_add_u32 v62, s44, v62
    v_add_u32 v63, s44, v63
    v_lshlrev_b32 v4, 16, v4
    v_lshlrev_b32 v5, 16, v5
    v_mul_f32 v248, s60, v4
    v_fma_f32 v249, v4, s60, -v248
    v_exp_f32 v248, v248
    v_fma_f32 v249, v4, s61, v249
    v_mul_f32 v249, s62, v249
    v_fma_f32 v248, v248, v249, v248
    v_cvt_pk_bf16_f32 v248, v248, v248
    v_lshlrev_b32 v4, 16, v248
    s_cmp_lg_u32 s36, 0
    s_cbranch_scc1 L_cnt_32
    v_mov_b32 v31, 1
    s_mov_b64 exec, 1
    buffer_atomic_add v31, off, s[28:31], 0 sc1
    s_mov_b64 exec, -1
L_cnt_32:
    s_mov_b32 s66, 0
    buffer_load_dword a200, v6, s[72:75], s76 offen
    s_cmp_lg_u32 s36, 0
    s_cbranch_scc1 L_xw
    v_mov_b32 v112, v100
    v_mov_b32 v113, v101
    v_mov_b32 v114, v102
    v_mov_b32 v115, v103
    s_mov_b32 s63, 8
    s_add_u32 s64, s57, 8960
    s_call_b64 s[54:55], L_kchan
    s_add_u32 s43, s57, 8960
    v_add_u32 v236, s43, v17
    ds_read_b128 v[124:127], v236 offset:0
    ds_read_b128 v[128:131], v236 offset:1024
    ds_read_b128 v[132:135], v236 offset:2048
    ds_read_b128 v[136:139], v236 offset:3072
    ds_read_b128 v[140:143], v236 offset:4096
    ds_read_b128 v[144:147], v236 offset:5120
    ds_read_b128 v[148:151], v236 offset:6144
    ds_read_b128 v[152:155], v236 offset:7168
    ds_read_b128 v[156:159], v236 offset:8192
    s_mul_i32 s43, s56, 1024
    s_add_u32 s43, s43, 41943040
    s_waitcnt lgkmcnt(0)
    buffer_store_dwordx4 v[124:127], v17, s[12:15], s43 offen offset:0
    buffer_store_dwordx4 v[128:131], v17, s[12:15], s43 offen offset:1024
    buffer_store_dwordx4 v[132:135], v17, s[12:15], s43 offen offset:2048
    buffer_store_dwordx4 v[136:139], v17, s[12:15], s43 offen offset:3072
    s_add_u32 s43, s43, 4096
    buffer_store_dwordx4 v[140:143], v17, s[12:15], s43 offen offset:0
    buffer_store_dwordx4 v[144:147], v17, s[12:15], s43 offen offset:1024
    buffer_store_dwordx4 v[148:151], v17, s[12:15], s43 offen offset:2048
    buffer_store_dwordx4 v[152:155], v17, s[12:15], s43 offen offset:3072
    s_add_u32 s43, s43, 4096
    buffer_store_dwordx4 v[156:159], v17, s[12:15], s43 offen offset:0
    s_branch L_xw_done
L_xw:
    v_lshrrev_b32 v236, 1, v1
    v_lshrrev_b32 v237, 1, v236
    v_and_b32 v237, 7, v237
    v_and_b32 v238, 1, v1
    v_lshlrev_b32 v238, 2, v238
    v_xor_b32 v237, v237, v238
    s_add_u32 s46, s57, 8960
    v_lshlrev_b32 v239, 7, v236
    v_add_u32 v239, s46, v239
    v_xor_b32 v240, 0, v237
    v_lshl_add_u32 v240, v240, 4, v239
    ds_read_b128 v[124:127], v240 offset:0
    ds_read_b128 v[140:143], v240 offset:4096
    ds_read_b128 v[156:159], v240 offset:8192
    v_xor_b32 v240, 1, v237
    v_lshl_add_u32 v240, v240, 4, v239
    ds_read_b128 v[128:131], v240 offset:0
    ds_read_b128 v[144:147], v240 offset:4096
    ds_read_b128 v[160:163], v240 offset:8192
    v_xor_b32 v240, 2, v237
    v_lshl_add_u32 v240, v240, 4, v239
    ds_read_b128 v[132:135], v240 offset:0
    ds_read_b128 v[148:151], v240 offset:4096
    ds_read_b128 v[164:167], v240 offset:8192
    v_xor_b32 v240, 3, v237
    v_lshl_add_u32 v240, v240, 4, v239
    ds_read_b128 v[136:139], v240 offset:0
    ds_read_b128 v[152:155], v240 offset:4096
    ds_read_b128 v[168:171], v240 offset:8192
    s_waitcnt lgkmcnt(0)
    v_mov_b32 v240, 0
    v_mov_b32 v241, 0
    v_dot2c_f32_bf16 v240, v124, v180
    v_dot2c_f32_bf16 v241, v125, v181
    v_dot2c_f32_bf16 v240, v126, v182
    v_dot2c_f32_bf16 v241, v127, v183
    v_dot2c_f32_bf16 v240, v128, v184
    v_dot2c_f32_bf16 v241, v129, v185
    v_dot2c_f32_bf16 v240, v130, v186
    v_dot2c_f32_bf16 v241, v131, v187
    v_dot2c_f32_bf16 v240, v132, v188
    v_dot2c_f32_bf16 v241, v133, v189
    v_dot2c_f32_bf16 v240, v134, v190
    v_dot2c_f32_bf16 v241, v135, v191
    v_dot2c_f32_bf16 v240, v136, v192
    v_dot2c_f32_bf16 v241, v137, v193
    v_dot2c_f32_bf16 v240, v138, v194
    v_dot2c_f32_bf16 v241, v139, v195
    v_dot2c_f32_bf16 v240, v140, v196
    v_dot2c_f32_bf16 v241, v141, v197
    v_dot2c_f32_bf16 v240, v142, v198
    v_dot2c_f32_bf16 v241, v143, v199
    v_dot2c_f32_bf16 v240, v144, v200
    v_dot2c_f32_bf16 v241, v145, v201
    v_dot2c_f32_bf16 v240, v146, v202
    v_dot2c_f32_bf16 v241, v147, v203
    v_dot2c_f32_bf16 v240, v148, v204
    v_dot2c_f32_bf16 v241, v149, v205
    v_dot2c_f32_bf16 v240, v150, v206
    v_dot2c_f32_bf16 v241, v151, v207
    v_dot2c_f32_bf16 v240, v152, v208
    v_dot2c_f32_bf16 v241, v153, v209
    v_dot2c_f32_bf16 v240, v154, v210
    v_dot2c_f32_bf16 v241, v155, v211
    v_dot2c_f32_bf16 v240, v156, v212
    v_dot2c_f32_bf16 v241, v157, v213
    v_dot2c_f32_bf16 v240, v158, v214
    v_dot2c_f32_bf16 v241, v159, v215
    v_dot2c_f32_bf16 v240, v160, v216
    v_dot2c_f32_bf16 v241, v161, v217
    v_dot2c_f32_bf16 v240, v162, v218
    v_dot2c_f32_bf16 v241, v163, v219
    v_dot2c_f32_bf16 v240, v164, v220
    v_dot2c_f32_bf16 v241, v165, v221
    v_dot2c_f32_bf16 v240, v166, v222
    v_dot2c_f32_bf16 v241, v167, v223
    v_dot2c_f32_bf16 v240, v168, v224
    v_dot2c_f32_bf16 v241, v169, v225
    v_dot2c_f32_bf16 v240, v170, v226
    v_dot2c_f32_bf16 v241, v171, v227
    s_lshl_b32 s43, s36, 7
    s_add_u32 s43, s43, 163200
    v_lshlrev_b32 v236, 2, v236
    v_add_f32 v240, v240, v241
    v_add_u32 v236, s43, v236
    s_nop 0
    v_add_f32_dpp v240, v240, v240 quad_perm:[1,0,3,2] row_mask:0xf bank_mask:0xf
    ds_write_b32 v236, v240
    s_call_b64 s[54:55], L_utsub
    s_add_u32 s53, s53, 1
    s_add_u32 s46, s46, 4096
    s_call_b64 s[54:55], L_utsub
    s_add_u32 s53, s53, 1
    s_add_u32 s46, s46, 4096
    s_call_b64 s[54:55], L_utsub
L_xw_done:
    buffer_load_dword a201, v6, s[72:75], s77 offen
    buffer_load_dword a202, v6, s[72:75], s78 offen
    v_mov_b32 v112, v104
    v_mov_b32 v113, v105
    v_mov_b32 v114, v106
    v_mov_b32 v115, v107
    s_mov_b32 s63, s36
    s_add_u32 s64, s57, 0
    s_call_b64 s[54:55], L_kchan
    s_barrier
    v_mov_b32 v31, 1
    s_waitcnt vmcnt(2)
    buffer_store_dword v31, off, s[12:15], s42 sc1
    s_cmp_lg_u32 s36, 1
    s_cbranch_scc1 L_gt_skip
    v_and_b32 v236, 31, v1
    v_lshlrev_b32 v236, 2, v236
    v_add_u32 v237, 163328, v236
    ds_read2_b32 v[238:239], v237 offset0:0 offset1:32
    ds_read_b32 v240, v237 offset:256
    s_lshl_b32 s43, s52, 1
    s_add_u32 s43, s43, 37879808
    s_waitcnt lgkmcnt(0)
    v_add_f32 v238, v238, v239
    v_add_f32 v238, v238, v240
    v_mul_f32 v238, 0xbfb8aa3b, v238
    v_exp_f32 v238, v238
    s_nop 0
    v_add_f32 v238, 1.0, v238
    v_rcp_f32 v238, v238
    s_nop 0
    buffer_store_dword v238, v236, s[12:15], s43 offen sc1
L_gt_skip:
    buffer_load_dword v24, off, s[28:31], 0 sc1
    s_mov_b32 s66, 2
    v_mov_b32 v112, v108
    v_mov_b32 v113, v109
    v_mov_b32 v114, v110
    v_mov_b32 v115, v111
    s_add_u32 s63, s36, 4
    s_add_u32 s64, s57, 8960
    s_call_b64 s[54:55], L_kchan
    s_add_u32 s60, s56, s36
    s_add_u32 s61, s57, 0
    v_bfrev_b32 v4, 1
    v_cmp_le_u32 vcc, 25, v1
    s_nop 1
    v_cndmask_b32 v4, v4, v17, vcc
    v_lshrrev_b32 v27, 4, v1
    v_and_b32 v28, 3, v1
    v_lshrrev_b32 v29, 2, v1
    v_and_b32 v29, 3, v29
    v_mul_u32_u24 v6, 4640, v28
    v_lshl_add_u32 v6, v29, 7, v6
    v_lshl_add_u32 v6, v27, 4, v6
    s_add_u32 s43, s57, 17920
    v_add_u32 v6, s43, v6
    v_lshlrev_b32 v8, 5, v27
    v_lshl_add_u32 v8, v28, 2, v8
    v_lshl_add_u32 v8, v29, 7, v8
    s_add_u32 s43, s57, 36480
    v_add_u32 v8, s43, v8
    v_add_u32 v9, s43, v17
    v_and_b32 v28, 1, v1
    v_lshrrev_b32 v29, 1, v1
    v_and_b32 v29, 7, v29
    v_mul_u32_u24 v7, 4480, v28
    v_sub_u32 v27, v27, v29
    v_lshl_add_u32 v7, v27, 4, v7
    s_add_u32 s43, s61, 112
    v_add_u32 v7, s43, v7
    s_mul_i32 s44, s60, 4224
    s_add_u32 s44, s44, 18874080
    s_add_u32 s68, s34, s44
    s_addc_u32 s69, s35, 0
    s_and_b32 s69, s69, 0xffff
    s_mov_b32 s70, 4512
    s_mov_b32 s71, 0x00020000
    s_cmp_eq_u32 s66, 1
    s_cbranch_scc1 L_uc3
    s_mov_b32 s43, 0x20000
    s_mov_b32 s44, 37814272
    v_mov_b32 v20, 0
L_uc1:
    v_min_u32 v20, v20, v21
    v_min3_u32 v20, v20, v22, v23
    v_cmp_gt_u32 vcc, 1, v20
    v_cmp_gt_u32 s[76:77], v26, v24
    s_or_b64 vcc, vcc, s[76:77]
    s_cbranch_scc0 L_uc3
    s_sub_u32 s43, s43, 1
    s_cbranch_scc1 L_uc3
    buffer_load_dword v24, off, s[28:31], 0 sc1
    s_waitcnt vmcnt(0)
    buffer_load_dwordx4 v[20:23], v25, s[12:15], s44 offen sc1
    s_waitcnt vmcnt(0)
    s_branch L_uc1
L_uc3:
    s_add_u32 m0, s57, 17920
    s_mov_b32 s47, 4
    buffer_load_dwordx4 v4, s[68:71], s47 offen offset:0 sc1 lds
    buffer_load_dwordx4 v17, s[68:71], s47 offen offset:1024 sc1 lds
    buffer_load_dwordx4 v17, s[68:71], s47 offen offset:2048 sc1 lds
    buffer_load_dwordx4 v17, s[68:71], s47 offen offset:3072 sc1 lds
    s_add_u32 m0, s57, 22560
    s_mov_b32 s47, 8
    buffer_load_dwordx4 v4, s[68:71], s47 offen offset:0 sc1 lds
    buffer_load_dwordx4 v17, s[68:71], s47 offen offset:1024 sc1 lds
    buffer_load_dwordx4 v17, s[68:71], s47 offen offset:2048 sc1 lds
    buffer_load_dwordx4 v17, s[68:71], s47 offen offset:3072 sc1 lds
    s_add_u32 m0, s57, 27200
    s_mov_b32 s47, 12
    buffer_load_dwordx4 v4, s[68:71], s47 offen offset:0 sc1 lds
    buffer_load_dwordx4 v17, s[68:71], s47 offen offset:1024 sc1 lds
    buffer_load_dwordx4 v17, s[68:71], s47 offen offset:2048 sc1 lds
    buffer_load_dwordx4 v17, s[68:71], s47 offen offset:3072 sc1 lds
    s_add_u32 m0, s57, 31840
    s_mov_b32 s47, 16
    buffer_load_dwordx4 v4, s[68:71], s47 offen offset:0 sc1 lds
    buffer_load_dwordx4 v17, s[68:71], s47 offen offset:1024 sc1 lds
    buffer_load_dwordx4 v17, s[68:71], s47 offen offset:2048 sc1 lds
    buffer_load_dwordx4 v17, s[68:71], s47 offen offset:3072 sc1 lds
    s_add_u32 m0, s57, 22016
    s_mov_b32 s47, 4100
    s_mov_b32 exec_hi, 0
    buffer_load_dwordx4 v17, s[68:71], s47 offen sc1 lds
    s_mov_b64 exec, -1
    s_add_u32 m0, s57, 26656
    s_mov_b32 s47, 4104
    s_mov_b32 exec_hi, 0
    buffer_load_dwordx4 v17, s[68:71], s47 offen sc1 lds
    s_mov_b64 exec, -1
    s_add_u32 m0, s57, 31296
    s_mov_b32 s47, 4108
    s_mov_b32 exec_hi, 0
    buffer_load_dwordx4 v17, s[68:71], s47 offen sc1 lds
    s_mov_b64 exec, -1
    s_add_u32 m0, s57, 35936
    s_mov_b32 s47, 4112
    s_mov_b32 exec_hi, 0
    buffer_load_dwordx4 v17, s[68:71], s47 offen sc1 lds
    s_mov_b64 exec, -1
    s_barrier
    s_lshl_b32 s63, s60, 12
    s_add_u32 s63, s63, 24117248
    s_waitcnt vmcnt(0)
    ds_read_b128 v[64:67], v7 offset:4096
    ds_read_b128 a[28:31], v6 offset:512
    ds_read_b128 a[60:63], v6 offset:1024
    ds_read_b128 a[92:95], v6 offset:1536
    ds_read_b128 a[124:127], v6 offset:2048
    ds_read_b128 a[156:159], v6 offset:2560
    ds_read_b128 a[188:191], v6 offset:3072
    ds_read_b128 a[220:223], v6 offset:3584
    ds_read_b128 a[252:255], v6 offset:4096
    ds_read_b128 v[68:71], v7 offset:4032
    ds_read_b128 a[24:27], v6 offset:448
    ds_read_b128 a[56:59], v6 offset:960
    s_waitcnt lgkmcnt(8)
    v_mfma_f32_16x16x32_bf16 v[32:35], v[64:67], a[28:31], 0
    ds_read_b128 a[88:91], v6 offset:1472
    ds_read_b128 a[120:123], v6 offset:1984
    v_mfma_f32_16x16x32_bf16 v[36:39], v[64:67], a[60:63], 0
    ds_read_b128 a[152:155], v6 offset:2496
    ds_read_b128 a[184:187], v6 offset:3008
    v_mfma_f32_16x16x32_bf16 v[40:43], v[64:67], a[92:95], 0
    ds_read_b128 a[216:219], v6 offset:3520
    s_waitcnt lgkmcnt(10)
    v_mfma_f32_16x16x32_bf16 v[44:47], v[64:67], a[124:127], 0
    ds_read_b128 a[248:251], v6 offset:4032
    v_mfma_f32_16x16x32_bf16 v[48:51], v[64:67], a[156:159], 0
    ds_read_b128 v[72:75], v7 offset:3968
    ds_read_b128 a[20:23], v6 offset:384
    v_mfma_f32_16x16x32_bf16 v[52:55], v[64:67], a[188:191], 0
    ds_read_b128 a[52:55], v6 offset:896
    s_waitcnt lgkmcnt(10)
    v_mfma_f32_16x16x32_bf16 v[56:59], v[64:67], a[220:223], 0
    ds_read_b128 a[84:87], v6 offset:1408
    v_mfma_f32_16x16x32_bf16 v[60:63], v[64:67], a[252:255], 0
    ds_read_b128 a[116:119], v6 offset:1920
    v_mfma_f32_16x16x32_bf16 v[32:35], v[68:71], a[24:27], v[32:35]
    ds_read_b128 a[148:151], v6 offset:2432
    s_waitcnt lgkmcnt(10)
    v_mfma_f32_16x16x32_bf16 v[36:39], v[68:71], a[56:59], v[36:39]
    ds_read_b128 a[180:183], v6 offset:2944
    v_mfma_f32_16x16x32_bf16 v[40:43], v[68:71], a[88:91], v[40:43]
    ds_read_b128 a[212:215], v6 offset:3456
    v_mfma_f32_16x16x32_bf16 v[44:47], v[68:71], a[120:123], v[44:47]
    ds_read_b128 a[244:247], v6 offset:3968
    s_waitcnt lgkmcnt(10)
    v_mfma_f32_16x16x32_bf16 v[48:51], v[68:71], a[152:155], v[48:51]
    ds_read_b128 v[76:79], v7 offset:3904
    ds_read_b128 a[16:19], v6 offset:320
    v_mfma_f32_16x16x32_bf16 v[52:55], v[68:71], a[184:187], v[52:55]
    ds_read_b128 a[48:51], v6 offset:832
    v_mfma_f32_16x16x32_bf16 v[56:59], v[68:71], a[216:219], v[56:59]
    ds_read_b128 a[80:83], v6 offset:1344
    s_waitcnt lgkmcnt(10)
    v_mfma_f32_16x16x32_bf16 v[60:63], v[68:71], a[248:251], v[60:63]
    ds_read_b128 a[112:115], v6 offset:1856
    v_mfma_f32_16x16x32_bf16 v[32:35], v[72:75], a[20:23], v[32:35]
    ds_read_b128 a[144:147], v6 offset:2368
    v_mfma_f32_16x16x32_bf16 v[36:39], v[72:75], a[52:55], v[36:39]
    ds_read_b128 a[176:179], v6 offset:2880
    s_waitcnt lgkmcnt(10)
    v_mfma_f32_16x16x32_bf16 v[40:43], v[72:75], a[84:87], v[40:43]
    ds_read_b128 a[208:211], v6 offset:3392
    v_mfma_f32_16x16x32_bf16 v[44:47], v[72:75], a[116:119], v[44:47]
    ds_read_b128 a[240:243], v6 offset:3904
    v_mfma_f32_16x16x32_bf16 v[48:51], v[72:75], a[148:151], v[48:51]
    ds_read_b128 v[80:83], v7 offset:3840
    ds_read_b128 a[12:15], v6 offset:256
    s_waitcnt lgkmcnt(11)
    v_mfma_f32_16x16x32_bf16 v[52:55], v[72:75], a[180:183], v[52:55]
    ds_read_b128 a[44:47], v6 offset:768
    v_mfma_f32_16x16x32_bf16 v[56:59], v[72:75], a[212:215], v[56:59]
    ds_read_b128 a[76:79], v6 offset:1280
    v_mfma_f32_16x16x32_bf16 v[60:63], v[72:75], a[244:247], v[60:63]
    ds_read_b128 a[108:111], v6 offset:1792
    s_waitcnt lgkmcnt(10)
    v_mfma_f32_16x16x32_bf16 v[32:35], v[76:79], a[16:19], v[32:35]
    ds_read_b128 a[140:143], v6 offset:2304
    v_mfma_f32_16x16x32_bf16 v[36:39], v[76:79], a[48:51], v[36:39]
    ds_read_b128 a[172:175], v6 offset:2816
    v_mfma_f32_16x16x32_bf16 v[40:43], v[76:79], a[80:83], v[40:43]
    ds_read_b128 a[204:207], v6 offset:3328
    s_waitcnt lgkmcnt(10)
    v_mfma_f32_16x16x32_bf16 v[44:47], v[76:79], a[112:115], v[44:47]
    ds_read_b128 a[236:239], v6 offset:3840
    v_mfma_f32_16x16x32_bf16 v[48:51], v[76:79], a[144:147], v[48:51]
    ds_read_b128 v[84:87], v7 offset:3776
    ds_read_b128 a[8:11], v6 offset:192
    v_mfma_f32_16x16x32_bf16 v[52:55], v[76:79], a[176:179], v[52:55]
    ds_read_b128 a[40:43], v6 offset:704
    s_waitcnt lgkmcnt(10)
    v_mfma_f32_16x16x32_bf16 v[56:59], v[76:79], a[208:211], v[56:59]
    ds_read_b128 a[72:75], v6 offset:1216
    v_mfma_f32_16x16x32_bf16 v[60:63], v[76:79], a[240:243], v[60:63]
    ds_read_b128 a[104:107], v6 offset:1728
    v_mfma_f32_16x16x32_bf16 v[32:35], v[80:83], a[12:15], v[32:35]
    ds_read_b128 a[136:139], v6 offset:2240
    s_waitcnt lgkmcnt(10)
    v_mfma_f32_16x16x32_bf16 v[36:39], v[80:83], a[44:47], v[36:39]
    ds_read_b128 a[168:171], v6 offset:2752
    v_mfma_f32_16x16x32_bf16 v[40:43], v[80:83], a[76:79], v[40:43]
    ds_read_b128 a[200:203], v6 offset:3264
    v_mfma_f32_16x16x32_bf16 v[44:47], v[80:83], a[108:111], v[44:47]
    ds_read_b128 a[232:235], v6 offset:3776
    s_waitcnt lgkmcnt(10)
    v_mfma_f32_16x16x32_bf16 v[48:51], v[80:83], a[140:143], v[48:51]
    ds_read_b128 v[88:91], v7 offset:3712
    ds_read_b128 a[4:7], v6 offset:128
    v_mfma_f32_16x16x32_bf16 v[52:55], v[80:83], a[172:175], v[52:55]
    ds_read_b128 a[36:39], v6 offset:640
    v_mfma_f32_16x16x32_bf16 v[56:59], v[80:83], a[204:207], v[56:59]
    ds_read_b128 a[68:71], v6 offset:1152
    s_waitcnt lgkmcnt(10)
    v_mfma_f32_16x16x32_bf16 v[60:63], v[80:83], a[236:239], v[60:63]
    ds_read_b128 a[100:103], v6 offset:1664
    v_mfma_f32_16x16x32_bf16 v[32:35], v[84:87], a[8:11], v[32:35]
    ds_read_b128 a[132:135], v6 offset:2176
    v_mfma_f32_16x16x32_bf16 v[36:39], v[84:87], a[40:43], v[36:39]
    ds_read_b128 a[164:167], v6 offset:2688
    s_waitcnt lgkmcnt(10)
    v_mfma_f32_16x16x32_bf16 v[40:43], v[84:87], a[72:75], v[40:43]
    ds_read_b128 a[196:199], v6 offset:3200
    v_mfma_f32_16x16x32_bf16 v[44:47], v[84:87], a[104:107], v[44:47]
    ds_read_b128 a[228:231], v6 offset:3712
    v_mfma_f32_16x16x32_bf16 v[48:51], v[84:87], a[136:139], v[48:51]
    ds_read_b128 v[92:95], v7 offset:3648
    ds_read_b128 a[0:3], v6 offset:64
    s_waitcnt lgkmcnt(11)
    v_mfma_f32_16x16x32_bf16 v[52:55], v[84:87], a[168:171], v[52:55]
    ds_read_b128 a[32:35], v6 offset:576
    v_mfma_f32_16x16x32_bf16 v[56:59], v[84:87], a[200:203], v[56:59]
    ds_read_b128 a[64:67], v6 offset:1088
    v_mfma_f32_16x16x32_bf16 v[60:63], v[84:87], a[232:235], v[60:63]
    ds_read_b128 a[96:99], v6 offset:1600
    s_waitcnt lgkmcnt(10)
    v_mfma_f32_16x16x32_bf16 v[32:35], v[88:91], a[4:7], v[32:35]
    ds_read_b128 a[128:131], v6 offset:2112
    v_mfma_f32_16x16x32_bf16 v[36:39], v[88:91], a[36:39], v[36:39]
    ds_read_b128 a[160:163], v6 offset:2624
    v_mfma_f32_16x16x32_bf16 v[40:43], v[88:91], a[68:71], v[40:43]
    ds_read_b128 a[192:195], v6 offset:3136
    s_waitcnt lgkmcnt(10)
    v_mfma_f32_16x16x32_bf16 v[44:47], v[88:91], a[100:103], v[44:47]
    ds_read_b128 a[224:227], v6 offset:3648
    v_mfma_f32_16x16x32_bf16 v[48:51], v[88:91], a[132:135], v[48:51]
    ds_read_b128 v[64:67], v7 offset:3584
    ds_read_b128 v[96:99], v6 offset:0
    v_mfma_f32_16x16x32_bf16 v[52:55], v[88:91], a[164:167], v[52:55]
    s_waitcnt lgkmcnt(9)
    v_mfma_f32_16x16x32_bf16 v[56:59], v[88:91], a[196:199], v[56:59]
    v_mfma_f32_16x16x32_bf16 v[60:63], v[88:91], a[228:231], v[60:63]
    v_mfma_f32_16x16x32_bf16 v[32:35], v[92:95], a[0:3], v[32:35]
    s_waitcnt lgkmcnt(6)
    v_mfma_f32_16x16x32_bf16 v[36:39], v[92:95], a[32:35], v[36:39]
    v_mfma_f32_16x16x32_bf16 v[40:43], v[92:95], a[64:67], v[40:43]
    v_mfma_f32_16x16x32_bf16 v[44:47], v[92:95], a[96:99], v[44:47]
    s_waitcnt lgkmcnt(3)
    v_mfma_f32_16x16x32_bf16 v[48:51], v[92:95], a[128:131], v[48:51]
    ds_read_b128 v[68:71], v7 offset:3520
    v_mfma_f32_16x16x32_bf16 v[52:55], v[92:95], a[160:163], v[52:55]
    v_mfma_f32_16x16x32_bf16 v[56:59], v[92:95], a[192:195], v[56:59]
    s_waitcnt lgkmcnt(1)
    v_mfma_f32_16x16x32_bf16 v[60:63], v[92:95], a[224:227], v[60:63]
    s_add_u32 s60, s60, 4
    s_mul_i32 s44, s60, 4224
    v_mfma_f32_16x16x32_bf16 v[32:35], v[64:67], v[96:99], v[32:35]
    s_add_u32 s44, s44, 18874080
    s_add_u32 s68, s34, s44
    v_mfma_f32_16x16x32_bf16 v[36:39], v[64:67], a[28:31], v[36:39]
    s_addc_u32 s69, s35, 0
    s_and_b32 s69, s69, 0xffff
    v_mfma_f32_16x16x32_bf16 v[40:43], v[64:67], a[60:63], v[40:43]
    s_mov_b32 s70, 4512
    s_mov_b32 s71, 0x00020000
    v_mfma_f32_16x16x32_bf16 v[44:47], v[64:67], a[92:95], v[44:47]
    ds_read_b128 v[72:75], v7 offset:3456
    v_cvt_pk_bf16_f32 v100, v32, v33
    v_mfma_f32_16x16x32_bf16 v[48:51], v[64:67], a[124:127], v[48:51]
    v_cvt_pk_bf16_f32 v101, v34, v35
    ds_write_b32 v8, v100 offset:0
    v_mfma_f32_16x16x32_bf16 v[52:55], v[64:67], a[156:159], v[52:55]
    ds_write_b32 v8, v101 offset:16
    s_add_u32 m0, s57, 17920
    v_mfma_f32_16x16x32_bf16 v[56:59], v[64:67], a[188:191], v[56:59]
    s_mov_b32 s47, 4
    buffer_load_dwordx4 v4, s[68:71], s47 offen offset:0 sc1 lds
    v_mfma_f32_16x16x32_bf16 v[60:63], v[64:67], a[220:223], v[60:63]
    s_waitcnt lgkmcnt(3)
    v_mfma_f32_16x16x32_bf16 v[36:39], v[68:71], a[24:27], v[36:39]
    v_mfma_f32_16x16x32_bf16 v[40:43], v[68:71], a[56:59], v[40:43]
    v_mfma_f32_16x16x32_bf16 v[44:47], v[68:71], a[88:91], v[44:47]
    ds_read_b128 v[76:79], v7 offset:3392
    v_mfma_f32_16x16x32_bf16 v[48:51], v[68:71], a[120:123], v[48:51]
    v_mfma_f32_16x16x32_bf16 v[52:55], v[68:71], a[152:155], v[52:55]
    buffer_load_dwordx4 v17, s[68:71], s47 offen offset:1024 sc1 lds
    v_mfma_f32_16x16x32_bf16 v[56:59], v[68:71], a[184:187], v[56:59]
    v_mfma_f32_16x16x32_bf16 v[60:63], v[68:71], a[216:219], v[60:63]
    s_waitcnt lgkmcnt(3)
    v_mfma_f32_16x16x32_bf16 v[36:39], v[72:75], a[20:23], v[36:39]
    v_mfma_f32_16x16x32_bf16 v[40:43], v[72:75], a[52:55], v[40:43]
    v_mfma_f32_16x16x32_bf16 v[44:47], v[72:75], a[84:87], v[44:47]
    ds_read_b128 v[80:83], v7 offset:3328
    v_mfma_f32_16x16x32_bf16 v[48:51], v[72:75], a[116:119], v[48:51]
    buffer_load_dwordx4 v17, s[68:71], s47 offen offset:2048 sc1 lds
    v_mfma_f32_16x16x32_bf16 v[52:55], v[72:75], a[148:151], v[52:55]
    v_mfma_f32_16x16x32_bf16 v[56:59], v[72:75], a[180:183], v[56:59]
    v_mfma_f32_16x16x32_bf16 v[60:63], v[72:75], a[212:215], v[60:63]
    s_waitcnt lgkmcnt(1)
    v_mfma_f32_16x16x32_bf16 v[36:39], v[76:79], a[16:19], v[36:39]
    v_mfma_f32_16x16x32_bf16 v[40:43], v[76:79], a[48:51], v[40:43]
    v_mfma_f32_16x16x32_bf16 v[44:47], v[76:79], a[80:83], v[44:47]
    ds_read_b128 v[84:87], v7 offset:3264
    buffer_load_dwordx4 v17, s[68:71], s47 offen offset:3072 sc1 lds
    v_mfma_f32_16x16x32_bf16 v[48:51], v[76:79], a[112:115], v[48:51]
    s_add_u32 m0, s57, 22560
    s_mov_b32 s47, 8
    v_mfma_f32_16x16x32_bf16 v[52:55], v[76:79], a[144:147], v[52:55]
    v_mfma_f32_16x16x32_bf16 v[56:59], v[76:79], a[176:179], v[56:59]
    v_mfma_f32_16x16x32_bf16 v[60:63], v[76:79], a[208:211], v[60:63]
    s_waitcnt lgkmcnt(1)
    v_mfma_f32_16x16x32_bf16 v[36:39], v[80:83], a[12:15], v[36:39]
    v_mfma_f32_16x16x32_bf16 v[40:43], v[80:83], a[44:47], v[40:43]
    buffer_load_dwordx4 v4, s[68:71], s47 offen offset:0 sc1 lds
    v_mfma_f32_16x16x32_bf16 v[44:47], v[80:83], a[76:79], v[44:47]
    ds_read_b128 v[88:91], v7 offset:3200
    v_mfma_f32_16x16x32_bf16 v[48:51], v[80:83], a[108:111], v[48:51]
    v_mfma_f32_16x16x32_bf16 v[52:55], v[80:83], a[140:143], v[52:55]
    v_mfma_f32_16x16x32_bf16 v[56:59], v[80:83], a[172:175], v[56:59]
    v_mfma_f32_16x16x32_bf16 v[60:63], v[80:83], a[204:207], v[60:63]
    s_waitcnt lgkmcnt(1)
    v_mfma_f32_16x16x32_bf16 v[36:39], v[84:87], a[8:11], v[36:39]
    buffer_load_dwordx4 v17, s[68:71], s47 offen offset:1024 sc1 lds
    v_mfma_f32_16x16x32_bf16 v[40:43], v[84:87], a[40:43], v[40:43]
    v_mfma_f32_16x16x32_bf16 v[44:47], v[84:87], a[72:75], v[44:47]
    ds_read_b128 v[92:95], v7 offset:3136
    v_mfma_f32_16x16x32_bf16 v[48:51], v[84:87], a[104:107], v[48:51]
    v_mfma_f32_16x16x32_bf16 v[52:55], v[84:87], a[136:139], v[52:55]
    v_mfma_f32_16x16x32_bf16 v[56:59], v[84:87], a[168:171], v[56:59]
    v_mfma_f32_16x16x32_bf16 v[60:63], v[84:87], a[200:203], v[60:63]
    buffer_load_dwordx4 v17, s[68:71], s47 offen offset:2048 sc1 lds
    s_waitcnt lgkmcnt(1)
    v_mfma_f32_16x16x32_bf16 v[36:39], v[88:91], a[4:7], v[36:39]
    v_mfma_f32_16x16x32_bf16 v[40:43], v[88:91], a[36:39], v[40:43]
    v_mfma_f32_16x16x32_bf16 v[44:47], v[88:91], a[68:71], v[44:47]
    ds_read_b128 v[64:67], v7 offset:3072
    v_mfma_f32_16x16x32_bf16 v[48:51], v[88:91], a[100:103], v[48:51]
    v_mfma_f32_16x16x32_bf16 v[52:55], v[88:91], a[132:135], v[52:55]
    v_mfma_f32_16x16x32_bf16 v[56:59], v[88:91], a[164:167], v[56:59]
    buffer_load_dwordx4 v17, s[68:71], s47 offen offset:3072 sc1 lds
    v_mfma_f32_16x16x32_bf16 v[60:63], v[88:91], a[196:199], v[60:63]
    s_add_u32 m0, s57, 27200
    s_mov_b32 s47, 12
    s_waitcnt lgkmcnt(1)
    v_mfma_f32_16x16x32_bf16 v[36:39], v[92:95], a[0:3], v[36:39]
    v_mfma_f32_16x16x32_bf16 v[40:43], v[92:95], a[32:35], v[40:43]
    v_mfma_f32_16x16x32_bf16 v[44:47], v[92:95], a[64:67], v[44:47]
    ds_read_b128 v[68:71], v7 offset:3008
    v_mfma_f32_16x16x32_bf16 v[48:51], v[92:95], a[96:99], v[48:51]
    v_mfma_f32_16x16x32_bf16 v[52:55], v[92:95], a[128:131], v[52:55]
    buffer_load_dwordx4 v4, s[68:71], s47 offen offset:0 sc1 lds
    v_mfma_f32_16x16x32_bf16 v[56:59], v[92:95], a[160:163], v[56:59]
    v_mfma_f32_16x16x32_bf16 v[60:63], v[92:95], a[192:195], v[60:63]
    s_waitcnt lgkmcnt(1)
    v_mfma_f32_16x16x32_bf16 v[36:39], v[64:67], v[96:99], v[36:39]
    v_mfma_f32_16x16x32_bf16 v[40:43], v[64:67], a[28:31], v[40:43]
    ds_read_b128 v[72:75], v7 offset:2944
    v_mfma_f32_16x16x32_bf16 v[44:47], v[64:67], a[60:63], v[44:47]
    v_mfma_f32_16x16x32_bf16 v[48:51], v[64:67], a[92:95], v[48:51]
    buffer_load_dwordx4 v17, s[68:71], s47 offen offset:1024 sc1 lds
    v_mfma_f32_16x16x32_bf16 v[52:55], v[64:67], a[124:127], v[52:55]
    v_mfma_f32_16x16x32_bf16 v[56:59], v[64:67], a[156:159], v[56:59]
    v_mfma_f32_16x16x32_bf16 v[60:63], v[64:67], a[188:191], v[60:63]
    v_cvt_pk_bf16_f32 v102, v36, v37
    v_cvt_pk_bf16_f32 v103, v38, v39
    s_waitcnt lgkmcnt(1)
    v_mfma_f32_16x16x32_bf16 v[40:43], v[68:71], a[24:27], v[40:43]
    ds_read_b128 v[76:79], v7 offset:2880
    ds_write_b32 v8, v102 offset:512
    v_mfma_f32_16x16x32_bf16 v[44:47], v[68:71], a[56:59], v[44:47]
    ds_write_b32 v8, v103 offset:528
    ds_read_b128 v[104:107], v9 offset:0
    v_mfma_f32_16x16x32_bf16 v[48:51], v[68:71], a[88:91], v[48:51]
    buffer_load_dwordx4 v17, s[68:71], s47 offen offset:2048 sc1 lds
    v_mfma_f32_16x16x32_bf16 v[52:55], v[68:71], a[120:123], v[52:55]
    v_mfma_f32_16x16x32_bf16 v[56:59], v[68:71], a[152:155], v[56:59]
    v_mfma_f32_16x16x32_bf16 v[60:63], v[68:71], a[184:187], v[60:63]
    s_waitcnt lgkmcnt(4)
    v_mfma_f32_16x16x32_bf16 v[40:43], v[72:75], a[20:23], v[40:43]
    ds_read_b128 v[80:83], v7 offset:2816
    v_mfma_f32_16x16x32_bf16 v[44:47], v[72:75], a[52:55], v[44:47]
    v_mfma_f32_16x16x32_bf16 v[48:51], v[72:75], a[84:87], v[48:51]
    buffer_load_dwordx4 v17, s[68:71], s47 offen offset:3072 sc1 lds
    v_mfma_f32_16x16x32_bf16 v[52:55], v[72:75], a[116:119], v[52:55]
    s_waitcnt lgkmcnt(1)
    buffer_store_dwordx4 v[104:107], v17, s[12:15], s63 offen offset:0 sc1
    v_mfma_f32_16x16x32_bf16 v[56:59], v[72:75], a[148:151], v[56:59]
    s_add_u32 m0, s57, 31840
    s_mov_b32 s47, 16
    v_mfma_f32_16x16x32_bf16 v[60:63], v[72:75], a[180:183], v[60:63]
    v_mfma_f32_16x16x32_bf16 v[40:43], v[76:79], a[16:19], v[40:43]
    ds_read_b128 v[84:87], v7 offset:2752
    v_mfma_f32_16x16x32_bf16 v[44:47], v[76:79], a[48:51], v[44:47]
    v_mfma_f32_16x16x32_bf16 v[48:51], v[76:79], a[80:83], v[48:51]
    buffer_load_dwordx4 v4, s[68:71], s47 offen offset:0 sc1 lds
    v_mfma_f32_16x16x32_bf16 v[52:55], v[76:79], a[112:115], v[52:55]
    v_mfma_f32_16x16x32_bf16 v[56:59], v[76:79], a[144:147], v[56:59]
    v_mfma_f32_16x16x32_bf16 v[60:63], v[76:79], a[176:179], v[60:63]
    s_waitcnt lgkmcnt(1)
    v_mfma_f32_16x16x32_bf16 v[40:43], v[80:83], a[12:15], v[40:43]
    ds_read_b128 v[88:91], v7 offset:2688
    v_mfma_f32_16x16x32_bf16 v[44:47], v[80:83], a[44:47], v[44:47]
    v_mfma_f32_16x16x32_bf16 v[48:51], v[80:83], a[76:79], v[48:51]
    buffer_load_dwordx4 v17, s[68:71], s47 offen offset:1024 sc1 lds
    v_mfma_f32_16x16x32_bf16 v[52:55], v[80:83], a[108:111], v[52:55]
    v_mfma_f32_16x16x32_bf16 v[56:59], v[80:83], a[140:143], v[56:59]
    v_mfma_f32_16x16x32_bf16 v[60:63], v[80:83], a[172:175], v[60:63]
    s_waitcnt lgkmcnt(1)
    v_mfma_f32_16x16x32_bf16 v[40:43], v[84:87], a[8:11], v[40:43]
    ds_read_b128 v[92:95], v7 offset:2624
    v_mfma_f32_16x16x32_bf16 v[44:47], v[84:87], a[40:43], v[44:47]
    v_mfma_f32_16x16x32_bf16 v[48:51], v[84:87], a[72:75], v[48:51]
    buffer_load_dwordx4 v17, s[68:71], s47 offen offset:2048 sc1 lds
    v_mfma_f32_16x16x32_bf16 v[52:55], v[84:87], a[104:107], v[52:55]
    v_mfma_f32_16x16x32_bf16 v[56:59], v[84:87], a[136:139], v[56:59]
    v_mfma_f32_16x16x32_bf16 v[60:63], v[84:87], a[168:171], v[60:63]
    s_waitcnt lgkmcnt(1)
    v_mfma_f32_16x16x32_bf16 v[40:43], v[88:91], a[4:7], v[40:43]
    ds_read_b128 v[64:67], v7 offset:2560
    v_mfma_f32_16x16x32_bf16 v[44:47], v[88:91], a[36:39], v[44:47]
    v_mfma_f32_16x16x32_bf16 v[48:51], v[88:91], a[68:71], v[48:51]
    buffer_load_dwordx4 v17, s[68:71], s47 offen offset:3072 sc1 lds
    v_mfma_f32_16x16x32_bf16 v[52:55], v[88:91], a[100:103], v[52:55]
    v_mfma_f32_16x16x32_bf16 v[56:59], v[88:91], a[132:135], v[56:59]
    v_mfma_f32_16x16x32_bf16 v[60:63], v[88:91], a[164:167], v[60:63]
    s_waitcnt lgkmcnt(1)
    v_mfma_f32_16x16x32_bf16 v[40:43], v[92:95], a[0:3], v[40:43]
    ds_read_b128 v[68:71], v7 offset:2496
    v_mfma_f32_16x16x32_bf16 v[44:47], v[92:95], a[32:35], v[44:47]
    v_mfma_f32_16x16x32_bf16 v[48:51], v[92:95], a[64:67], v[48:51]
    s_add_u32 m0, s57, 22016
    s_mov_b32 s47, 4100
    s_mov_b32 exec_hi, 0
    buffer_load_dwordx4 v17, s[68:71], s47 offen sc1 lds
    s_mov_b64 exec, -1
    v_mfma_f32_16x16x32_bf16 v[52:55], v[92:95], a[96:99], v[52:55]
    v_mfma_f32_16x16x32_bf16 v[56:59], v[92:95], a[128:131], v[56:59]
    v_mfma_f32_16x16x32_bf16 v[60:63], v[92:95], a[160:163], v[60:63]
    ds_read_b128 v[72:75], v7 offset:2432
    s_waitcnt lgkmcnt(2)
    v_mfma_f32_16x16x32_bf16 v[40:43], v[64:67], v[96:99], v[40:43]
    v_mfma_f32_16x16x32_bf16 v[44:47], v[64:67], a[28:31], v[44:47]
    v_mfma_f32_16x16x32_bf16 v[48:51], v[64:67], a[60:63], v[48:51]
    s_add_u32 m0, s57, 26656
    s_mov_b32 s47, 4104
    s_mov_b32 exec_hi, 0
    buffer_load_dwordx4 v17, s[68:71], s47 offen sc1 lds
    s_mov_b64 exec, -1
    v_mfma_f32_16x16x32_bf16 v[52:55], v[64:67], a[92:95], v[52:55]
    v_mfma_f32_16x16x32_bf16 v[56:59], v[64:67], a[124:127], v[56:59]
    ds_read_b128 v[76:79], v7 offset:2368
    v_mfma_f32_16x16x32_bf16 v[60:63], v[64:67], a[156:159], v[60:63]
    s_waitcnt lgkmcnt(2)
    v_mfma_f32_16x16x32_bf16 v[44:47], v[68:71], a[24:27], v[44:47]
    v_cvt_pk_bf16_f32 v100, v40, v41
    v_cvt_pk_bf16_f32 v101, v42, v43
    v_mfma_f32_16x16x32_bf16 v[48:51], v[68:71], a[56:59], v[48:51]
    ds_write_b32 v8, v100 offset:1024
    ds_write_b32 v8, v101 offset:1040
    v_mfma_f32_16x16x32_bf16 v[52:55], v[68:71], a[88:91], v[52:55]
    s_add_u32 m0, s57, 31296
    s_mov_b32 s47, 4108
    s_mov_b32 exec_hi, 0
    buffer_load_dwordx4 v17, s[68:71], s47 offen sc1 lds
    s_mov_b64 exec, -1
    v_mfma_f32_16x16x32_bf16 v[56:59], v[68:71], a[120:123], v[56:59]
    ds_read_b128 v[80:83], v7 offset:2304
    v_mfma_f32_16x16x32_bf16 v[60:63], v[68:71], a[152:155], v[60:63]
    s_waitcnt lgkmcnt(4)
    v_mfma_f32_16x16x32_bf16 v[44:47], v[72:75], a[20:23], v[44:47]
    v_mfma_f32_16x16x32_bf16 v[48:51], v[72:75], a[52:55], v[48:51]
    v_mfma_f32_16x16x32_bf16 v[52:55], v[72:75], a[84:87], v[52:55]
    v_mfma_f32_16x16x32_bf16 v[56:59], v[72:75], a[116:119], v[56:59]
    ds_read_b128 v[84:87], v7 offset:2240
    s_add_u32 m0, s57, 35936
    s_mov_b32 s47, 4112
    s_mov_b32 exec_hi, 0
    buffer_load_dwordx4 v17, s[68:71], s47 offen sc1 lds
    s_mov_b64 exec, -1
    v_mfma_f32_16x16x32_bf16 v[60:63], v[72:75], a[148:151], v[60:63]
    s_waitcnt lgkmcnt(4)
    v_mfma_f32_16x16x32_bf16 v[44:47], v[76:79], a[16:19], v[44:47]
    v_mfma_f32_16x16x32_bf16 v[48:51], v[76:79], a[48:51], v[48:51]
    v_mfma_f32_16x16x32_bf16 v[52:55], v[76:79], a[80:83], v[52:55]
    v_mfma_f32_16x16x32_bf16 v[56:59], v[76:79], a[112:115], v[56:59]
    ds_read_b128 v[88:91], v7 offset:2176
    v_mfma_f32_16x16x32_bf16 v[60:63], v[76:79], a[144:147], v[60:63]
    s_waitcnt lgkmcnt(2)
    v_mfma_f32_16x16x32_bf16 v[44:47], v[80:83], a[12:15], v[44:47]
    v_mfma_f32_16x16x32_bf16 v[48:51], v[80:83], a[44:47], v[48:51]
    v_mfma_f32_16x16x32_bf16 v[52:55], v[80:83], a[76:79], v[52:55]
    v_mfma_f32_16x16x32_bf16 v[56:59], v[80:83], a[108:111], v[56:59]
    ds_read_b128 v[92:95], v7 offset:2112
    v_mfma_f32_16x16x32_bf16 v[60:63], v[80:83], a[140:143], v[60:63]
    s_waitcnt lgkmcnt(2)
    v_mfma_f32_16x16x32_bf16 v[44:47], v[84:87], a[8:11], v[44:47]
    v_mfma_f32_16x16x32_bf16 v[48:51], v[84:87], a[40:43], v[48:51]
    v_mfma_f32_16x16x32_bf16 v[52:55], v[84:87], a[72:75], v[52:55]
    v_mfma_f32_16x16x32_bf16 v[56:59], v[84:87], a[104:107], v[56:59]
    ds_read_b128 v[64:67], v7 offset:2048
    v_mfma_f32_16x16x32_bf16 v[60:63], v[84:87], a[136:139], v[60:63]
    s_waitcnt lgkmcnt(2)
    v_mfma_f32_16x16x32_bf16 v[44:47], v[88:91], a[4:7], v[44:47]
    v_mfma_f32_16x16x32_bf16 v[48:51], v[88:91], a[36:39], v[48:51]
    v_mfma_f32_16x16x32_bf16 v[52:55], v[88:91], a[68:71], v[52:55]
    v_mfma_f32_16x16x32_bf16 v[56:59], v[88:91], a[100:103], v[56:59]
    ds_read_b128 v[68:71], v7 offset:1984
    v_mfma_f32_16x16x32_bf16 v[60:63], v[88:91], a[132:135], v[60:63]
    s_waitcnt lgkmcnt(2)
    v_mfma_f32_16x16x32_bf16 v[44:47], v[92:95], a[0:3], v[44:47]
    v_mfma_f32_16x16x32_bf16 v[48:51], v[92:95], a[32:35], v[48:51]
    v_mfma_f32_16x16x32_bf16 v[52:55], v[92:95], a[64:67], v[52:55]
    ds_read_b128 v[72:75], v7 offset:1920
    v_mfma_f32_16x16x32_bf16 v[56:59], v[92:95], a[96:99], v[56:59]
    v_mfma_f32_16x16x32_bf16 v[60:63], v[92:95], a[128:131], v[60:63]
    s_waitcnt lgkmcnt(2)
    v_mfma_f32_16x16x32_bf16 v[44:47], v[64:67], v[96:99], v[44:47]
    v_mfma_f32_16x16x32_bf16 v[48:51], v[64:67], a[28:31], v[48:51]
    ds_read_b128 v[76:79], v7 offset:1856
    v_mfma_f32_16x16x32_bf16 v[52:55], v[64:67], a[60:63], v[52:55]
    v_mfma_f32_16x16x32_bf16 v[56:59], v[64:67], a[92:95], v[56:59]
    v_mfma_f32_16x16x32_bf16 v[60:63], v[64:67], a[124:127], v[60:63]
    s_waitcnt lgkmcnt(2)
    v_mfma_f32_16x16x32_bf16 v[48:51], v[68:71], a[24:27], v[48:51]
    ds_read_b128 v[80:83], v7 offset:1792
    v_cvt_pk_bf16_f32 v102, v44, v45
    v_mfma_f32_16x16x32_bf16 v[52:55], v[68:71], a[56:59], v[52:55]
    v_cvt_pk_bf16_f32 v103, v46, v47
    ds_write_b32 v8, v102 offset:1536
    v_mfma_f32_16x16x32_bf16 v[56:59], v[68:71], a[88:91], v[56:59]
    ds_write_b32 v8, v103 offset:1552
    ds_read_b128 v[108:111], v9 offset:1024
    v_mfma_f32_16x16x32_bf16 v[60:63], v[68:71], a[120:123], v[60:63]
    s_waitcnt lgkmcnt(5)
    v_mfma_f32_16x16x32_bf16 v[48:51], v[72:75], a[20:23], v[48:51]
    ds_read_b128 v[84:87], v7 offset:1728
    v_mfma_f32_16x16x32_bf16 v[52:55], v[72:75], a[52:55], v[52:55]
    v_mfma_f32_16x16x32_bf16 v[56:59], v[72:75], a[84:87], v[56:59]
    v_mfma_f32_16x16x32_bf16 v[60:63], v[72:75], a[116:119], v[60:63]
    s_waitcnt lgkmcnt(5)
    v_mfma_f32_16x16x32_bf16 v[48:51], v[76:79], a[16:19], v[48:51]
    ds_read_b128 v[88:91], v7 offset:1664
    v_mfma_f32_16x16x32_bf16 v[52:55], v[76:79], a[48:51], v[52:55]
    s_waitcnt lgkmcnt(2)
    buffer_store_dwordx4 v[108:111], v17, s[12:15], s63 offen offset:1024 sc1
    v_mfma_f32_16x16x32_bf16 v[56:59], v[76:79], a[80:83], v[56:59]
    v_mfma_f32_16x16x32_bf16 v[60:63], v[76:79], a[112:115], v[60:63]
    v_mfma_f32_16x16x32_bf16 v[48:51], v[80:83], a[12:15], v[48:51]
    ds_read_b128 v[92:95], v7 offset:1600
    v_mfma_f32_16x16x32_bf16 v[52:55], v[80:83], a[44:47], v[52:55]
    v_mfma_f32_16x16x32_bf16 v[56:59], v[80:83], a[76:79], v[56:59]
    v_mfma_f32_16x16x32_bf16 v[60:63], v[80:83], a[108:111], v[60:63]
    s_waitcnt lgkmcnt(2)
    v_mfma_f32_16x16x32_bf16 v[48:51], v[84:87], a[8:11], v[48:51]
    ds_read_b128 v[64:67], v7 offset:1536
    v_mfma_f32_16x16x32_bf16 v[52:55], v[84:87], a[40:43], v[52:55]
    v_mfma_f32_16x16x32_bf16 v[56:59], v[84:87], a[72:75], v[56:59]
    v_mfma_f32_16x16x32_bf16 v[60:63], v[84:87], a[104:107], v[60:63]
    s_waitcnt lgkmcnt(2)
    v_mfma_f32_16x16x32_bf16 v[48:51], v[88:91], a[4:7], v[48:51]
    ds_read_b128 v[68:71], v7 offset:1472
    v_mfma_f32_16x16x32_bf16 v[52:55], v[88:91], a[36:39], v[52:55]
    v_mfma_f32_16x16x32_bf16 v[56:59], v[88:91], a[68:71], v[56:59]
    v_mfma_f32_16x16x32_bf16 v[60:63], v[88:91], a[100:103], v[60:63]
    ds_read_b128 v[72:75], v7 offset:1408
    s_waitcnt lgkmcnt(3)
    v_mfma_f32_16x16x32_bf16 v[48:51], v[92:95], a[0:3], v[48:51]
    v_mfma_f32_16x16x32_bf16 v[52:55], v[92:95], a[32:35], v[52:55]
    v_mfma_f32_16x16x32_bf16 v[56:59], v[92:95], a[64:67], v[56:59]
    ds_read_b128 v[76:79], v7 offset:1344
    v_mfma_f32_16x16x32_bf16 v[60:63], v[92:95], a[96:99], v[60:63]
    s_waitcnt lgkmcnt(3)
    v_mfma_f32_16x16x32_bf16 v[48:51], v[64:67], v[96:99], v[48:51]
    v_mfma_f32_16x16x32_bf16 v[52:55], v[64:67], a[28:31], v[52:55]
    ds_read_b128 v[80:83], v7 offset:1280
    v_mfma_f32_16x16x32_bf16 v[56:59], v[64:67], a[60:63], v[56:59]
    v_mfma_f32_16x16x32_bf16 v[60:63], v[64:67], a[92:95], v[60:63]
    s_waitcnt lgkmcnt(3)
    v_mfma_f32_16x16x32_bf16 v[52:55], v[68:71], a[24:27], v[52:55]
    ds_read_b128 v[84:87], v7 offset:1216
    v_mfma_f32_16x16x32_bf16 v[56:59], v[68:71], a[56:59], v[56:59]
    v_cvt_pk_bf16_f32 v100, v48, v49
    v_cvt_pk_bf16_f32 v101, v50, v51
    v_mfma_f32_16x16x32_bf16 v[60:63], v[68:71], a[88:91], v[60:63]
    ds_write_b32 v8, v100 offset:2048
    ds_write_b32 v8, v101 offset:2064
    s_waitcnt lgkmcnt(5)
    v_mfma_f32_16x16x32_bf16 v[52:55], v[72:75], a[20:23], v[52:55]
    ds_read_b128 v[88:91], v7 offset:1152
    v_mfma_f32_16x16x32_bf16 v[56:59], v[72:75], a[52:55], v[56:59]
    v_mfma_f32_16x16x32_bf16 v[60:63], v[72:75], a[84:87], v[60:63]
    s_waitcnt lgkmcnt(5)
    v_mfma_f32_16x16x32_bf16 v[52:55], v[76:79], a[16:19], v[52:55]
    ds_read_b128 v[92:95], v7 offset:1088
    v_mfma_f32_16x16x32_bf16 v[56:59], v[76:79], a[48:51], v[56:59]
    v_mfma_f32_16x16x32_bf16 v[60:63], v[76:79], a[80:83], v[60:63]
    s_waitcnt lgkmcnt(5)
    v_mfma_f32_16x16x32_bf16 v[52:55], v[80:83], a[12:15], v[52:55]
    ds_read_b128 v[64:67], v7 offset:1024
    v_mfma_f32_16x16x32_bf16 v[56:59], v[80:83], a[44:47], v[56:59]
    v_mfma_f32_16x16x32_bf16 v[60:63], v[80:83], a[76:79], v[60:63]
    s_waitcnt lgkmcnt(5)
    v_mfma_f32_16x16x32_bf16 v[52:55], v[84:87], a[8:11], v[52:55]
    ds_read_b128 v[68:71], v7 offset:960
    v_mfma_f32_16x16x32_bf16 v[56:59], v[84:87], a[40:43], v[56:59]
    v_mfma_f32_16x16x32_bf16 v[60:63], v[84:87], a[72:75], v[60:63]
    ds_read_b128 v[72:75], v7 offset:896
    s_waitcnt lgkmcnt(4)
    v_mfma_f32_16x16x32_bf16 v[52:55], v[88:91], a[4:7], v[52:55]
    v_mfma_f32_16x16x32_bf16 v[56:59], v[88:91], a[36:39], v[56:59]
    ds_read_b128 v[76:79], v7 offset:832
    v_mfma_f32_16x16x32_bf16 v[60:63], v[88:91], a[68:71], v[60:63]
    s_waitcnt lgkmcnt(4)
    v_mfma_f32_16x16x32_bf16 v[52:55], v[92:95], a[0:3], v[52:55]
    ds_read_b128 v[80:83], v7 offset:768
    v_mfma_f32_16x16x32_bf16 v[56:59], v[92:95], a[32:35], v[56:59]
    v_mfma_f32_16x16x32_bf16 v[60:63], v[92:95], a[64:67], v[60:63]
    ds_read_b128 v[84:87], v7 offset:704
    s_waitcnt lgkmcnt(5)
    v_mfma_f32_16x16x32_bf16 v[52:55], v[64:67], v[96:99], v[52:55]
    v_mfma_f32_16x16x32_bf16 v[56:59], v[64:67], a[28:31], v[56:59]
    ds_read_b128 v[88:91], v7 offset:640
    v_mfma_f32_16x16x32_bf16 v[60:63], v[64:67], a[60:63], v[60:63]
    s_waitcnt lgkmcnt(4)
    v_mfma_f32_16x16x32_bf16 v[56:59], v[68:71], a[24:27], v[56:59]
    ds_read_b128 v[92:95], v7 offset:576
    v_mfma_f32_16x16x32_bf16 v[60:63], v[68:71], a[56:59], v[60:63]
    v_mfma_f32_16x16x32_bf16 v[56:59], v[72:75], a[20:23], v[56:59]
    ds_read_b128 v[64:67], v7 offset:512
    v_cvt_pk_bf16_f32 v102, v52, v53
    v_mfma_f32_16x16x32_bf16 v[60:63], v[72:75], a[52:55], v[60:63]
    v_cvt_pk_bf16_f32 v103, v54, v55
    ds_write_b32 v8, v102 offset:2560
    s_waitcnt lgkmcnt(5)
    v_mfma_f32_16x16x32_bf16 v[56:59], v[76:79], a[16:19], v[56:59]
    ds_read_b128 v[68:71], v7 offset:448
    ds_write_b32 v8, v103 offset:2576
    v_mfma_f32_16x16x32_bf16 v[60:63], v[76:79], a[48:51], v[60:63]
    ds_read_b128 v[72:75], v7 offset:384
    ds_read_b128 v[104:107], v9 offset:2048
    v_mfma_f32_16x16x32_bf16 v[56:59], v[80:83], a[12:15], v[56:59]
    ds_read_b128 v[76:79], v7 offset:320
    v_mfma_f32_16x16x32_bf16 v[60:63], v[80:83], a[44:47], v[60:63]
    ds_read_b128 v[80:83], v7 offset:256
    s_waitcnt lgkmcnt(9)
    v_mfma_f32_16x16x32_bf16 v[56:59], v[84:87], a[8:11], v[56:59]
    v_mfma_f32_16x16x32_bf16 v[60:63], v[84:87], a[40:43], v[60:63]
    ds_read_b128 v[84:87], v7 offset:192
    v_mfma_f32_16x16x32_bf16 v[56:59], v[88:91], a[4:7], v[56:59]
    v_mfma_f32_16x16x32_bf16 v[60:63], v[88:91], a[36:39], v[60:63]
    ds_read_b128 v[88:91], v7 offset:128
    s_waitcnt lgkmcnt(4)
    buffer_store_dwordx4 v[104:107], v17, s[12:15], s63 offen offset:2048 sc1
    v_mfma_f32_16x16x32_bf16 v[56:59], v[92:95], a[0:3], v[56:59]
    v_mfma_f32_16x16x32_bf16 v[60:63], v[92:95], a[32:35], v[60:63]
    ds_read_b128 v[92:95], v7 offset:64
    v_mfma_f32_16x16x32_bf16 v[56:59], v[64:67], v[96:99], v[56:59]
    v_mfma_f32_16x16x32_bf16 v[60:63], v[64:67], a[28:31], v[60:63]
    ds_read_b128 v[64:67], v7 offset:0
    v_mfma_f32_16x16x32_bf16 v[60:63], v[68:71], a[24:27], v[60:63]
    v_mfma_f32_16x16x32_bf16 v[60:63], v[72:75], a[20:23], v[60:63]
    s_waitcnt lgkmcnt(3)
    v_mfma_f32_16x16x32_bf16 v[60:63], v[76:79], a[16:19], v[60:63]
    v_mfma_f32_16x16x32_bf16 v[60:63], v[80:83], a[12:15], v[60:63]
    v_mfma_f32_16x16x32_bf16 v[60:63], v[84:87], a[8:11], v[60:63]
    v_cvt_pk_bf16_f32 v100, v56, v57
    v_cvt_pk_bf16_f32 v101, v58, v59
    s_waitcnt lgkmcnt(0)
    v_mfma_f32_16x16x32_bf16 v[60:63], v[88:91], a[4:7], v[60:63]
    ds_write_b32 v8, v100 offset:3072
    ds_write_b32 v8, v101 offset:3088
    v_mfma_f32_16x16x32_bf16 v[60:63], v[92:95], a[0:3], v[60:63]
    v_mfma_f32_16x16x32_bf16 v[60:63], v[64:67], v[96:99], v[60:63]
    s_nop 0
    s_nop 0
    s_nop 0
    s_nop 0
    s_nop 0
    s_nop 0
    s_nop 0
    s_nop 0
    v_cvt_pk_bf16_f32 v102, v60, v61
    v_cvt_pk_bf16_f32 v103, v62, v63
    ds_write_b32 v8, v102 offset:3584
    ds_write_b32 v8, v103 offset:3600
    ds_read_b128 v[108:111], v9 offset:3072
    s_nop 0
    s_nop 0
    s_nop 0
    s_nop 0
    s_nop 0
    s_nop 0
    s_nop 0
    s_nop 0
    s_nop 0
    s_nop 0
    s_nop 0
    s_waitcnt lgkmcnt(0)
    buffer_store_dwordx4 v[108:111], v17, s[12:15], s63 offen offset:3072 sc1
    s_lshl_b32 s63, s60, 12
    s_add_u32 s63, s63, 24117248
    s_waitcnt vmcnt(3)
    ds_read_b128 v[64:67], v7 offset:13056
    ds_read_b128 a[28:31], v6 offset:512
    ds_read_b128 a[60:63], v6 offset:1024
    ds_read_b128 a[92:95], v6 offset:1536
    ds_read_b128 a[124:127], v6 offset:2048
    ds_read_b128 a[156:159], v6 offset:2560
    ds_read_b128 a[188:191], v6 offset:3072
    ds_read_b128 a[220:223], v6 offset:3584
    ds_read_b128 a[252:255], v6 offset:4096
    ds_read_b128 v[68:71], v7 offset:12992
    ds_read_b128 a[24:27], v6 offset:448
    ds_read_b128 a[56:59], v6 offset:960
    s_waitcnt lgkmcnt(8)
    v_mfma_f32_16x16x32_bf16 v[32:35], v[64:67], a[28:31], 0
    ds_read_b128 a[88:91], v6 offset:1472
    ds_read_b128 a[120:123], v6 offset:1984
    v_mfma_f32_16x16x32_bf16 v[36:39], v[64:67], a[60:63], 0
    ds_read_b128 a[152:155], v6 offset:2496
    ds_read_b128 a[184:187], v6 offset:3008
    v_mfma_f32_16x16x32_bf16 v[40:43], v[64:67], a[92:95], 0
    ds_read_b128 a[216:219], v6 offset:3520
    s_waitcnt lgkmcnt(10)
    v_mfma_f32_16x16x32_bf16 v[44:47], v[64:67], a[124:127], 0
    ds_read_b128 a[248:251], v6 offset:4032
    v_mfma_f32_16x16x32_bf16 v[48:51], v[64:67], a[156:159], 0
    ds_read_b128 v[72:75], v7 offset:12928
    ds_read_b128 a[20:23], v6 offset:384
    v_mfma_f32_16x16x32_bf16 v[52:55], v[64:67], a[188:191], 0
    ds_read_b128 a[52:55], v6 offset:896
    s_waitcnt lgkmcnt(10)
    v_mfma_f32_16x16x32_bf16 v[56:59], v[64:67], a[220:223], 0
    ds_read_b128 a[84:87], v6 offset:1408
    v_mfma_f32_16x16x32_bf16 v[60:63], v[64:67], a[252:255], 0
    ds_read_b128 a[116:119], v6 offset:1920
    v_mfma_f32_16x16x32_bf16 v[32:35], v[68:71], a[24:27], v[32:35]
    ds_read_b128 a[148:151], v6 offset:2432
    s_waitcnt lgkmcnt(10)
    v_mfma_f32_16x16x32_bf16 v[36:39], v[68:71], a[56:59], v[36:39]
    ds_read_b128 a[180:183], v6 offset:2944
    v_mfma_f32_16x16x32_bf16 v[40:43], v[68:71], a[88:91], v[40:43]
    ds_read_b128 a[212:215], v6 offset:3456
    v_mfma_f32_16x16x32_bf16 v[44:47], v[68:71], a[120:123], v[44:47]
    ds_read_b128 a[244:247], v6 offset:3968
    s_waitcnt lgkmcnt(10)
    v_mfma_f32_16x16x32_bf16 v[48:51], v[68:71], a[152:155], v[48:51]
    ds_read_b128 v[76:79], v7 offset:12864
    ds_read_b128 a[16:19], v6 offset:320
    v_mfma_f32_16x16x32_bf16 v[52:55], v[68:71], a[184:187], v[52:55]
    ds_read_b128 a[48:51], v6 offset:832
    v_mfma_f32_16x16x32_bf16 v[56:59], v[68:71], a[216:219], v[56:59]
    ds_read_b128 a[80:83], v6 offset:1344
    s_waitcnt lgkmcnt(10)
    v_mfma_f32_16x16x32_bf16 v[60:63], v[68:71], a[248:251], v[60:63]
    ds_read_b128 a[112:115], v6 offset:1856
    v_mfma_f32_16x16x32_bf16 v[32:35], v[72:75], a[20:23], v[32:35]
    ds_read_b128 a[144:147], v6 offset:2368
    v_mfma_f32_16x16x32_bf16 v[36:39], v[72:75], a[52:55], v[36:39]
    ds_read_b128 a[176:179], v6 offset:2880
    s_waitcnt lgkmcnt(10)
    v_mfma_f32_16x16x32_bf16 v[40:43], v[72:75], a[84:87], v[40:43]
    ds_read_b128 a[208:211], v6 offset:3392
    v_mfma_f32_16x16x32_bf16 v[44:47], v[72:75], a[116:119], v[44:47]
    ds_read_b128 a[240:243], v6 offset:3904
    v_mfma_f32_16x16x32_bf16 v[48:51], v[72:75], a[148:151], v[48:51]
    ds_read_b128 v[80:83], v7 offset:12800
    ds_read_b128 a[12:15], v6 offset:256
    s_waitcnt lgkmcnt(11)
    v_mfma_f32_16x16x32_bf16 v[52:55], v[72:75], a[180:183], v[52:55]
    ds_read_b128 a[44:47], v6 offset:768
    v_mfma_f32_16x16x32_bf16 v[56:59], v[72:75], a[212:215], v[56:59]
    ds_read_b128 a[76:79], v6 offset:1280
    v_mfma_f32_16x16x32_bf16 v[60:63], v[72:75], a[244:247], v[60:63]
    ds_read_b128 a[108:111], v6 offset:1792
    s_waitcnt lgkmcnt(10)
    v_mfma_f32_16x16x32_bf16 v[32:35], v[76:79], a[16:19], v[32:35]
    ds_read_b128 a[140:143], v6 offset:2304
    v_mfma_f32_16x16x32_bf16 v[36:39], v[76:79], a[48:51], v[36:39]
    ds_read_b128 a[172:175], v6 offset:2816
    v_mfma_f32_16x16x32_bf16 v[40:43], v[76:79], a[80:83], v[40:43]
    ds_read_b128 a[204:207], v6 offset:3328
    s_waitcnt lgkmcnt(10)
    v_mfma_f32_16x16x32_bf16 v[44:47], v[76:79], a[112:115], v[44:47]
    ds_read_b128 a[236:239], v6 offset:3840
    v_mfma_f32_16x16x32_bf16 v[48:51], v[76:79], a[144:147], v[48:51]
    ds_read_b128 v[84:87], v7 offset:12736
    ds_read_b128 a[8:11], v6 offset:192
    v_mfma_f32_16x16x32_bf16 v[52:55], v[76:79], a[176:179], v[52:55]
    ds_read_b128 a[40:43], v6 offset:704
    s_waitcnt lgkmcnt(10)
    v_mfma_f32_16x16x32_bf16 v[56:59], v[76:79], a[208:211], v[56:59]
    ds_read_b128 a[72:75], v6 offset:1216
    v_mfma_f32_16x16x32_bf16 v[60:63], v[76:79], a[240:243], v[60:63]
    ds_read_b128 a[104:107], v6 offset:1728
    v_mfma_f32_16x16x32_bf16 v[32:35], v[80:83], a[12:15], v[32:35]
    ds_read_b128 a[136:139], v6 offset:2240
    s_waitcnt lgkmcnt(10)
    v_mfma_f32_16x16x32_bf16 v[36:39], v[80:83], a[44:47], v[36:39]
    ds_read_b128 a[168:171], v6 offset:2752
    v_mfma_f32_16x16x32_bf16 v[40:43], v[80:83], a[76:79], v[40:43]
    ds_read_b128 a[200:203], v6 offset:3264
    v_mfma_f32_16x16x32_bf16 v[44:47], v[80:83], a[108:111], v[44:47]
    ds_read_b128 a[232:235], v6 offset:3776
    s_waitcnt lgkmcnt(10)
    v_mfma_f32_16x16x32_bf16 v[48:51], v[80:83], a[140:143], v[48:51]
    ds_read_b128 v[88:91], v7 offset:12672
    ds_read_b128 a[4:7], v6 offset:128
    v_mfma_f32_16x16x32_bf16 v[52:55], v[80:83], a[172:175], v[52:55]
    ds_read_b128 a[36:39], v6 offset:640
    v_mfma_f32_16x16x32_bf16 v[56:59], v[80:83], a[204:207], v[56:59]
    ds_read_b128 a[68:71], v6 offset:1152
    s_waitcnt lgkmcnt(10)
    v_mfma_f32_16x16x32_bf16 v[60:63], v[80:83], a[236:239], v[60:63]
    ds_read_b128 a[100:103], v6 offset:1664
    v_mfma_f32_16x16x32_bf16 v[32:35], v[84:87], a[8:11], v[32:35]
    ds_read_b128 a[132:135], v6 offset:2176
    v_mfma_f32_16x16x32_bf16 v[36:39], v[84:87], a[40:43], v[36:39]
    ds_read_b128 a[164:167], v6 offset:2688
    s_waitcnt lgkmcnt(10)
    v_mfma_f32_16x16x32_bf16 v[40:43], v[84:87], a[72:75], v[40:43]
    ds_read_b128 a[196:199], v6 offset:3200
    v_mfma_f32_16x16x32_bf16 v[44:47], v[84:87], a[104:107], v[44:47]
    ds_read_b128 a[228:231], v6 offset:3712
    v_mfma_f32_16x16x32_bf16 v[48:51], v[84:87], a[136:139], v[48:51]
    ds_read_b128 v[92:95], v7 offset:12608
    ds_read_b128 a[0:3], v6 offset:64
    s_waitcnt lgkmcnt(11)
    v_mfma_f32_16x16x32_bf16 v[52:55], v[84:87], a[168:171], v[52:55]
    ds_read_b128 a[32:35], v6 offset:576
    v_mfma_f32_16x16x32_bf16 v[56:59], v[84:87], a[200:203], v[56:59]
    ds_read_b128 a[64:67], v6 offset:1088
    v_mfma_f32_16x16x32_bf16 v[60:63], v[84:87], a[232:235], v[60:63]
    ds_read_b128 a[96:99], v6 offset:1600
    s_waitcnt lgkmcnt(10)
    v_mfma_f32_16x16x32_bf16 v[32:35], v[88:91], a[4:7], v[32:35]
    ds_read_b128 a[128:131], v6 offset:2112
    v_mfma_f32_16x16x32_bf16 v[36:39], v[88:91], a[36:39], v[36:39]
    ds_read_b128 a[160:163], v6 offset:2624
    v_mfma_f32_16x16x32_bf16 v[40:43], v[88:91], a[68:71], v[40:43]
    ds_read_b128 a[192:195], v6 offset:3136
    s_waitcnt lgkmcnt(10)
    v_mfma_f32_16x16x32_bf16 v[44:47], v[88:91], a[100:103], v[44:47]
    ds_read_b128 a[224:227], v6 offset:3648
    v_mfma_f32_16x16x32_bf16 v[48:51], v[88:91], a[132:135], v[48:51]
    ds_read_b128 v[64:67], v7 offset:12544
    ds_read_b128 v[96:99], v6 offset:0
    v_mfma_f32_16x16x32_bf16 v[52:55], v[88:91], a[164:167], v[52:55]
    s_waitcnt lgkmcnt(9)
    v_mfma_f32_16x16x32_bf16 v[56:59], v[88:91], a[196:199], v[56:59]
    v_mfma_f32_16x16x32_bf16 v[60:63], v[88:91], a[228:231], v[60:63]
    v_mfma_f32_16x16x32_bf16 v[32:35], v[92:95], a[0:3], v[32:35]
    s_waitcnt lgkmcnt(6)
    v_mfma_f32_16x16x32_bf16 v[36:39], v[92:95], a[32:35], v[36:39]
    v_mfma_f32_16x16x32_bf16 v[40:43], v[92:95], a[64:67], v[40:43]
    v_mfma_f32_16x16x32_bf16 v[44:47], v[92:95], a[96:99], v[44:47]
    s_waitcnt lgkmcnt(3)
    v_mfma_f32_16x16x32_bf16 v[48:51], v[92:95], a[128:131], v[48:51]
    ds_read_b128 v[68:71], v7 offset:12480
    v_mfma_f32_16x16x32_bf16 v[52:55], v[92:95], a[160:163], v[52:55]
    v_mfma_f32_16x16x32_bf16 v[56:59], v[92:95], a[192:195], v[56:59]
    s_waitcnt lgkmcnt(1)
    v_mfma_f32_16x16x32_bf16 v[60:63], v[92:95], a[224:227], v[60:63]
    s_add_u32 s60, s56, 8
    s_mul_i32 s44, s60, 4224
    v_mfma_f32_16x16x32_bf16 v[32:35], v[64:67], v[96:99], v[32:35]
    s_add_u32 s44, s44, 18874080
    s_add_u32 s68, s34, s44
    v_mfma_f32_16x16x32_bf16 v[36:39], v[64:67], a[28:31], v[36:39]
    s_addc_u32 s69, s35, 0
    s_and_b32 s69, s69, 0xffff
    v_mfma_f32_16x16x32_bf16 v[40:43], v[64:67], a[60:63], v[40:43]
    s_mov_b32 s70, 4512
    s_mov_b32 s71, 0x00020000
    v_mfma_f32_16x16x32_bf16 v[44:47], v[64:67], a[92:95], v[44:47]
    ds_read_b128 v[72:75], v7 offset:12416
    v_cvt_pk_bf16_f32 v100, v32, v33
    v_mfma_f32_16x16x32_bf16 v[48:51], v[64:67], a[124:127], v[48:51]
    v_cvt_pk_bf16_f32 v101, v34, v35
    ds_write_b32 v8, v100 offset:0
    v_mfma_f32_16x16x32_bf16 v[52:55], v[64:67], a[156:159], v[52:55]
    ds_write_b32 v8, v101 offset:16
    s_add_u32 m0, s57, 17920
    v_mfma_f32_16x16x32_bf16 v[56:59], v[64:67], a[188:191], v[56:59]
    s_mov_b32 s47, 4
    buffer_load_dwordx4 v4, s[68:71], s47 offen offset:0 sc1 lds
    v_mfma_f32_16x16x32_bf16 v[60:63], v[64:67], a[220:223], v[60:63]
    s_waitcnt lgkmcnt(3)
    v_mfma_f32_16x16x32_bf16 v[36:39], v[68:71], a[24:27], v[36:39]
    v_mfma_f32_16x16x32_bf16 v[40:43], v[68:71], a[56:59], v[40:43]
    v_mfma_f32_16x16x32_bf16 v[44:47], v[68:71], a[88:91], v[44:47]
    ds_read_b128 v[76:79], v7 offset:12352
    v_mfma_f32_16x16x32_bf16 v[48:51], v[68:71], a[120:123], v[48:51]
    v_mfma_f32_16x16x32_bf16 v[52:55], v[68:71], a[152:155], v[52:55]
    buffer_load_dwordx4 v17, s[68:71], s47 offen offset:1024 sc1 lds
    v_mfma_f32_16x16x32_bf16 v[56:59], v[68:71], a[184:187], v[56:59]
    v_mfma_f32_16x16x32_bf16 v[60:63], v[68:71], a[216:219], v[60:63]
    s_waitcnt lgkmcnt(3)
    v_mfma_f32_16x16x32_bf16 v[36:39], v[72:75], a[20:23], v[36:39]
    v_mfma_f32_16x16x32_bf16 v[40:43], v[72:75], a[52:55], v[40:43]
    v_mfma_f32_16x16x32_bf16 v[44:47], v[72:75], a[84:87], v[44:47]
    ds_read_b128 v[80:83], v7 offset:12288
    v_mfma_f32_16x16x32_bf16 v[48:51], v[72:75], a[116:119], v[48:51]
    buffer_load_dwordx4 v17, s[68:71], s47 offen offset:2048 sc1 lds
    v_mfma_f32_16x16x32_bf16 v[52:55], v[72:75], a[148:151], v[52:55]
    v_mfma_f32_16x16x32_bf16 v[56:59], v[72:75], a[180:183], v[56:59]
    v_mfma_f32_16x16x32_bf16 v[60:63], v[72:75], a[212:215], v[60:63]
    s_waitcnt lgkmcnt(1)
    v_mfma_f32_16x16x32_bf16 v[36:39], v[76:79], a[16:19], v[36:39]
    v_mfma_f32_16x16x32_bf16 v[40:43], v[76:79], a[48:51], v[40:43]
    v_mfma_f32_16x16x32_bf16 v[44:47], v[76:79], a[80:83], v[44:47]
    ds_read_b128 v[84:87], v7 offset:12224
    buffer_load_dwordx4 v17, s[68:71], s47 offen offset:3072 sc1 lds
    v_mfma_f32_16x16x32_bf16 v[48:51], v[76:79], a[112:115], v[48:51]
    s_add_u32 m0, s57, 22560
    s_mov_b32 s47, 8
    v_mfma_f32_16x16x32_bf16 v[52:55], v[76:79], a[144:147], v[52:55]
    v_mfma_f32_16x16x32_bf16 v[56:59], v[76:79], a[176:179], v[56:59]
    v_mfma_f32_16x16x32_bf16 v[60:63], v[76:79], a[208:211], v[60:63]
    s_waitcnt lgkmcnt(1)
    v_mfma_f32_16x16x32_bf16 v[36:39], v[80:83], a[12:15], v[36:39]
    v_mfma_f32_16x16x32_bf16 v[40:43], v[80:83], a[44:47], v[40:43]
    buffer_load_dwordx4 v4, s[68:71], s47 offen offset:0 sc1 lds
    v_mfma_f32_16x16x32_bf16 v[44:47], v[80:83], a[76:79], v[44:47]
    ds_read_b128 v[88:91], v7 offset:12160
    v_mfma_f32_16x16x32_bf16 v[48:51], v[80:83], a[108:111], v[48:51]
    v_mfma_f32_16x16x32_bf16 v[52:55], v[80:83], a[140:143], v[52:55]
    v_mfma_f32_16x16x32_bf16 v[56:59], v[80:83], a[172:175], v[56:59]
    v_mfma_f32_16x16x32_bf16 v[60:63], v[80:83], a[204:207], v[60:63]
    s_waitcnt lgkmcnt(1)
    v_mfma_f32_16x16x32_bf16 v[36:39], v[84:87], a[8:11], v[36:39]
    buffer_load_dwordx4 v17, s[68:71], s47 offen offset:1024 sc1 lds
    v_mfma_f32_16x16x32_bf16 v[40:43], v[84:87], a[40:43], v[40:43]
    v_mfma_f32_16x16x32_bf16 v[44:47], v[84:87], a[72:75], v[44:47]
    ds_read_b128 v[92:95], v7 offset:12096
    v_mfma_f32_16x16x32_bf16 v[48:51], v[84:87], a[104:107], v[48:51]
    v_mfma_f32_16x16x32_bf16 v[52:55], v[84:87], a[136:139], v[52:55]
    v_mfma_f32_16x16x32_bf16 v[56:59], v[84:87], a[168:171], v[56:59]
    v_mfma_f32_16x16x32_bf16 v[60:63], v[84:87], a[200:203], v[60:63]
    buffer_load_dwordx4 v17, s[68:71], s47 offen offset:2048 sc1 lds
    s_waitcnt lgkmcnt(1)
    v_mfma_f32_16x16x32_bf16 v[36:39], v[88:91], a[4:7], v[36:39]
    v_mfma_f32_16x16x32_bf16 v[40:43], v[88:91], a[36:39], v[40:43]
    v_mfma_f32_16x16x32_bf16 v[44:47], v[88:91], a[68:71], v[44:47]
    ds_read_b128 v[64:67], v7 offset:12032
    v_mfma_f32_16x16x32_bf16 v[48:51], v[88:91], a[100:103], v[48:51]
    v_mfma_f32_16x16x32_bf16 v[52:55], v[88:91], a[132:135], v[52:55]
    v_mfma_f32_16x16x32_bf16 v[56:59], v[88:91], a[164:167], v[56:59]
    buffer_load_dwordx4 v17, s[68:71], s47 offen offset:3072 sc1 lds
    v_mfma_f32_16x16x32_bf16 v[60:63], v[88:91], a[196:199], v[60:63]
    s_add_u32 m0, s57, 27200
    s_mov_b32 s47, 12
    s_waitcnt lgkmcnt(1)
    v_mfma_f32_16x16x32_bf16 v[36:39], v[92:95], a[0:3], v[36:39]
    v_mfma_f32_16x16x32_bf16 v[40:43], v[92:95], a[32:35], v[40:43]
    v_mfma_f32_16x16x32_bf16 v[44:47], v[92:95], a[64:67], v[44:47]
    ds_read_b128 v[68:71], v7 offset:11968
    v_mfma_f32_16x16x32_bf16 v[48:51], v[92:95], a[96:99], v[48:51]
    v_mfma_f32_16x16x32_bf16 v[52:55], v[92:95], a[128:131], v[52:55]
    buffer_load_dwordx4 v4, s[68:71], s47 offen offset:0 sc1 lds
    v_mfma_f32_16x16x32_bf16 v[56:59], v[92:95], a[160:163], v[56:59]
    v_mfma_f32_16x16x32_bf16 v[60:63], v[92:95], a[192:195], v[60:63]
    s_waitcnt lgkmcnt(1)
    v_mfma_f32_16x16x32_bf16 v[36:39], v[64:67], v[96:99], v[36:39]
    v_mfma_f32_16x16x32_bf16 v[40:43], v[64:67], a[28:31], v[40:43]
    ds_read_b128 v[72:75], v7 offset:11904
    v_mfma_f32_16x16x32_bf16 v[44:47], v[64:67], a[60:63], v[44:47]
    v_mfma_f32_16x16x32_bf16 v[48:51], v[64:67], a[92:95], v[48:51]
    buffer_load_dwordx4 v17, s[68:71], s47 offen offset:1024 sc1 lds
    v_mfma_f32_16x16x32_bf16 v[52:55], v[64:67], a[124:127], v[52:55]
    v_mfma_f32_16x16x32_bf16 v[56:59], v[64:67], a[156:159], v[56:59]
    v_mfma_f32_16x16x32_bf16 v[60:63], v[64:67], a[188:191], v[60:63]
    v_cvt_pk_bf16_f32 v102, v36, v37
    v_cvt_pk_bf16_f32 v103, v38, v39
    s_waitcnt lgkmcnt(1)
    v_mfma_f32_16x16x32_bf16 v[40:43], v[68:71], a[24:27], v[40:43]
    ds_read_b128 v[76:79], v7 offset:11840
    ds_write_b32 v8, v102 offset:512
    v_mfma_f32_16x16x32_bf16 v[44:47], v[68:71], a[56:59], v[44:47]
    ds_write_b32 v8, v103 offset:528
    ds_read_b128 v[104:107], v9 offset:0
    v_mfma_f32_16x16x32_bf16 v[48:51], v[68:71], a[88:91], v[48:51]
    buffer_load_dwordx4 v17, s[68:71], s47 offen offset:2048 sc1 lds
    v_mfma_f32_16x16x32_bf16 v[52:55], v[68:71], a[120:123], v[52:55]
    v_mfma_f32_16x16x32_bf16 v[56:59], v[68:71], a[152:155], v[56:59]
    v_mfma_f32_16x16x32_bf16 v[60:63], v[68:71], a[184:187], v[60:63]
    s_waitcnt lgkmcnt(4)
    v_mfma_f32_16x16x32_bf16 v[40:43], v[72:75], a[20:23], v[40:43]
    ds_read_b128 v[80:83], v7 offset:11776
    v_mfma_f32_16x16x32_bf16 v[44:47], v[72:75], a[52:55], v[44:47]
    v_mfma_f32_16x16x32_bf16 v[48:51], v[72:75], a[84:87], v[48:51]
    buffer_load_dwordx4 v17, s[68:71], s47 offen offset:3072 sc1 lds
    v_mfma_f32_16x16x32_bf16 v[52:55], v[72:75], a[116:119], v[52:55]
    s_waitcnt lgkmcnt(1)
    buffer_store_dwordx4 v[104:107], v17, s[12:15], s63 offen offset:0 sc1
    v_mfma_f32_16x16x32_bf16 v[56:59], v[72:75], a[148:151], v[56:59]
    s_add_u32 m0, s57, 31840
    s_mov_b32 s47, 16
    v_mfma_f32_16x16x32_bf16 v[60:63], v[72:75], a[180:183], v[60:63]
    v_mfma_f32_16x16x32_bf16 v[40:43], v[76:79], a[16:19], v[40:43]
    ds_read_b128 v[84:87], v7 offset:11712
    v_mfma_f32_16x16x32_bf16 v[44:47], v[76:79], a[48:51], v[44:47]
    v_mfma_f32_16x16x32_bf16 v[48:51], v[76:79], a[80:83], v[48:51]
    buffer_load_dwordx4 v4, s[68:71], s47 offen offset:0 sc1 lds
    v_mfma_f32_16x16x32_bf16 v[52:55], v[76:79], a[112:115], v[52:55]
    v_mfma_f32_16x16x32_bf16 v[56:59], v[76:79], a[144:147], v[56:59]
    v_mfma_f32_16x16x32_bf16 v[60:63], v[76:79], a[176:179], v[60:63]
    s_waitcnt lgkmcnt(1)
    v_mfma_f32_16x16x32_bf16 v[40:43], v[80:83], a[12:15], v[40:43]
    ds_read_b128 v[88:91], v7 offset:11648
    v_mfma_f32_16x16x32_bf16 v[44:47], v[80:83], a[44:47], v[44:47]
    v_mfma_f32_16x16x32_bf16 v[48:51], v[80:83], a[76:79], v[48:51]
    buffer_load_dwordx4 v17, s[68:71], s47 offen offset:1024 sc1 lds
    v_mfma_f32_16x16x32_bf16 v[52:55], v[80:83], a[108:111], v[52:55]
    v_mfma_f32_16x16x32_bf16 v[56:59], v[80:83], a[140:143], v[56:59]
    v_mfma_f32_16x16x32_bf16 v[60:63], v[80:83], a[172:175], v[60:63]
    s_waitcnt lgkmcnt(1)
    v_mfma_f32_16x16x32_bf16 v[40:43], v[84:87], a[8:11], v[40:43]
    ds_read_b128 v[92:95], v7 offset:11584
    v_mfma_f32_16x16x32_bf16 v[44:47], v[84:87], a[40:43], v[44:47]
    v_mfma_f32_16x16x32_bf16 v[48:51], v[84:87], a[72:75], v[48:51]
    buffer_load_dwordx4 v17, s[68:71], s47 offen offset:2048 sc1 lds
    v_mfma_f32_16x16x32_bf16 v[52:55], v[84:87], a[104:107], v[52:55]
    v_mfma_f32_16x16x32_bf16 v[56:59], v[84:87], a[136:139], v[56:59]
    v_mfma_f32_16x16x32_bf16 v[60:63], v[84:87], a[168:171], v[60:63]
    s_waitcnt lgkmcnt(1)
    v_mfma_f32_16x16x32_bf16 v[40:43], v[88:91], a[4:7], v[40:43]
    ds_read_b128 v[64:67], v7 offset:11520
    v_mfma_f32_16x16x32_bf16 v[44:47], v[88:91], a[36:39], v[44:47]
    v_mfma_f32_16x16x32_bf16 v[48:51], v[88:91], a[68:71], v[48:51]
    buffer_load_dwordx4 v17, s[68:71], s47 offen offset:3072 sc1 lds
    v_mfma_f32_16x16x32_bf16 v[52:55], v[88:91], a[100:103], v[52:55]
    v_mfma_f32_16x16x32_bf16 v[56:59], v[88:91], a[132:135], v[56:59]
    v_mfma_f32_16x16x32_bf16 v[60:63], v[88:91], a[164:167], v[60:63]
    s_waitcnt lgkmcnt(1)
    v_mfma_f32_16x16x32_bf16 v[40:43], v[92:95], a[0:3], v[40:43]
    ds_read_b128 v[68:71], v7 offset:11456
    v_mfma_f32_16x16x32_bf16 v[44:47], v[92:95], a[32:35], v[44:47]
    v_mfma_f32_16x16x32_bf16 v[48:51], v[92:95], a[64:67], v[48:51]
    s_add_u32 m0, s57, 22016
    s_mov_b32 s47, 4100
    s_mov_b32 exec_hi, 0
    buffer_load_dwordx4 v17, s[68:71], s47 offen sc1 lds
    s_mov_b64 exec, -1
    v_mfma_f32_16x16x32_bf16 v[52:55], v[92:95], a[96:99], v[52:55]
    v_mfma_f32_16x16x32_bf16 v[56:59], v[92:95], a[128:131], v[56:59]
    v_mfma_f32_16x16x32_bf16 v[60:63], v[92:95], a[160:163], v[60:63]
    ds_read_b128 v[72:75], v7 offset:11392
    s_waitcnt lgkmcnt(2)
    v_mfma_f32_16x16x32_bf16 v[40:43], v[64:67], v[96:99], v[40:43]
    v_mfma_f32_16x16x32_bf16 v[44:47], v[64:67], a[28:31], v[44:47]
    v_mfma_f32_16x16x32_bf16 v[48:51], v[64:67], a[60:63], v[48:51]
    s_add_u32 m0, s57, 26656
    s_mov_b32 s47, 4104
    s_mov_b32 exec_hi, 0
    buffer_load_dwordx4 v17, s[68:71], s47 offen sc1 lds
    s_mov_b64 exec, -1
    v_mfma_f32_16x16x32_bf16 v[52:55], v[64:67], a[92:95], v[52:55]
    v_mfma_f32_16x16x32_bf16 v[56:59], v[64:67], a[124:127], v[56:59]
    ds_read_b128 v[76:79], v7 offset:11328
    v_mfma_f32_16x16x32_bf16 v[60:63], v[64:67], a[156:159], v[60:63]
    s_waitcnt lgkmcnt(2)
    v_mfma_f32_16x16x32_bf16 v[44:47], v[68:71], a[24:27], v[44:47]
    v_cvt_pk_bf16_f32 v100, v40, v41
    v_cvt_pk_bf16_f32 v101, v42, v43
    v_mfma_f32_16x16x32_bf16 v[48:51], v[68:71], a[56:59], v[48:51]
    ds_write_b32 v8, v100 offset:1024
    ds_write_b32 v8, v101 offset:1040
    v_mfma_f32_16x16x32_bf16 v[52:55], v[68:71], a[88:91], v[52:55]
    s_add_u32 m0, s57, 31296
    s_mov_b32 s47, 4108
    s_mov_b32 exec_hi, 0
    buffer_load_dwordx4 v17, s[68:71], s47 offen sc1 lds
    s_mov_b64 exec, -1
    v_mfma_f32_16x16x32_bf16 v[56:59], v[68:71], a[120:123], v[56:59]
    ds_read_b128 v[80:83], v7 offset:11264
    v_mfma_f32_16x16x32_bf16 v[60:63], v[68:71], a[152:155], v[60:63]
    s_waitcnt lgkmcnt(4)
    v_mfma_f32_16x16x32_bf16 v[44:47], v[72:75], a[20:23], v[44:47]
    v_mfma_f32_16x16x32_bf16 v[48:51], v[72:75], a[52:55], v[48:51]
    v_mfma_f32_16x16x32_bf16 v[52:55], v[72:75], a[84:87], v[52:55]
    v_mfma_f32_16x16x32_bf16 v[56:59], v[72:75], a[116:119], v[56:59]
    ds_read_b128 v[84:87], v7 offset:11200
    s_add_u32 m0, s57, 35936
    s_mov_b32 s47, 4112
    s_mov_b32 exec_hi, 0
    buffer_load_dwordx4 v17, s[68:71], s47 offen sc1 lds
    s_mov_b64 exec, -1
    v_mfma_f32_16x16x32_bf16 v[60:63], v[72:75], a[148:151], v[60:63]
    s_mul_i32 s47, s56, 1024
    s_add_u32 s47, s47, 41943040
    s_add_u32 m0, s57, 0
    s_waitcnt lgkmcnt(4)
    v_mfma_f32_16x16x32_bf16 v[44:47], v[76:79], a[16:19], v[44:47]
    v_mfma_f32_16x16x32_bf16 v[48:51], v[76:79], a[48:51], v[48:51]
    v_mfma_f32_16x16x32_bf16 v[52:55], v[76:79], a[80:83], v[52:55]
    v_mfma_f32_16x16x32_bf16 v[56:59], v[76:79], a[112:115], v[56:59]
    ds_read_b128 v[88:91], v7 offset:11136
    v_mfma_f32_16x16x32_bf16 v[60:63], v[76:79], a[144:147], v[60:63]
    buffer_load_dwordx4 v17, s[12:15], s47 offen offset:0 lds
    s_waitcnt lgkmcnt(2)
    v_mfma_f32_16x16x32_bf16 v[44:47], v[80:83], a[12:15], v[44:47]
    v_mfma_f32_16x16x32_bf16 v[48:51], v[80:83], a[44:47], v[48:51]
    v_mfma_f32_16x16x32_bf16 v[52:55], v[80:83], a[76:79], v[52:55]
    v_mfma_f32_16x16x32_bf16 v[56:59], v[80:83], a[108:111], v[56:59]
    ds_read_b128 v[92:95], v7 offset:11072
    v_mfma_f32_16x16x32_bf16 v[60:63], v[80:83], a[140:143], v[60:63]
    s_waitcnt lgkmcnt(2)
    v_mfma_f32_16x16x32_bf16 v[44:47], v[84:87], a[8:11], v[44:47]
    buffer_load_dwordx4 v17, s[12:15], s47 offen offset:1024 lds
    v_mfma_f32_16x16x32_bf16 v[48:51], v[84:87], a[40:43], v[48:51]
    v_mfma_f32_16x16x32_bf16 v[52:55], v[84:87], a[72:75], v[52:55]
    v_mfma_f32_16x16x32_bf16 v[56:59], v[84:87], a[104:107], v[56:59]
    ds_read_b128 v[64:67], v7 offset:11008
    v_mfma_f32_16x16x32_bf16 v[60:63], v[84:87], a[136:139], v[60:63]
    s_waitcnt lgkmcnt(2)
    v_mfma_f32_16x16x32_bf16 v[44:47], v[88:91], a[4:7], v[44:47]
    v_mfma_f32_16x16x32_bf16 v[48:51], v[88:91], a[36:39], v[48:51]
    buffer_load_dwordx4 v17, s[12:15], s47 offen offset:2048 lds
    v_mfma_f32_16x16x32_bf16 v[52:55], v[88:91], a[68:71], v[52:55]
    v_mfma_f32_16x16x32_bf16 v[56:59], v[88:91], a[100:103], v[56:59]
    ds_read_b128 v[68:71], v7 offset:10944
    v_mfma_f32_16x16x32_bf16 v[60:63], v[88:91], a[132:135], v[60:63]
    s_waitcnt lgkmcnt(2)
    v_mfma_f32_16x16x32_bf16 v[44:47], v[92:95], a[0:3], v[44:47]
    v_mfma_f32_16x16x32_bf16 v[48:51], v[92:95], a[32:35], v[48:51]
    v_mfma_f32_16x16x32_bf16 v[52:55], v[92:95], a[64:67], v[52:55]
    ds_read_b128 v[72:75], v7 offset:10880
    buffer_load_dwordx4 v17, s[12:15], s47 offen offset:3072 lds
    v_mfma_f32_16x16x32_bf16 v[56:59], v[92:95], a[96:99], v[56:59]
    s_add_u32 m0, s57, 4096
    s_add_u32 s47, s47, 4096
    v_mfma_f32_16x16x32_bf16 v[60:63], v[92:95], a[128:131], v[60:63]
    s_waitcnt lgkmcnt(2)
    v_mfma_f32_16x16x32_bf16 v[44:47], v[64:67], v[96:99], v[44:47]
    v_mfma_f32_16x16x32_bf16 v[48:51], v[64:67], a[28:31], v[48:51]
    ds_read_b128 v[76:79], v7 offset:10816
    v_mfma_f32_16x16x32_bf16 v[52:55], v[64:67], a[60:63], v[52:55]
    v_mfma_f32_16x16x32_bf16 v[56:59], v[64:67], a[92:95], v[56:59]
    buffer_load_dwordx4 v17, s[12:15], s47 offen offset:0 lds
    v_mfma_f32_16x16x32_bf16 v[60:63], v[64:67], a[124:127], v[60:63]
    s_waitcnt lgkmcnt(2)
    v_mfma_f32_16x16x32_bf16 v[48:51], v[68:71], a[24:27], v[48:51]
    ds_read_b128 v[80:83], v7 offset:10752
    v_cvt_pk_bf16_f32 v102, v44, v45
    v_mfma_f32_16x16x32_bf16 v[52:55], v[68:71], a[56:59], v[52:55]
    v_cvt_pk_bf16_f32 v103, v46, v47
    ds_write_b32 v8, v102 offset:1536
    v_mfma_f32_16x16x32_bf16 v[56:59], v[68:71], a[88:91], v[56:59]
    ds_write_b32 v8, v103 offset:1552
    ds_read_b128 v[108:111], v9 offset:1024
    v_mfma_f32_16x16x32_bf16 v[60:63], v[68:71], a[120:123], v[60:63]
    s_waitcnt lgkmcnt(5)
    v_mfma_f32_16x16x32_bf16 v[48:51], v[72:75], a[20:23], v[48:51]
    ds_read_b128 v[84:87], v7 offset:10688
    buffer_load_dwordx4 v17, s[12:15], s47 offen offset:1024 lds
    v_mfma_f32_16x16x32_bf16 v[52:55], v[72:75], a[52:55], v[52:55]
    v_mfma_f32_16x16x32_bf16 v[56:59], v[72:75], a[84:87], v[56:59]
    v_mfma_f32_16x16x32_bf16 v[60:63], v[72:75], a[116:119], v[60:63]
    s_waitcnt lgkmcnt(5)
    v_mfma_f32_16x16x32_bf16 v[48:51], v[76:79], a[16:19], v[48:51]
    ds_read_b128 v[88:91], v7 offset:10624
    s_waitcnt lgkmcnt(2)
    buffer_store_dwordx4 v[108:111], v17, s[12:15], s63 offen offset:1024 sc1
    v_mfma_f32_16x16x32_bf16 v[52:55], v[76:79], a[48:51], v[52:55]
    v_mfma_f32_16x16x32_bf16 v[56:59], v[76:79], a[80:83], v[56:59]
    buffer_load_dwordx4 v17, s[12:15], s47 offen offset:2048 lds
    v_mfma_f32_16x16x32_bf16 v[60:63], v[76:79], a[112:115], v[60:63]
    v_mfma_f32_16x16x32_bf16 v[48:51], v[80:83], a[12:15], v[48:51]
    ds_read_b128 v[92:95], v7 offset:10560
    v_mfma_f32_16x16x32_bf16 v[52:55], v[80:83], a[44:47], v[52:55]
    v_mfma_f32_16x16x32_bf16 v[56:59], v[80:83], a[76:79], v[56:59]
    v_mfma_f32_16x16x32_bf16 v[60:63], v[80:83], a[108:111], v[60:63]
    s_waitcnt lgkmcnt(2)
    v_mfma_f32_16x16x32_bf16 v[48:51], v[84:87], a[8:11], v[48:51]
    ds_read_b128 v[64:67], v7 offset:10496
    buffer_load_dwordx4 v17, s[12:15], s47 offen offset:3072 lds
    v_mfma_f32_16x16x32_bf16 v[52:55], v[84:87], a[40:43], v[52:55]
    v_mfma_f32_16x16x32_bf16 v[56:59], v[84:87], a[72:75], v[56:59]
    v_mfma_f32_16x16x32_bf16 v[60:63], v[84:87], a[104:107], v[60:63]
    s_waitcnt lgkmcnt(2)
    v_mfma_f32_16x16x32_bf16 v[48:51], v[88:91], a[4:7], v[48:51]
    ds_read_b128 v[68:71], v7 offset:10432
    v_mfma_f32_16x16x32_bf16 v[52:55], v[88:91], a[36:39], v[52:55]
    v_mfma_f32_16x16x32_bf16 v[56:59], v[88:91], a[68:71], v[56:59]
    s_add_u32 m0, s57, 8192
    s_add_u32 s47, s47, 4096
    s_mov_b32 exec_hi, 0xffff
    buffer_load_dwordx4 v17, s[12:15], s47 offen lds
    s_mov_b64 exec, -1
    v_mfma_f32_16x16x32_bf16 v[60:63], v[88:91], a[100:103], v[60:63]
    ds_read_b128 v[72:75], v7 offset:10368
    s_waitcnt lgkmcnt(3)
    v_mfma_f32_16x16x32_bf16 v[48:51], v[92:95], a[0:3], v[48:51]
    v_mfma_f32_16x16x32_bf16 v[52:55], v[92:95], a[32:35], v[52:55]
    v_mfma_f32_16x16x32_bf16 v[56:59], v[92:95], a[64:67], v[56:59]
    ds_read_b128 v[76:79], v7 offset:10304
    v_mfma_f32_16x16x32_bf16 v[60:63], v[92:95], a[96:99], v[60:63]
    s_waitcnt lgkmcnt(3)
    v_mfma_f32_16x16x32_bf16 v[48:51], v[64:67], v[96:99], v[48:51]
    v_mfma_f32_16x16x32_bf16 v[52:55], v[64:67], a[28:31], v[52:55]
    ds_read_b128 v[80:83], v7 offset:10240
    v_mfma_f32_16x16x32_bf16 v[56:59], v[64:67], a[60:63], v[56:59]
    v_mfma_f32_16x16x32_bf16 v[60:63], v[64:67], a[92:95], v[60:63]
    s_waitcnt lgkmcnt(3)
    v_mfma_f32_16x16x32_bf16 v[52:55], v[68:71], a[24:27], v[52:55]
    ds_read_b128 v[84:87], v7 offset:10176
    v_mfma_f32_16x16x32_bf16 v[56:59], v[68:71], a[56:59], v[56:59]
    v_cvt_pk_bf16_f32 v100, v48, v49
    v_cvt_pk_bf16_f32 v101, v50, v51
    v_mfma_f32_16x16x32_bf16 v[60:63], v[68:71], a[88:91], v[60:63]
    ds_write_b32 v8, v100 offset:2048
    ds_write_b32 v8, v101 offset:2064
    s_waitcnt lgkmcnt(5)
    v_mfma_f32_16x16x32_bf16 v[52:55], v[72:75], a[20:23], v[52:55]
    ds_read_b128 v[88:91], v7 offset:10112
    v_mfma_f32_16x16x32_bf16 v[56:59], v[72:75], a[52:55], v[56:59]
    v_mfma_f32_16x16x32_bf16 v[60:63], v[72:75], a[84:87], v[60:63]
    s_waitcnt lgkmcnt(5)
    v_mfma_f32_16x16x32_bf16 v[52:55], v[76:79], a[16:19], v[52:55]
    ds_read_b128 v[92:95], v7 offset:10048
    v_mfma_f32_16x16x32_bf16 v[56:59], v[76:79], a[48:51], v[56:59]
    v_mfma_f32_16x16x32_bf16 v[60:63], v[76:79], a[80:83], v[60:63]
    s_waitcnt lgkmcnt(5)
    v_mfma_f32_16x16x32_bf16 v[52:55], v[80:83], a[12:15], v[52:55]
    ds_read_b128 v[64:67], v7 offset:9984
    v_mfma_f32_16x16x32_bf16 v[56:59], v[80:83], a[44:47], v[56:59]
    v_mfma_f32_16x16x32_bf16 v[60:63], v[80:83], a[76:79], v[60:63]
    s_waitcnt lgkmcnt(5)
    v_mfma_f32_16x16x32_bf16 v[52:55], v[84:87], a[8:11], v[52:55]
    ds_read_b128 v[68:71], v7 offset:9920
    v_mfma_f32_16x16x32_bf16 v[56:59], v[84:87], a[40:43], v[56:59]
    v_mfma_f32_16x16x32_bf16 v[60:63], v[84:87], a[72:75], v[60:63]
    ds_read_b128 v[72:75], v7 offset:9856
    s_waitcnt lgkmcnt(4)
    v_mfma_f32_16x16x32_bf16 v[52:55], v[88:91], a[4:7], v[52:55]
    v_mfma_f32_16x16x32_bf16 v[56:59], v[88:91], a[36:39], v[56:59]
    ds_read_b128 v[76:79], v7 offset:9792
    v_mfma_f32_16x16x32_bf16 v[60:63], v[88:91], a[68:71], v[60:63]
    s_waitcnt lgkmcnt(4)
    v_mfma_f32_16x16x32_bf16 v[52:55], v[92:95], a[0:3], v[52:55]
    ds_read_b128 v[80:83], v7 offset:9728
    v_mfma_f32_16x16x32_bf16 v[56:59], v[92:95], a[32:35], v[56:59]
    v_mfma_f32_16x16x32_bf16 v[60:63], v[92:95], a[64:67], v[60:63]
    ds_read_b128 v[84:87], v7 offset:9664
    s_waitcnt lgkmcnt(5)
    v_mfma_f32_16x16x32_bf16 v[52:55], v[64:67], v[96:99], v[52:55]
    v_mfma_f32_16x16x32_bf16 v[56:59], v[64:67], a[28:31], v[56:59]
    ds_read_b128 v[88:91], v7 offset:9600
    v_mfma_f32_16x16x32_bf16 v[60:63], v[64:67], a[60:63], v[60:63]
    s_waitcnt lgkmcnt(4)
    v_mfma_f32_16x16x32_bf16 v[56:59], v[68:71], a[24:27], v[56:59]
    ds_read_b128 v[92:95], v7 offset:9536
    v_mfma_f32_16x16x32_bf16 v[60:63], v[68:71], a[56:59], v[60:63]
    v_mfma_f32_16x16x32_bf16 v[56:59], v[72:75], a[20:23], v[56:59]
    ds_read_b128 v[64:67], v7 offset:9472
    v_cvt_pk_bf16_f32 v102, v52, v53
    v_mfma_f32_16x16x32_bf16 v[60:63], v[72:75], a[52:55], v[60:63]
    v_cvt_pk_bf16_f32 v103, v54, v55
    ds_write_b32 v8, v102 offset:2560
    s_waitcnt lgkmcnt(5)
    v_mfma_f32_16x16x32_bf16 v[56:59], v[76:79], a[16:19], v[56:59]
    ds_read_b128 v[68:71], v7 offset:9408
    ds_write_b32 v8, v103 offset:2576
    v_mfma_f32_16x16x32_bf16 v[60:63], v[76:79], a[48:51], v[60:63]
    ds_read_b128 v[72:75], v7 offset:9344
    ds_read_b128 v[104:107], v9 offset:2048
    v_mfma_f32_16x16x32_bf16 v[56:59], v[80:83], a[12:15], v[56:59]
    ds_read_b128 v[76:79], v7 offset:9280
    v_mfma_f32_16x16x32_bf16 v[60:63], v[80:83], a[44:47], v[60:63]
    ds_read_b128 v[80:83], v7 offset:9216
    s_waitcnt lgkmcnt(9)
    v_mfma_f32_16x16x32_bf16 v[56:59], v[84:87], a[8:11], v[56:59]
    v_mfma_f32_16x16x32_bf16 v[60:63], v[84:87], a[40:43], v[60:63]
    ds_read_b128 v[84:87], v7 offset:9152
    v_mfma_f32_16x16x32_bf16 v[56:59], v[88:91], a[4:7], v[56:59]
    v_mfma_f32_16x16x32_bf16 v[60:63], v[88:91], a[36:39], v[60:63]
    ds_read_b128 v[88:91], v7 offset:9088
    s_waitcnt lgkmcnt(4)
    buffer_store_dwordx4 v[104:107], v17, s[12:15], s63 offen offset:2048 sc1
    v_mfma_f32_16x16x32_bf16 v[56:59], v[92:95], a[0:3], v[56:59]
    v_mfma_f32_16x16x32_bf16 v[60:63], v[92:95], a[32:35], v[60:63]
    ds_read_b128 v[92:95], v7 offset:9024
    v_mfma_f32_16x16x32_bf16 v[56:59], v[64:67], v[96:99], v[56:59]
    v_mfma_f32_16x16x32_bf16 v[60:63], v[64:67], a[28:31], v[60:63]
    ds_read_b128 v[64:67], v7 offset:8960
    v_mfma_f32_16x16x32_bf16 v[60:63], v[68:71], a[24:27], v[60:63]
    v_mfma_f32_16x16x32_bf16 v[60:63], v[72:75], a[20:23], v[60:63]
    s_waitcnt lgkmcnt(3)
    v_mfma_f32_16x16x32_bf16 v[60:63], v[76:79], a[16:19], v[60:63]
    v_mfma_f32_16x16x32_bf16 v[60:63], v[80:83], a[12:15], v[60:63]
    v_mfma_f32_16x16x32_bf16 v[60:63], v[84:87], a[8:11], v[60:63]
    v_cvt_pk_bf16_f32 v100, v56, v57
    v_cvt_pk_bf16_f32 v101, v58, v59
    s_waitcnt lgkmcnt(0)
    v_mfma_f32_16x16x32_bf16 v[60:63], v[88:91], a[4:7], v[60:63]
    ds_write_b32 v8, v100 offset:3072
    ds_write_b32 v8, v101 offset:3088
    v_mfma_f32_16x16x32_bf16 v[60:63], v[92:95], a[0:3], v[60:63]
    v_mfma_f32_16x16x32_bf16 v[60:63], v[64:67], v[96:99], v[60:63]
    s_nop 0
    s_nop 0
    s_nop 0
    s_nop 0
    s_nop 0
    s_nop 0
    s_nop 0
    s_nop 0
    v_cvt_pk_bf16_f32 v102, v60, v61
    v_cvt_pk_bf16_f32 v103, v62, v63
    ds_write_b32 v8, v102 offset:3584
    ds_write_b32 v8, v103 offset:3600
    ds_read_b128 v[108:111], v9 offset:3072
    s_nop 0
    s_nop 0
    s_nop 0
    s_nop 0
    s_nop 0
    s_nop 0
    s_nop 0
    s_nop 0
    s_nop 0
    s_nop 0
    s_nop 0
    s_waitcnt lgkmcnt(0)
    buffer_store_dwordx4 v[108:111], v17, s[12:15], s63 offen offset:3072 sc1
    s_lshl_b32 s63, s60, 12
    s_add_u32 s63, s63, 24117248
    s_lshl_b32 s43, s36, 6
    v_subrev_u32 v11, s43, v7
    v_subrev_u32 v12, s43, v6
    s_waitcnt vmcnt(2)
    ds_read_b128 a[32:35], v11 offset:4096
    ds_read_b128 a[0:3], v12 offset:512
    ds_read_b128 a[4:7], v12 offset:1024
    ds_read_b128 a[8:11], v12 offset:1536
    ds_read_b128 a[12:15], v12 offset:2048
    ds_read_b128 a[16:19], v12 offset:2560
    ds_read_b128 a[20:23], v12 offset:3072
    ds_read_b128 a[24:27], v12 offset:3584
    ds_read_b128 a[28:31], v12 offset:4096
    ds_read_b128 a[36:39], v11 offset:3584
    ds_read_b128 a[40:43], v11 offset:3072
    ds_read_b128 a[44:47], v11 offset:2560
    s_waitcnt lgkmcnt(10)
    v_mfma_f32_16x16x32_bf16 v[32:35], a[32:35], a[0:3], 0
    ds_read_b128 a[48:51], v11 offset:2048
    s_waitcnt lgkmcnt(10)
    v_mfma_f32_16x16x32_bf16 v[36:39], a[32:35], a[4:7], 0
    ds_read_b128 a[52:55], v11 offset:1536
    s_waitcnt lgkmcnt(10)
    v_mfma_f32_16x16x32_bf16 v[40:43], a[32:35], a[8:11], 0
    ds_read_b128 a[56:59], v11 offset:1024
    s_waitcnt lgkmcnt(10)
    v_mfma_f32_16x16x32_bf16 v[44:47], a[32:35], a[12:15], 0
    ds_read_b128 a[60:63], v11 offset:512
    s_waitcnt lgkmcnt(10)
    v_mfma_f32_16x16x32_bf16 v[48:51], a[32:35], a[16:19], 0
    ds_read_b128 a[96:99], v11 offset:3840
    s_waitcnt lgkmcnt(10)
    v_mfma_f32_16x16x32_bf16 v[52:55], a[32:35], a[20:23], 0
    ds_read_b128 a[64:67], v12 offset:256
    s_waitcnt lgkmcnt(10)
    v_mfma_f32_16x16x32_bf16 v[56:59], a[32:35], a[24:27], 0
    ds_read_b128 a[68:71], v12 offset:768
    s_waitcnt lgkmcnt(10)
    v_mfma_f32_16x16x32_bf16 v[60:63], a[32:35], a[28:31], 0
    ds_read_b128 a[72:75], v12 offset:1280
    s_waitcnt lgkmcnt(10)
    v_mfma_f32_16x16x32_bf16 v[36:39], a[36:39], a[0:3], v[36:39]
    ds_read_b128 a[76:79], v12 offset:1792
    v_mfma_f32_16x16x32_bf16 v[40:43], a[36:39], a[4:7], v[40:43]
    ds_read_b128 a[80:83], v12 offset:2304
    v_mfma_f32_16x16x32_bf16 v[44:47], a[36:39], a[8:11], v[44:47]
    ds_read_b128 a[84:87], v12 offset:2816
    v_mfma_f32_16x16x32_bf16 v[48:51], a[36:39], a[12:15], v[48:51]
    ds_read_b128 a[88:91], v12 offset:3328
    v_mfma_f32_16x16x32_bf16 v[52:55], a[36:39], a[16:19], v[52:55]
    ds_read_b128 a[92:95], v12 offset:3840
    v_mfma_f32_16x16x32_bf16 v[56:59], a[36:39], a[20:23], v[56:59]
    ds_read_b128 a[100:103], v11 offset:3328
    v_mfma_f32_16x16x32_bf16 v[60:63], a[36:39], a[24:27], v[60:63]
    ds_read_b128 a[104:107], v11 offset:2816
    s_waitcnt lgkmcnt(15)
    v_mfma_f32_16x16x32_bf16 v[40:43], a[40:43], a[0:3], v[40:43]
    ds_read_b128 a[108:111], v11 offset:2304
    v_mfma_f32_16x16x32_bf16 v[44:47], a[40:43], a[4:7], v[44:47]
    ds_read_b128 a[112:115], v11 offset:1792
    v_mfma_f32_16x16x32_bf16 v[48:51], a[40:43], a[8:11], v[48:51]
    ds_read_b128 a[116:119], v11 offset:1280
    v_mfma_f32_16x16x32_bf16 v[52:55], a[40:43], a[12:15], v[52:55]
    ds_read_b128 a[120:123], v11 offset:768
    v_mfma_f32_16x16x32_bf16 v[56:59], a[40:43], a[16:19], v[56:59]
    ds_read_b128 a[124:127], v11 offset:256
    v_mfma_f32_16x16x32_bf16 v[60:63], a[40:43], a[20:23], v[60:63]
    v_mfma_f32_16x16x32_bf16 v[44:47], a[44:47], a[0:3], v[44:47]
    v_mfma_f32_16x16x32_bf16 v[48:51], a[44:47], a[4:7], v[48:51]
    v_mfma_f32_16x16x32_bf16 v[52:55], a[44:47], a[8:11], v[52:55]
    v_mfma_f32_16x16x32_bf16 v[56:59], a[44:47], a[12:15], v[56:59]
    v_mfma_f32_16x16x32_bf16 v[60:63], a[44:47], a[16:19], v[60:63]
    s_waitcnt lgkmcnt(15)
    v_mfma_f32_16x16x32_bf16 v[48:51], a[48:51], a[0:3], v[48:51]
    v_mfma_f32_16x16x32_bf16 v[52:55], a[48:51], a[4:7], v[52:55]
    v_mfma_f32_16x16x32_bf16 v[56:59], a[48:51], a[8:11], v[56:59]
    v_mfma_f32_16x16x32_bf16 v[60:63], a[48:51], a[12:15], v[60:63]
    v_mfma_f32_16x16x32_bf16 v[52:55], a[52:55], a[0:3], v[52:55]
    v_mfma_f32_16x16x32_bf16 v[56:59], a[52:55], a[4:7], v[56:59]
    v_mfma_f32_16x16x32_bf16 v[60:63], a[52:55], a[8:11], v[60:63]
    v_mfma_f32_16x16x32_bf16 v[56:59], a[56:59], a[0:3], v[56:59]
    v_mfma_f32_16x16x32_bf16 v[60:63], a[56:59], a[4:7], v[60:63]
    v_mfma_f32_16x16x32_bf16 v[60:63], a[60:63], a[0:3], v[60:63]
    s_waitcnt lgkmcnt(14)
    v_mfma_f32_16x16x32_bf16 v[32:35], a[96:99], a[64:67], v[32:35]
    s_waitcnt lgkmcnt(13)
    v_mfma_f32_16x16x32_bf16 v[36:39], a[96:99], a[68:71], v[36:39]
    s_waitcnt lgkmcnt(12)
    v_mfma_f32_16x16x32_bf16 v[40:43], a[96:99], a[72:75], v[40:43]
    s_waitcnt lgkmcnt(11)
    v_mfma_f32_16x16x32_bf16 v[44:47], a[96:99], a[76:79], v[44:47]
    s_waitcnt lgkmcnt(10)
    v_mfma_f32_16x16x32_bf16 v[48:51], a[96:99], a[80:83], v[48:51]
    s_waitcnt lgkmcnt(9)
    v_mfma_f32_16x16x32_bf16 v[52:55], a[96:99], a[84:87], v[52:55]
    s_waitcnt lgkmcnt(8)
    v_mfma_f32_16x16x32_bf16 v[56:59], a[96:99], a[88:91], v[56:59]
    s_waitcnt lgkmcnt(7)
    v_mfma_f32_16x16x32_bf16 v[60:63], a[96:99], a[92:95], v[60:63]
    s_waitcnt lgkmcnt(6)
    v_mfma_f32_16x16x32_bf16 v[36:39], a[100:103], a[64:67], v[36:39]
    v_mfma_f32_16x16x32_bf16 v[40:43], a[100:103], a[68:71], v[40:43]
    v_mfma_f32_16x16x32_bf16 v[44:47], a[100:103], a[72:75], v[44:47]
    v_mfma_f32_16x16x32_bf16 v[48:51], a[100:103], a[76:79], v[48:51]
    v_mfma_f32_16x16x32_bf16 v[52:55], a[100:103], a[80:83], v[52:55]
    v_mfma_f32_16x16x32_bf16 v[56:59], a[100:103], a[84:87], v[56:59]
    v_mfma_f32_16x16x32_bf16 v[60:63], a[100:103], a[88:91], v[60:63]
    s_waitcnt lgkmcnt(5)
    v_mfma_f32_16x16x32_bf16 v[40:43], a[104:107], a[64:67], v[40:43]
    v_mfma_f32_16x16x32_bf16 v[44:47], a[104:107], a[68:71], v[44:47]
    v_mfma_f32_16x16x32_bf16 v[48:51], a[104:107], a[72:75], v[48:51]
    v_mfma_f32_16x16x32_bf16 v[52:55], a[104:107], a[76:79], v[52:55]
    v_mfma_f32_16x16x32_bf16 v[56:59], a[104:107], a[80:83], v[56:59]
    v_mfma_f32_16x16x32_bf16 v[60:63], a[104:107], a[84:87], v[60:63]
    s_waitcnt lgkmcnt(4)
    v_mfma_f32_16x16x32_bf16 v[44:47], a[108:111], a[64:67], v[44:47]
    v_mfma_f32_16x16x32_bf16 v[48:51], a[108:111], a[68:71], v[48:51]
    v_mfma_f32_16x16x32_bf16 v[52:55], a[108:111], a[72:75], v[52:55]
    v_mfma_f32_16x16x32_bf16 v[56:59], a[108:111], a[76:79], v[56:59]
    v_mfma_f32_16x16x32_bf16 v[60:63], a[108:111], a[80:83], v[60:63]
    s_waitcnt lgkmcnt(3)
    v_mfma_f32_16x16x32_bf16 v[48:51], a[112:115], a[64:67], v[48:51]
    v_mfma_f32_16x16x32_bf16 v[52:55], a[112:115], a[68:71], v[52:55]
    v_mfma_f32_16x16x32_bf16 v[56:59], a[112:115], a[72:75], v[56:59]
    v_mfma_f32_16x16x32_bf16 v[60:63], a[112:115], a[76:79], v[60:63]
    s_waitcnt lgkmcnt(2)
    v_mfma_f32_16x16x32_bf16 v[52:55], a[116:119], a[64:67], v[52:55]
    v_mfma_f32_16x16x32_bf16 v[56:59], a[116:119], a[68:71], v[56:59]
    v_mfma_f32_16x16x32_bf16 v[60:63], a[116:119], a[72:75], v[60:63]
    s_waitcnt lgkmcnt(1)
    v_mfma_f32_16x16x32_bf16 v[56:59], a[120:123], a[64:67], v[56:59]
    v_mfma_f32_16x16x32_bf16 v[60:63], a[120:123], a[68:71], v[60:63]
    s_waitcnt lgkmcnt(0)
    v_mfma_f32_16x16x32_bf16 v[60:63], a[124:127], a[64:67], v[60:63]
    s_cmp_lg_u32 s36, 0
    s_cbranch_scc1 L_cv9x
    ds_read_b128 a[128:131], v7 offset:0
    ds_read_b128 v[96:99], v6 offset:0
    s_waitcnt lgkmcnt(0)
    v_mfma_f32_16x16x32_bf16 v[32:35], a[36:39], v[96:99], v[32:35]
    v_mfma_f32_16x16x32_bf16 v[36:39], a[40:43], v[96:99], v[36:39]
    v_mfma_f32_16x16x32_bf16 v[40:43], a[44:47], v[96:99], v[40:43]
    v_mfma_f32_16x16x32_bf16 v[44:47], a[48:51], v[96:99], v[44:47]
    v_mfma_f32_16x16x32_bf16 v[48:51], a[52:55], v[96:99], v[48:51]
    v_mfma_f32_16x16x32_bf16 v[52:55], a[56:59], v[96:99], v[52:55]
    v_mfma_f32_16x16x32_bf16 v[56:59], a[60:63], v[96:99], v[56:59]
    v_mfma_f32_16x16x32_bf16 v[60:63], a[128:131], v[96:99], v[60:63]
L_cv9x:
    s_add_u32 s43, s57, 17920
    v_add_u32 v13, s43, v17
    s_lshl_b32 s43, s36, 11
    s_add_u32 s43, s43, 17920
    v_add_u32 v14, s43, v17
    v_add_u32 v15, 81920, v14
    s_nop 5
    ds_write_b128 v13, v[32:35] offset:0
    ds_write_b128 v13, v[36:39] offset:1024
    ds_write_b128 v13, v[40:43] offset:2048
    ds_write_b128 v13, v[44:47] offset:3072
    ds_write_b128 v13, v[48:51] offset:4096
    ds_write_b128 v13, v[52:55] offset:5120
    ds_write_b128 v13, v[56:59] offset:6144
    ds_write_b128 v13, v[60:63] offset:7168
    s_waitcnt lgkmcnt(0)
    s_barrier
    ds_read_b128 v[64:67], v14 offset:0
    ds_read_b128 v[68:71], v14 offset:1024
    ds_read_b128 v[72:75], v14 offset:40960
    ds_read_b128 v[76:79], v14 offset:41984
    ds_read_b128 v[80:83], v15 offset:0
    ds_read_b128 v[84:87], v15 offset:1024
    ds_read_b128 v[88:91], v15 offset:40960
    ds_read_b128 v[92:95], v15 offset:41984
    s_waitcnt lgkmcnt(0)
    v_pk_add_f32 v[64:65], v[64:65], v[72:73]
    v_pk_add_f32 v[80:81], v[80:81], v[88:89]
    v_pk_add_f32 v[66:67], v[66:67], v[74:75]
    v_pk_add_f32 v[82:83], v[82:83], v[90:91]
    v_pk_add_f32 v[68:69], v[68:69], v[76:77]
    v_pk_add_f32 v[84:85], v[84:85], v[92:93]
    v_pk_add_f32 v[70:71], v[70:71], v[78:79]
    v_pk_add_f32 v[86:87], v[86:87], v[94:95]
    v_pk_add_f32 v[64:65], v[64:65], v[80:81]
    v_pk_add_f32 v[66:67], v[66:67], v[82:83]
    v_pk_add_f32 v[68:69], v[68:69], v[84:85]
    v_pk_add_f32 v[70:71], v[70:71], v[86:87]
    v_cvt_pk_bf16_f32 v100, v64, v65
    v_cvt_pk_bf16_f32 v101, v66, v67
    v_cvt_pk_bf16_f32 v102, v68, v69
    v_cvt_pk_bf16_f32 v103, v70, v71
    ds_write_b32 v8, v100 offset:0
    ds_write_b32 v8, v101 offset:16
    ds_write_b32 v8, v102 offset:512
    ds_write_b32 v8, v103 offset:528
    s_waitcnt lgkmcnt(0)
    ds_read_b128 v[104:107], v9
    s_lshl_b32 s43, s36, 10
    s_add_u32 s63, s63, s43
    s_waitcnt lgkmcnt(0)
    buffer_store_dwordx4 v[104:107], v17, s[12:15], s63 offen sc1
    v_mov_b32 v31, 1
    s_add_u32 s42, s42, 4096
    s_waitcnt vmcnt(0)
    buffer_store_dword v31, off, s[12:15], s42 sc1
    s_waitcnt vmcnt(0) lgkmcnt(0)
L_end:
    s_endpgm
L_utsub:
    v_lshrrev_b32 v144, 4, v1
    v_lshrrev_b32 v145, 2, v1
    v_and_b32 v145, 3, v145
    v_lshl_add_u32 v145, v144, 3, v145
    v_and_b32 v146, 1, v1
    v_lshlrev_b32 v146, 3, v146
    v_lshl_add_u32 v146, v145, 7, v146
    v_add_u32 v146, s46, v146
    v_lshrrev_b32 v147, 1, v1
    v_and_b32 v147, 1, v147
    v_lshrrev_b32 v145, 1, v145
    v_and_b32 v145, 7, v145
    v_xor_b32 v147, v147, v145
    v_xor_b32 v148, 0, v147
    v_lshl_add_u32 v148, v148, 4, v146
    ds_read_b64_tr_b16 v[124:125], v148 offset:0
    v_xor_b32 v149, 2, v147
    v_lshl_add_u32 v149, v149, 4, v146
    ds_read_b64_tr_b16 v[126:127], v149 offset:512
    v_xor_b32 v148, 2, v147
    v_lshl_add_u32 v148, v148, 4, v146
    ds_read_b64_tr_b16 v[128:129], v148 offset:0
    v_xor_b32 v149, 0, v147
    v_lshl_add_u32 v149, v149, 4, v146
    ds_read_b64_tr_b16 v[130:131], v149 offset:512
    v_xor_b32 v148, 4, v147
    v_lshl_add_u32 v148, v148, 4, v146
    ds_read_b64_tr_b16 v[132:133], v148 offset:0
    v_xor_b32 v149, 6, v147
    v_lshl_add_u32 v149, v149, 4, v146
    ds_read_b64_tr_b16 v[134:135], v149 offset:512
    v_xor_b32 v148, 6, v147
    v_lshl_add_u32 v148, v148, 4, v146
    ds_read_b64_tr_b16 v[136:137], v148 offset:0
    v_xor_b32 v149, 4, v147
    v_lshl_add_u32 v149, v149, 4, v146
    ds_read_b64_tr_b16 v[138:139], v149 offset:512
    v_and_b32 v145, 15, v1
    v_mul_u32_u24 v145, 4224, v145
    v_lshl_add_u32 v145, v144, 4, v145
    s_mul_i32 s43, s53, 270336
    s_add_u32 s43, s43, s52
    s_add_u32 s43, s43, 18874496
    s_waitcnt lgkmcnt(0)
    buffer_store_dwordx4 v[124:127], v145, s[12:15], s43 offen sc1
    s_add_u32 s43, s43, 67584
    buffer_store_dwordx4 v[128:131], v145, s[12:15], s43 offen sc1
    s_add_u32 s43, s43, 67584
    buffer_store_dwordx4 v[132:135], v145, s[12:15], s43 offen sc1
    s_add_u32 s43, s43, 67584
    buffer_store_dwordx4 v[136:139], v145, s[12:15], s43 offen sc1
    s_add_u32 s43, s43, 67584
    s_cmp_lg_u32 s52, 0
    s_cbranch_scc1 L_utz
    v_mul_u32_u24 v145, 4224, v1
    s_mul_i32 s43, s53, 270336
    s_add_u32 s43, s43, 18874480
    v_mov_b32 v140, 0
    v_mov_b32 v141, 0
    v_mov_b32 v142, 0
    v_mov_b32 v143, 0
    buffer_store_dwordx4 v[140:143], v145, s[12:15], s43 offen sc1
L_utz:
    s_setpc_b64 s[54:55]
L_kchan:
    v_readlane_b32 s58, v4, s63
    v_readlane_b32 s59, v5, s63
    v_lshlrev_b32 v236, 16, v112
    v_and_b32 v237, 0xffff0000, v112
    v_lshlrev_b32 v117, 16, v113
    v_and_b32 v121, 0xffff0000, v113
    v_mul_f32 v238, s60, v236
    v_mul_f32 v240, s60, v237
    v_fma_f32 v239, v236, s60, -v238
    v_fma_f32 v241, v237, s60, -v240
    v_exp_f32 v238, v238
    v_exp_f32 v240, v240
    v_fma_f32 v239, v236, s61, v239
    v_fma_f32 v241, v237, s61, v241
    v_mul_f32 v239, s62, v239
    v_mul_f32 v241, s62, v241
    v_fma_f32 v238, v238, v239, v238
    v_fma_f32 v240, v240, v241, v240
    v_cvt_pk_bf16_f32 v238, v238, v238
    v_cvt_pk_bf16_f32 v240, v240, v240
    v_lshlrev_b32 v116, 16, v238
    v_lshlrev_b32 v120, 16, v240
    v_lshlrev_b32 v118, 16, v114
    v_and_b32 v122, 0xffff0000, v114
    v_lshlrev_b32 v119, 16, v115
    v_and_b32 v123, 0xffff0000, v115
    v_mul_f32 v116, s58, v116
    v_mul_f32 v117, s58, v117
    v_mul_f32 v118, s58, v118
    v_mul_f32 v119, s58, v119
    v_mul_f32 v120, s58, v120
    v_mul_f32 v121, s58, v121
    v_mul_f32 v122, s58, v122
    v_mul_f32 v123, s58, v123
    v_mul_f32 v116, 0xbfb8aa3b, v116
    v_mul_f32 v117, 0.15915494, v117
    v_mul_f32 v120, 0xbfb8aa3b, v120
    v_mul_f32 v121, 0.15915494, v121
    v_add_f32 v134, v118, v118
    v_add_f32 v135, v119, v119
    v_add_f32 v190, v122, v122
    v_add_f32 v191, v123, v123
    v_mov_b32 v236, v116
    v_fract_f32 v237, v117
    v_mov_b32 v238, v120
    v_fract_f32 v239, v121
    v_mul_f32 v240, 0x41000000, v116
    v_mul_f32 v241, 0x41000000, v117
    v_mul_f32 v242, 0x41000000, v120
    v_mul_f32 v243, 0x41000000, v121
    v_mul_f32 v244, 0x43000000, v116
    v_mul_f32 v245, 0x43000000, v117
    v_mul_f32 v246, 0x43000000, v120
    v_mul_f32 v247, 0x43000000, v121
    v_mul_f32 v248, 0x44000000, v116
    v_mul_f32 v249, 0x44000000, v117
    v_mul_f32 v250, 0x44000000, v120
    v_mul_f32 v251, 0x44000000, v121
    v_mul_f32 v252, 0x44800000, v116
    v_mul_f32 v253, 0x44800000, v117
    v_mul_f32 v254, 0x44800000, v120
    v_mul_f32 v255, 0x44800000, v121
    v_fract_f32 v241, v241
    v_fract_f32 v243, v243
    v_fract_f32 v245, v245
    v_fract_f32 v247, v247
    v_fract_f32 v249, v249
    v_fract_f32 v251, v251
    v_fract_f32 v253, v253
    v_fract_f32 v255, v255
    v_exp_f32 v236, v236
    v_cos_f32 v124, v237
    v_sin_f32 v125, v237
    v_exp_f32 v238, v238
    v_cos_f32 v180, v239
    v_sin_f32 v181, v239
    v_exp_f32 v240, v240
    v_cos_f32 v126, v241
    v_sin_f32 v127, v241
    v_exp_f32 v242, v242
    v_cos_f32 v182, v243
    v_sin_f32 v183, v243
    v_exp_f32 v244, v244
    v_cos_f32 v128, v245
    v_sin_f32 v129, v245
    v_exp_f32 v246, v246
    v_cos_f32 v184, v247
    v_sin_f32 v185, v247
    v_exp_f32 v248, v248
    v_cos_f32 v130, v249
    v_sin_f32 v131, v249
    v_exp_f32 v250, v250
    v_cos_f32 v186, v251
    v_sin_f32 v187, v251
    v_exp_f32 v252, v252
    v_cos_f32 v132, v253
    v_sin_f32 v133, v253
    v_exp_f32 v254, v254
    v_cos_f32 v188, v255
    v_sin_f32 v189, v255
    s_nop 0
    v_pk_mul_f32 v[124:125], v[124:125], v[236:237] op_sel_hi:[1,0]
    v_pk_mul_f32 v[180:181], v[180:181], v[238:239] op_sel_hi:[1,0]
    v_pk_mul_f32 v[126:127], v[126:127], v[240:241] op_sel_hi:[1,0]
    v_pk_mul_f32 v[182:183], v[182:183], v[242:243] op_sel_hi:[1,0]
    v_pk_mul_f32 v[128:129], v[128:129], v[244:245] op_sel_hi:[1,0]
    v_pk_mul_f32 v[184:185], v[184:185], v[246:247] op_sel_hi:[1,0]
    v_pk_mul_f32 v[130:131], v[130:131], v[248:249] op_sel_hi:[1,0]
    v_pk_mul_f32 v[186:187], v[186:187], v[250:251] op_sel_hi:[1,0]
    v_pk_mul_f32 v[132:133], v[132:133], v[252:253] op_sel_hi:[1,0]
    v_pk_mul_f32 v[188:189], v[188:189], v[254:255] op_sel_hi:[1,0]
    v_pk_mul_f32 v[136:137], v[124:125], v[124:125] op_sel_hi:[1,0]
    v_pk_mul_f32 v[192:193], v[180:181], v[180:181] op_sel_hi:[1,0]
    v_pk_mul_f32 v[138:139], v[128:129], v[128:129] op_sel_hi:[1,0]
    v_pk_mul_f32 v[194:195], v[184:185], v[184:185] op_sel_hi:[1,0]
    v_pk_mul_f32 v[140:141], v[130:131], v[128:129] op_sel_hi:[1,0]
    v_pk_mul_f32 v[196:197], v[186:187], v[184:185] op_sel_hi:[1,0]
    v_pk_mul_f32 v[142:143], v[128:129], v[124:125] op_sel_hi:[1,0]
    v_pk_mul_f32 v[198:199], v[184:185], v[180:181] op_sel_hi:[1,0]
    v_pk_mul_f32 v[144:145], v[126:127], v[126:127] op_sel_hi:[1,0]
    v_pk_mul_f32 v[200:201], v[182:183], v[182:183] op_sel_hi:[1,0]
    v_pk_mul_f32 v[146:147], v[134:135], v[126:127] op_sel_hi:[1,0]
    v_pk_mul_f32 v[202:203], v[190:191], v[182:183] op_sel_hi:[1,0]
    v_pk_mul_f32 v[148:149], v[132:133], v[128:129] op_sel_hi:[1,0]
    v_pk_mul_f32 v[204:205], v[188:189], v[184:185] op_sel_hi:[1,0]
    v_pk_fma_f32 v[136:137], v[124:125], v[124:125], v[136:137] op_sel:[1,1,0] op_sel_hi:[0,1,1] neg_lo:[1,0,0]
    v_pk_fma_f32 v[192:193], v[180:181], v[180:181], v[192:193] op_sel:[1,1,0] op_sel_hi:[0,1,1] neg_lo:[1,0,0]
    v_pk_fma_f32 v[138:139], v[128:129], v[128:129], v[138:139] op_sel:[1,1,0] op_sel_hi:[0,1,1] neg_lo:[1,0,0]
    v_pk_fma_f32 v[194:195], v[184:185], v[184:185], v[194:195] op_sel:[1,1,0] op_sel_hi:[0,1,1] neg_lo:[1,0,0]
    v_pk_fma_f32 v[140:141], v[130:131], v[128:129], v[140:141] op_sel:[1,1,0] op_sel_hi:[0,1,1] neg_lo:[1,0,0]
    v_pk_fma_f32 v[196:197], v[186:187], v[184:185], v[196:197] op_sel:[1,1,0] op_sel_hi:[0,1,1] neg_lo:[1,0,0]
    v_pk_fma_f32 v[142:143], v[128:129], v[124:125], v[142:143] op_sel:[1,1,0] op_sel_hi:[0,1,1] neg_lo:[1,0,0]
    v_pk_fma_f32 v[198:199], v[184:185], v[180:181], v[198:199] op_sel:[1,1,0] op_sel_hi:[0,1,1] neg_lo:[1,0,0]
    v_pk_fma_f32 v[144:145], v[126:127], v[126:127], v[144:145] op_sel:[1,1,0] op_sel_hi:[0,1,1] neg_lo:[1,0,0]
    v_pk_fma_f32 v[200:201], v[182:183], v[182:183], v[200:201] op_sel:[1,1,0] op_sel_hi:[0,1,1] neg_lo:[1,0,0]
    v_pk_fma_f32 v[146:147], v[134:135], v[126:127], v[146:147] op_sel:[1,1,0] op_sel_hi:[0,1,1] neg_lo:[1,0,0]
    v_pk_fma_f32 v[202:203], v[190:191], v[182:183], v[202:203] op_sel:[1,1,0] op_sel_hi:[0,1,1] neg_lo:[1,0,0]
    v_pk_fma_f32 v[148:149], v[132:133], v[128:129], v[148:149] op_sel:[1,1,0] op_sel_hi:[0,1,1] neg_lo:[1,0,0]
    v_pk_fma_f32 v[204:205], v[188:189], v[184:185], v[204:205] op_sel:[1,1,0] op_sel_hi:[0,1,1] neg_lo:[1,0,0]
    v_mov_b32 v236, 0x3f80
    v_mov_b32 v237, 0x3f80
    v_cvt_pk_bf16_f32 v238, v138, v139
    v_cvt_pk_bf16_f32 v239, v194, v195
    v_cvt_pk_bf16_f32 v240, v128, v129
    v_cvt_pk_bf16_f32 v241, v184, v185
    v_cvt_pk_bf16_f32 v242, v130, v131
    v_cvt_pk_bf16_f32 v243, v186, v187
    v_cvt_pk_bf16_f32 v244, v132, v133
    v_cvt_pk_bf16_f32 v245, v188, v189
    v_cvt_pk_bf16_f32 v246, v134, -v135
    v_cvt_pk_bf16_f32 v247, v190, -v191
    v_cvt_pk_bf16_f32 v248, v148, v149
    v_cvt_pk_bf16_f32 v249, v204, v205
    v_cvt_pk_bf16_f32 v250, v146, -v147
    v_cvt_pk_bf16_f32 v251, v202, -v203
    ds_write2st64_b64 v32, v[236:237], v[238:239] offset0:0 offset1:16
    ds_write2st64_b64 v40, v[240:241], v[242:243] offset0:0 offset1:16
    ds_write2st64_b64 v32, v[244:245], v[246:247] offset0:32 offset1:41
    ds_write2st64_b64 v33, v[248:249], v[250:251] offset0:32 offset1:41
    v_pk_mul_f32 v[150:151], v[136:137], v[124:125] op_sel_hi:[1,0]
    v_pk_mul_f32 v[206:207], v[192:193], v[180:181] op_sel_hi:[1,0]
    v_pk_mul_f32 v[152:153], v[136:137], v[136:137] op_sel_hi:[1,0]
    v_pk_mul_f32 v[208:209], v[192:193], v[192:193] op_sel_hi:[1,0]
    v_pk_mul_f32 v[154:155], v[138:139], v[128:129] op_sel_hi:[1,0]
    v_pk_mul_f32 v[210:211], v[194:195], v[184:185] op_sel_hi:[1,0]
    v_pk_mul_f32 v[156:157], v[130:131], v[138:139] op_sel_hi:[1,0]
    v_pk_mul_f32 v[212:213], v[186:187], v[194:195] op_sel_hi:[1,0]
    v_pk_mul_f32 v[158:159], v[128:129], v[136:137] op_sel_hi:[1,0]
    v_pk_mul_f32 v[214:215], v[184:185], v[192:193] op_sel_hi:[1,0]
    v_pk_mul_f32 v[160:161], v[138:139], v[136:137] op_sel_hi:[1,0]
    v_pk_mul_f32 v[216:217], v[194:195], v[192:193] op_sel_hi:[1,0]
    v_pk_mul_f32 v[162:163], v[134:135], v[144:145] op_sel_hi:[1,0]
    v_pk_mul_f32 v[218:219], v[190:191], v[200:201] op_sel_hi:[1,0]
    v_pk_mul_f32 v[164:165], v[146:147], v[144:145] op_sel_hi:[1,0]
    v_pk_mul_f32 v[220:221], v[202:203], v[200:201] op_sel_hi:[1,0]
    v_pk_mul_f32 v[166:167], v[132:133], v[138:139] op_sel_hi:[1,0]
    v_pk_mul_f32 v[222:223], v[188:189], v[194:195] op_sel_hi:[1,0]
    v_pk_mul_f32 v[168:169], v[148:149], v[138:139] op_sel_hi:[1,0]
    v_pk_mul_f32 v[224:225], v[204:205], v[194:195] op_sel_hi:[1,0]
    v_pk_fma_f32 v[150:151], v[136:137], v[124:125], v[150:151] op_sel:[1,1,0] op_sel_hi:[0,1,1] neg_lo:[1,0,0]
    v_pk_fma_f32 v[206:207], v[192:193], v[180:181], v[206:207] op_sel:[1,1,0] op_sel_hi:[0,1,1] neg_lo:[1,0,0]
    v_pk_fma_f32 v[152:153], v[136:137], v[136:137], v[152:153] op_sel:[1,1,0] op_sel_hi:[0,1,1] neg_lo:[1,0,0]
    v_pk_fma_f32 v[208:209], v[192:193], v[192:193], v[208:209] op_sel:[1,1,0] op_sel_hi:[0,1,1] neg_lo:[1,0,0]
    v_pk_fma_f32 v[154:155], v[138:139], v[128:129], v[154:155] op_sel:[1,1,0] op_sel_hi:[0,1,1] neg_lo:[1,0,0]
    v_pk_fma_f32 v[210:211], v[194:195], v[184:185], v[210:211] op_sel:[1,1,0] op_sel_hi:[0,1,1] neg_lo:[1,0,0]
    v_pk_fma_f32 v[156:157], v[130:131], v[138:139], v[156:157] op_sel:[1,1,0] op_sel_hi:[0,1,1] neg_lo:[1,0,0]
    v_pk_fma_f32 v[212:213], v[186:187], v[194:195], v[212:213] op_sel:[1,1,0] op_sel_hi:[0,1,1] neg_lo:[1,0,0]
    v_pk_fma_f32 v[158:159], v[128:129], v[136:137], v[158:159] op_sel:[1,1,0] op_sel_hi:[0,1,1] neg_lo:[1,0,0]
    v_pk_fma_f32 v[214:215], v[184:185], v[192:193], v[214:215] op_sel:[1,1,0] op_sel_hi:[0,1,1] neg_lo:[1,0,0]
    v_pk_fma_f32 v[160:161], v[138:139], v[136:137], v[160:161] op_sel:[1,1,0] op_sel_hi:[0,1,1] neg_lo:[1,0,0]
    v_pk_fma_f32 v[216:217], v[194:195], v[192:193], v[216:217] op_sel:[1,1,0] op_sel_hi:[0,1,1] neg_lo:[1,0,0]
    v_pk_fma_f32 v[162:163], v[134:135], v[144:145], v[162:163] op_sel:[1,1,0] op_sel_hi:[0,1,1] neg_lo:[1,0,0]
    v_pk_fma_f32 v[218:219], v[190:191], v[200:201], v[218:219] op_sel:[1,1,0] op_sel_hi:[0,1,1] neg_lo:[1,0,0]
    v_pk_fma_f32 v[164:165], v[146:147], v[144:145], v[164:165] op_sel:[1,1,0] op_sel_hi:[0,1,1] neg_lo:[1,0,0]
    v_pk_fma_f32 v[220:221], v[202:203], v[200:201], v[220:221] op_sel:[1,1,0] op_sel_hi:[0,1,1] neg_lo:[1,0,0]
    v_pk_fma_f32 v[166:167], v[132:133], v[138:139], v[166:167] op_sel:[1,1,0] op_sel_hi:[0,1,1] neg_lo:[1,0,0]
    v_pk_fma_f32 v[222:223], v[188:189], v[194:195], v[222:223] op_sel:[1,1,0] op_sel_hi:[0,1,1] neg_lo:[1,0,0]
    v_pk_fma_f32 v[168:169], v[148:149], v[138:139], v[168:169] op_sel:[1,1,0] op_sel_hi:[0,1,1] neg_lo:[1,0,0]
    v_pk_fma_f32 v[224:225], v[204:205], v[194:195], v[224:225] op_sel:[1,1,0] op_sel_hi:[0,1,1] neg_lo:[1,0,0]
    v_cvt_pk_bf16_f32 v236, v158, v159
    v_cvt_pk_bf16_f32 v237, v214, v215
    v_cvt_pk_bf16_f32 v238, v140, v141
    v_cvt_pk_bf16_f32 v239, v196, v197
    v_cvt_pk_bf16_f32 v240, v124, v125
    v_cvt_pk_bf16_f32 v241, v180, v181
    v_cvt_pk_bf16_f32 v242, v160, v161
    v_cvt_pk_bf16_f32 v243, v216, v217
    v_cvt_pk_bf16_f32 v244, v152, v153
    v_cvt_pk_bf16_f32 v245, v208, v209
    v_cvt_pk_bf16_f32 v246, v154, v155
    v_cvt_pk_bf16_f32 v247, v210, v211
    v_cvt_pk_bf16_f32 v248, v166, v167
    v_cvt_pk_bf16_f32 v249, v222, v223
    v_cvt_pk_bf16_f32 v250, v162, -v163
    v_cvt_pk_bf16_f32 v251, v218, -v219
    v_cvt_pk_bf16_f32 v252, v168, v169
    v_cvt_pk_bf16_f32 v253, v224, v225
    v_cvt_pk_bf16_f32 v254, v164, -v165
    v_cvt_pk_bf16_f32 v255, v220, -v221
    ds_write2st64_b64 v42, v[236:237], v[238:239] offset0:0 offset1:16
    ds_write2st64_b64 v33, v[240:241], v[242:243] offset0:0 offset1:16
    ds_write2st64_b64 v36, v[244:245], v[246:247] offset0:0 offset1:16
    ds_write2st64_b64 v34, v[248:249], v[250:251] offset0:32 offset1:41
    ds_write2st64_b64 v35, v[252:253], v[254:255] offset0:32 offset1:41
    v_pk_mul_f32 v[170:171], v[138:139], v[152:153] op_sel_hi:[1,0]
    v_pk_mul_f32 v[226:227], v[194:195], v[208:209] op_sel_hi:[1,0]
    v_pk_mul_f32 v[172:173], v[130:131], v[152:153] op_sel_hi:[1,0]
    v_pk_mul_f32 v[228:229], v[186:187], v[208:209] op_sel_hi:[1,0]
    v_pk_mul_f32 v[174:175], v[128:129], v[152:153] op_sel_hi:[1,0]
    v_pk_mul_f32 v[230:231], v[184:185], v[208:209] op_sel_hi:[1,0]
    v_pk_mul_f32 v[176:177], v[128:129], v[150:151] op_sel_hi:[1,0]
    v_pk_mul_f32 v[232:233], v[184:185], v[206:207] op_sel_hi:[1,0]
    v_pk_mul_f32 v[178:179], v[140:141], v[152:153] op_sel_hi:[1,0]
    v_pk_mul_f32 v[234:235], v[196:197], v[208:209] op_sel_hi:[1,0]
    v_pk_mul_f32 v[126:127], v[162:163], v[144:145] op_sel_hi:[1,0]
    v_pk_mul_f32 v[182:183], v[218:219], v[200:201] op_sel_hi:[1,0]
    v_pk_mul_f32 v[134:135], v[164:165], v[144:145] op_sel_hi:[1,0]
    v_pk_mul_f32 v[190:191], v[220:221], v[200:201] op_sel_hi:[1,0]
    v_pk_mul_f32 v[146:147], v[166:167], v[138:139] op_sel_hi:[1,0]
    v_pk_mul_f32 v[202:203], v[222:223], v[194:195] op_sel_hi:[1,0]
    v_pk_mul_f32 v[148:149], v[168:169], v[138:139] op_sel_hi:[1,0]
    v_pk_mul_f32 v[204:205], v[224:225], v[194:195] op_sel_hi:[1,0]
    v_pk_fma_f32 v[170:171], v[138:139], v[152:153], v[170:171] op_sel:[1,1,0] op_sel_hi:[0,1,1] neg_lo:[1,0,0]
    v_pk_fma_f32 v[226:227], v[194:195], v[208:209], v[226:227] op_sel:[1,1,0] op_sel_hi:[0,1,1] neg_lo:[1,0,0]
    v_pk_fma_f32 v[172:173], v[130:131], v[152:153], v[172:173] op_sel:[1,1,0] op_sel_hi:[0,1,1] neg_lo:[1,0,0]
    v_pk_fma_f32 v[228:229], v[186:187], v[208:209], v[228:229] op_sel:[1,1,0] op_sel_hi:[0,1,1] neg_lo:[1,0,0]
    v_pk_fma_f32 v[174:175], v[128:129], v[152:153], v[174:175] op_sel:[1,1,0] op_sel_hi:[0,1,1] neg_lo:[1,0,0]
    v_pk_fma_f32 v[230:231], v[184:185], v[208:209], v[230:231] op_sel:[1,1,0] op_sel_hi:[0,1,1] neg_lo:[1,0,0]
    v_pk_fma_f32 v[176:177], v[128:129], v[150:151], v[176:177] op_sel:[1,1,0] op_sel_hi:[0,1,1] neg_lo:[1,0,0]
    v_pk_fma_f32 v[232:233], v[184:185], v[206:207], v[232:233] op_sel:[1,1,0] op_sel_hi:[0,1,1] neg_lo:[1,0,0]
    v_pk_fma_f32 v[178:179], v[140:141], v[152:153], v[178:179] op_sel:[1,1,0] op_sel_hi:[0,1,1] neg_lo:[1,0,0]
    v_pk_fma_f32 v[234:235], v[196:197], v[208:209], v[234:235] op_sel:[1,1,0] op_sel_hi:[0,1,1] neg_lo:[1,0,0]
    v_pk_fma_f32 v[126:127], v[162:163], v[144:145], v[126:127] op_sel:[1,1,0] op_sel_hi:[0,1,1] neg_lo:[1,0,0]
    v_pk_fma_f32 v[182:183], v[218:219], v[200:201], v[182:183] op_sel:[1,1,0] op_sel_hi:[0,1,1] neg_lo:[1,0,0]
    v_pk_fma_f32 v[134:135], v[164:165], v[144:145], v[134:135] op_sel:[1,1,0] op_sel_hi:[0,1,1] neg_lo:[1,0,0]
    v_pk_fma_f32 v[190:191], v[220:221], v[200:201], v[190:191] op_sel:[1,1,0] op_sel_hi:[0,1,1] neg_lo:[1,0,0]
    v_pk_fma_f32 v[146:147], v[166:167], v[138:139], v[146:147] op_sel:[1,1,0] op_sel_hi:[0,1,1] neg_lo:[1,0,0]
    v_pk_fma_f32 v[202:203], v[222:223], v[194:195], v[202:203] op_sel:[1,1,0] op_sel_hi:[0,1,1] neg_lo:[1,0,0]
    v_pk_fma_f32 v[148:149], v[168:169], v[138:139], v[148:149] op_sel:[1,1,0] op_sel_hi:[0,1,1] neg_lo:[1,0,0]
    v_pk_fma_f32 v[204:205], v[224:225], v[194:195], v[204:205] op_sel:[1,1,0] op_sel_hi:[0,1,1] neg_lo:[1,0,0]
    v_cvt_pk_bf16_f32 v236, v136, v137
    v_cvt_pk_bf16_f32 v237, v192, v193
    v_cvt_pk_bf16_f32 v238, v170, v171
    v_cvt_pk_bf16_f32 v239, v226, v227
    v_cvt_pk_bf16_f32 v240, v142, v143
    v_cvt_pk_bf16_f32 v241, v198, v199
    v_cvt_pk_bf16_f32 v242, v172, v173
    v_cvt_pk_bf16_f32 v243, v228, v229
    v_cvt_pk_bf16_f32 v244, v174, v175
    v_cvt_pk_bf16_f32 v245, v230, v231
    v_cvt_pk_bf16_f32 v246, v156, v157
    v_cvt_pk_bf16_f32 v247, v212, v213
    v_cvt_pk_bf16_f32 v248, v176, v177
    v_cvt_pk_bf16_f32 v249, v232, v233
    v_cvt_pk_bf16_f32 v250, v178, v179
    v_cvt_pk_bf16_f32 v251, v234, v235
    v_cvt_pk_bf16_f32 v252, v146, v147
    v_cvt_pk_bf16_f32 v253, v202, v203
    v_cvt_pk_bf16_f32 v254, v126, -v127
    v_cvt_pk_bf16_f32 v255, v182, -v183
    ds_write2st64_b64 v34, v[236:237], v[238:239] offset0:0 offset1:16
    ds_write2st64_b64 v41, v[240:241], v[242:243] offset0:0 offset1:16
    ds_write2st64_b64 v44, v[244:245], v[246:247] offset0:0 offset1:16
    ds_write2st64_b64 v43, v[248:249], v[250:251] offset0:0 offset1:16
    ds_write2st64_b64 v36, v[252:253], v[254:255] offset0:32 offset1:41
    v_pk_mul_f32 v[132:133], v[152:153], v[124:125] op_sel_hi:[1,0]
    v_pk_mul_f32 v[188:189], v[208:209], v[180:181] op_sel_hi:[1,0]
    v_pk_mul_f32 v[158:159], v[152:153], v[136:137] op_sel_hi:[1,0]
    v_pk_mul_f32 v[214:215], v[208:209], v[192:193] op_sel_hi:[1,0]
    v_pk_mul_f32 v[160:161], v[152:153], v[150:151] op_sel_hi:[1,0]
    v_pk_mul_f32 v[216:217], v[208:209], v[206:207] op_sel_hi:[1,0]
    v_pk_mul_f32 v[162:163], v[130:131], v[154:155] op_sel_hi:[1,0]
    v_pk_mul_f32 v[218:219], v[186:187], v[210:211] op_sel_hi:[1,0]
    v_pk_mul_f32 v[164:165], v[154:155], v[136:137] op_sel_hi:[1,0]
    v_pk_mul_f32 v[220:221], v[210:211], v[192:193] op_sel_hi:[1,0]
    v_pk_mul_f32 v[166:167], v[154:155], v[152:153] op_sel_hi:[1,0]
    v_pk_mul_f32 v[222:223], v[210:211], v[208:209] op_sel_hi:[1,0]
    v_pk_mul_f32 v[168:169], v[156:157], v[152:153] op_sel_hi:[1,0]
    v_pk_mul_f32 v[224:225], v[212:213], v[208:209] op_sel_hi:[1,0]
    v_pk_mul_f32 v[140:141], v[126:127], v[144:145] op_sel_hi:[1,0]
    v_pk_mul_f32 v[196:197], v[182:183], v[200:201] op_sel_hi:[1,0]
    v_pk_mul_f32 v[170:171], v[134:135], v[144:145] op_sel_hi:[1,0]
    v_pk_mul_f32 v[226:227], v[190:191], v[200:201] op_sel_hi:[1,0]
    v_pk_mul_f32 v[142:143], v[146:147], v[138:139] op_sel_hi:[1,0]
    v_pk_mul_f32 v[198:199], v[202:203], v[194:195] op_sel_hi:[1,0]
    v_pk_mul_f32 v[172:173], v[148:149], v[138:139] op_sel_hi:[1,0]
    v_pk_mul_f32 v[228:229], v[204:205], v[194:195] op_sel_hi:[1,0]
    v_pk_fma_f32 v[132:133], v[152:153], v[124:125], v[132:133] op_sel:[1,1,0] op_sel_hi:[0,1,1] neg_lo:[1,0,0]
    v_pk_fma_f32 v[188:189], v[208:209], v[180:181], v[188:189] op_sel:[1,1,0] op_sel_hi:[0,1,1] neg_lo:[1,0,0]
    v_pk_fma_f32 v[158:159], v[152:153], v[136:137], v[158:159] op_sel:[1,1,0] op_sel_hi:[0,1,1] neg_lo:[1,0,0]
    v_pk_fma_f32 v[214:215], v[208:209], v[192:193], v[214:215] op_sel:[1,1,0] op_sel_hi:[0,1,1] neg_lo:[1,0,0]
    v_pk_fma_f32 v[160:161], v[152:153], v[150:151], v[160:161] op_sel:[1,1,0] op_sel_hi:[0,1,1] neg_lo:[1,0,0]
    v_pk_fma_f32 v[216:217], v[208:209], v[206:207], v[216:217] op_sel:[1,1,0] op_sel_hi:[0,1,1] neg_lo:[1,0,0]
    v_pk_fma_f32 v[162:163], v[130:131], v[154:155], v[162:163] op_sel:[1,1,0] op_sel_hi:[0,1,1] neg_lo:[1,0,0]
    v_pk_fma_f32 v[218:219], v[186:187], v[210:211], v[218:219] op_sel:[1,1,0] op_sel_hi:[0,1,1] neg_lo:[1,0,0]
    v_pk_fma_f32 v[164:165], v[154:155], v[136:137], v[164:165] op_sel:[1,1,0] op_sel_hi:[0,1,1] neg_lo:[1,0,0]
    v_pk_fma_f32 v[220:221], v[210:211], v[192:193], v[220:221] op_sel:[1,1,0] op_sel_hi:[0,1,1] neg_lo:[1,0,0]
    v_pk_fma_f32 v[166:167], v[154:155], v[152:153], v[166:167] op_sel:[1,1,0] op_sel_hi:[0,1,1] neg_lo:[1,0,0]
    v_pk_fma_f32 v[222:223], v[210:211], v[208:209], v[222:223] op_sel:[1,1,0] op_sel_hi:[0,1,1] neg_lo:[1,0,0]
    v_pk_fma_f32 v[168:169], v[156:157], v[152:153], v[168:169] op_sel:[1,1,0] op_sel_hi:[0,1,1] neg_lo:[1,0,0]
    v_pk_fma_f32 v[224:225], v[212:213], v[208:209], v[224:225] op_sel:[1,1,0] op_sel_hi:[0,1,1] neg_lo:[1,0,0]
    v_pk_fma_f32 v[140:141], v[126:127], v[144:145], v[140:141] op_sel:[1,1,0] op_sel_hi:[0,1,1] neg_lo:[1,0,0]
    v_pk_fma_f32 v[196:197], v[182:183], v[200:201], v[196:197] op_sel:[1,1,0] op_sel_hi:[0,1,1] neg_lo:[1,0,0]
    v_pk_fma_f32 v[170:171], v[134:135], v[144:145], v[170:171] op_sel:[1,1,0] op_sel_hi:[0,1,1] neg_lo:[1,0,0]
    v_pk_fma_f32 v[226:227], v[190:191], v[200:201], v[226:227] op_sel:[1,1,0] op_sel_hi:[0,1,1] neg_lo:[1,0,0]
    v_pk_fma_f32 v[142:143], v[146:147], v[138:139], v[142:143] op_sel:[1,1,0] op_sel_hi:[0,1,1] neg_lo:[1,0,0]
    v_pk_fma_f32 v[198:199], v[202:203], v[194:195], v[198:199] op_sel:[1,1,0] op_sel_hi:[0,1,1] neg_lo:[1,0,0]
    v_pk_fma_f32 v[172:173], v[148:149], v[138:139], v[172:173] op_sel:[1,1,0] op_sel_hi:[0,1,1] neg_lo:[1,0,0]
    v_pk_fma_f32 v[228:229], v[204:205], v[194:195], v[228:229] op_sel:[1,1,0] op_sel_hi:[0,1,1] neg_lo:[1,0,0]
    v_cvt_pk_bf16_f32 v236, v148, v149
    v_cvt_pk_bf16_f32 v237, v204, v205
    v_cvt_pk_bf16_f32 v238, v134, -v135
    v_cvt_pk_bf16_f32 v239, v190, -v191
    v_cvt_pk_bf16_f32 v240, v132, v133
    v_cvt_pk_bf16_f32 v241, v188, v189
    v_cvt_pk_bf16_f32 v242, v164, v165
    v_cvt_pk_bf16_f32 v243, v220, v221
    v_cvt_pk_bf16_f32 v244, v158, v159
    v_cvt_pk_bf16_f32 v245, v214, v215
    v_cvt_pk_bf16_f32 v246, v166, v167
    v_cvt_pk_bf16_f32 v247, v222, v223
    v_cvt_pk_bf16_f32 v248, v142, v143
    v_cvt_pk_bf16_f32 v249, v198, v199
    v_cvt_pk_bf16_f32 v250, v140, -v141
    v_cvt_pk_bf16_f32 v251, v196, -v197
    v_cvt_pk_bf16_f32 v252, v172, v173
    v_cvt_pk_bf16_f32 v253, v228, v229
    v_cvt_pk_bf16_f32 v254, v170, -v171
    v_cvt_pk_bf16_f32 v255, v226, -v227
    ds_write2st64_b64 v37, v[236:237], v[238:239] offset0:32 offset1:41
    ds_write2st64_b64 v37, v[240:241], v[242:243] offset0:0 offset1:16
    ds_write2st64_b64 v38, v[244:245], v[246:247] offset0:0 offset1:16
    ds_write2st64_b64 v38, v[248:249], v[250:251] offset0:32 offset1:41
    ds_write2st64_b64 v39, v[252:253], v[254:255] offset0:32 offset1:41
    v_pk_mul_f32 v[174:175], v[138:139], v[158:159] op_sel_hi:[1,0]
    v_pk_mul_f32 v[230:231], v[194:195], v[214:215] op_sel_hi:[1,0]
    v_pk_mul_f32 v[176:177], v[154:155], v[158:159] op_sel_hi:[1,0]
    v_pk_mul_f32 v[232:233], v[210:211], v[214:215] op_sel_hi:[1,0]
    v_pk_mul_f32 v[178:179], v[128:129], v[132:133] op_sel_hi:[1,0]
    v_pk_mul_f32 v[234:235], v[184:185], v[188:189] op_sel_hi:[1,0]
    v_pk_mul_f32 v[126:127], v[128:129], v[158:159] op_sel_hi:[1,0]
    v_pk_mul_f32 v[182:183], v[184:185], v[214:215] op_sel_hi:[1,0]
    v_pk_mul_f32 v[134:135], v[128:129], v[160:161] op_sel_hi:[1,0]
    v_pk_mul_f32 v[190:191], v[184:185], v[216:217] op_sel_hi:[1,0]
    v_pk_mul_f32 v[146:147], v[162:163], v[152:153] op_sel_hi:[1,0]
    v_pk_mul_f32 v[202:203], v[218:219], v[208:209] op_sel_hi:[1,0]
    v_pk_mul_f32 v[148:149], v[140:141], v[144:145] op_sel_hi:[1,0]
    v_pk_mul_f32 v[204:205], v[196:197], v[200:201] op_sel_hi:[1,0]
    v_pk_mul_f32 v[164:165], v[170:171], v[144:145] op_sel_hi:[1,0]
    v_pk_mul_f32 v[220:221], v[226:227], v[200:201] op_sel_hi:[1,0]
    v_pk_mul_f32 v[166:167], v[142:143], v[138:139] op_sel_hi:[1,0]
    v_pk_mul_f32 v[222:223], v[198:199], v[194:195] op_sel_hi:[1,0]
    v_pk_fma_f32 v[174:175], v[138:139], v[158:159], v[174:175] op_sel:[1,1,0] op_sel_hi:[0,1,1] neg_lo:[1,0,0]
    v_pk_fma_f32 v[230:231], v[194:195], v[214:215], v[230:231] op_sel:[1,1,0] op_sel_hi:[0,1,1] neg_lo:[1,0,0]
    v_pk_fma_f32 v[176:177], v[154:155], v[158:159], v[176:177] op_sel:[1,1,0] op_sel_hi:[0,1,1] neg_lo:[1,0,0]
    v_pk_fma_f32 v[232:233], v[210:211], v[214:215], v[232:233] op_sel:[1,1,0] op_sel_hi:[0,1,1] neg_lo:[1,0,0]
    v_pk_fma_f32 v[178:179], v[128:129], v[132:133], v[178:179] op_sel:[1,1,0] op_sel_hi:[0,1,1] neg_lo:[1,0,0]
    v_pk_fma_f32 v[234:235], v[184:185], v[188:189], v[234:235] op_sel:[1,1,0] op_sel_hi:[0,1,1] neg_lo:[1,0,0]
    v_pk_fma_f32 v[126:127], v[128:129], v[158:159], v[126:127] op_sel:[1,1,0] op_sel_hi:[0,1,1] neg_lo:[1,0,0]
    v_pk_fma_f32 v[182:183], v[184:185], v[214:215], v[182:183] op_sel:[1,1,0] op_sel_hi:[0,1,1] neg_lo:[1,0,0]
    v_pk_fma_f32 v[134:135], v[128:129], v[160:161], v[134:135] op_sel:[1,1,0] op_sel_hi:[0,1,1] neg_lo:[1,0,0]
    v_pk_fma_f32 v[190:191], v[184:185], v[216:217], v[190:191] op_sel:[1,1,0] op_sel_hi:[0,1,1] neg_lo:[1,0,0]
    v_pk_fma_f32 v[146:147], v[162:163], v[152:153], v[146:147] op_sel:[1,1,0] op_sel_hi:[0,1,1] neg_lo:[1,0,0]
    v_pk_fma_f32 v[202:203], v[218:219], v[208:209], v[202:203] op_sel:[1,1,0] op_sel_hi:[0,1,1] neg_lo:[1,0,0]
    v_pk_fma_f32 v[148:149], v[140:141], v[144:145], v[148:149] op_sel:[1,1,0] op_sel_hi:[0,1,1] neg_lo:[1,0,0]
    v_pk_fma_f32 v[204:205], v[196:197], v[200:201], v[204:205] op_sel:[1,1,0] op_sel_hi:[0,1,1] neg_lo:[1,0,0]
    v_pk_fma_f32 v[164:165], v[170:171], v[144:145], v[164:165] op_sel:[1,1,0] op_sel_hi:[0,1,1] neg_lo:[1,0,0]
    v_pk_fma_f32 v[220:221], v[226:227], v[200:201], v[220:221] op_sel:[1,1,0] op_sel_hi:[0,1,1] neg_lo:[1,0,0]
    v_pk_fma_f32 v[166:167], v[142:143], v[138:139], v[166:167] op_sel:[1,1,0] op_sel_hi:[0,1,1] neg_lo:[1,0,0]
    v_pk_fma_f32 v[222:223], v[198:199], v[194:195], v[222:223] op_sel:[1,1,0] op_sel_hi:[0,1,1] neg_lo:[1,0,0]
    v_cvt_pk_bf16_f32 v236, v150, v151
    v_cvt_pk_bf16_f32 v237, v206, v207
    v_cvt_pk_bf16_f32 v238, v174, v175
    v_cvt_pk_bf16_f32 v239, v230, v231
    v_cvt_pk_bf16_f32 v240, v160, v161
    v_cvt_pk_bf16_f32 v241, v216, v217
    v_cvt_pk_bf16_f32 v242, v176, v177
    v_cvt_pk_bf16_f32 v243, v232, v233
    v_cvt_pk_bf16_f32 v244, v178, v179
    v_cvt_pk_bf16_f32 v245, v234, v235
    v_cvt_pk_bf16_f32 v246, v168, v169
    v_cvt_pk_bf16_f32 v247, v224, v225
    v_cvt_pk_bf16_f32 v248, v126, v127
    v_cvt_pk_bf16_f32 v249, v182, v183
    v_cvt_pk_bf16_f32 v250, v162, v163
    v_cvt_pk_bf16_f32 v251, v218, v219
    v_cvt_pk_bf16_f32 v252, v134, v135
    v_cvt_pk_bf16_f32 v253, v190, v191
    v_cvt_pk_bf16_f32 v254, v146, v147
    v_cvt_pk_bf16_f32 v255, v202, v203
    ds_write2st64_b64 v35, v[236:237], v[238:239] offset0:0 offset1:16
    ds_write2st64_b64 v39, v[240:241], v[242:243] offset0:0 offset1:16
    ds_write2st64_b64 v45, v[244:245], v[246:247] offset0:0 offset1:16
    ds_write2st64_b64 v46, v[248:249], v[250:251] offset0:0 offset1:16
    ds_write2st64_b64 v47, v[252:253], v[254:255] offset0:0 offset1:16
    v_pk_mul_f32 v[124:125], v[148:149], v[144:145] op_sel_hi:[1,0]
    v_pk_mul_f32 v[180:181], v[204:205], v[200:201] op_sel_hi:[1,0]
    v_pk_mul_f32 v[136:137], v[164:165], v[144:145] op_sel_hi:[1,0]
    v_pk_mul_f32 v[192:193], v[220:221], v[200:201] op_sel_hi:[1,0]
    v_pk_fma_f32 v[124:125], v[148:149], v[144:145], v[124:125] op_sel:[1,1,0] op_sel_hi:[0,1,1] neg_lo:[1,0,0]
    v_pk_fma_f32 v[180:181], v[204:205], v[200:201], v[180:181] op_sel:[1,1,0] op_sel_hi:[0,1,1] neg_lo:[1,0,0]
    v_pk_fma_f32 v[136:137], v[164:165], v[144:145], v[136:137] op_sel:[1,1,0] op_sel_hi:[0,1,1] neg_lo:[1,0,0]
    v_pk_fma_f32 v[192:193], v[220:221], v[200:201], v[192:193] op_sel:[1,1,0] op_sel_hi:[0,1,1] neg_lo:[1,0,0]
    v_cvt_pk_bf16_f32 v236, v166, v167
    v_cvt_pk_bf16_f32 v237, v222, v223
    v_cvt_pk_bf16_f32 v238, v148, -v149
    v_cvt_pk_bf16_f32 v239, v204, -v205
    v_cvt_pk_bf16_f32 v240, v164, -v165
    v_cvt_pk_bf16_f32 v241, v220, -v221
    ds_write2st64_b64 v40, v[236:237], v[238:239] offset0:32 offset1:41
    ds_write_b64 v41, v[240:241] offset:20992
    v_pk_mul_f32 v[130:131], v[124:125], v[144:145] op_sel_hi:[1,0]
    v_pk_mul_f32 v[186:187], v[180:181], v[200:201] op_sel_hi:[1,0]
    v_pk_mul_f32 v[156:157], v[136:137], v[144:145] op_sel_hi:[1,0]
    v_pk_mul_f32 v[212:213], v[192:193], v[200:201] op_sel_hi:[1,0]
    v_pk_fma_f32 v[130:131], v[124:125], v[144:145], v[130:131] op_sel:[1,1,0] op_sel_hi:[0,1,1] neg_lo:[1,0,0]
    v_pk_fma_f32 v[186:187], v[180:181], v[200:201], v[186:187] op_sel:[1,1,0] op_sel_hi:[0,1,1] neg_lo:[1,0,0]
    v_pk_fma_f32 v[156:157], v[136:137], v[144:145], v[156:157] op_sel:[1,1,0] op_sel_hi:[0,1,1] neg_lo:[1,0,0]
    v_pk_fma_f32 v[212:213], v[192:193], v[200:201], v[212:213] op_sel:[1,1,0] op_sel_hi:[0,1,1] neg_lo:[1,0,0]
    v_cvt_pk_bf16_f32 v236, v124, -v125
    v_cvt_pk_bf16_f32 v237, v180, -v181
    v_cvt_pk_bf16_f32 v238, v136, -v137
    v_cvt_pk_bf16_f32 v239, v192, -v193
    ds_write_b64 v42, v[236:237] offset:20992
    ds_write_b64 v43, v[238:239] offset:20992
    v_pk_mul_f32 v[172:173], v[130:131], v[144:145] op_sel_hi:[1,0]
    v_pk_mul_f32 v[228:229], v[186:187], v[200:201] op_sel_hi:[1,0]
    v_pk_mul_f32 v[140:141], v[156:157], v[144:145] op_sel_hi:[1,0]
    v_pk_mul_f32 v[196:197], v[212:213], v[200:201] op_sel_hi:[1,0]
    v_pk_fma_f32 v[172:173], v[130:131], v[144:145], v[172:173] op_sel:[1,1,0] op_sel_hi:[0,1,1] neg_lo:[1,0,0]
    v_pk_fma_f32 v[228:229], v[186:187], v[200:201], v[228:229] op_sel:[1,1,0] op_sel_hi:[0,1,1] neg_lo:[1,0,0]
    v_pk_fma_f32 v[140:141], v[156:157], v[144:145], v[140:141] op_sel:[1,1,0] op_sel_hi:[0,1,1] neg_lo:[1,0,0]
    v_pk_fma_f32 v[196:197], v[212:213], v[200:201], v[196:197] op_sel:[1,1,0] op_sel_hi:[0,1,1] neg_lo:[1,0,0]
    v_cvt_pk_bf16_f32 v236, v130, -v131
    v_cvt_pk_bf16_f32 v237, v186, -v187
    v_cvt_pk_bf16_f32 v238, v156, -v157
    v_cvt_pk_bf16_f32 v239, v212, -v213
    v_cvt_pk_bf16_f32 v240, v172, -v173
    v_cvt_pk_bf16_f32 v241, v228, -v229
    v_cvt_pk_bf16_f32 v242, v140, -v141
    v_cvt_pk_bf16_f32 v243, v196, -v197
    ds_write_b64 v44, v[236:237] offset:20992
    ds_write_b64 v45, v[238:239] offset:20992
    ds_write_b64 v46, v[240:241] offset:20992
    ds_write_b64 v47, v[242:243] offset:20992
    s_mov_b32 s43, 37814272
    s_cmp_eq_u32 s66, 2
    s_cbranch_scc0 L_kc_npoll
    s_waitcnt vmcnt(0)
    buffer_load_dwordx4 v[20:23], v25, s[12:15], s43 offen sc1
L_kc_npoll:
    ds_read_b128 a[0:3], v48 offset:20992
    ds_read_b128 a[32:35], v48 offset:0
    ds_read_b128 a[64:67], v48 offset:8192
    ds_read_b128 a[96:99], v48 offset:16384
    ds_read_b128 a[4:7], v49 offset:20992
    ds_read_b128 a[36:39], v49 offset:0
    ds_read_b128 a[68:71], v49 offset:8192
    ds_read_b128 a[100:103], v49 offset:16384
    ds_read_b128 a[8:11], v50 offset:20992
    ds_read_b128 a[40:43], v50 offset:0
    ds_read_b128 a[72:75], v50 offset:8192
    ds_read_b128 a[104:107], v50 offset:16384
    s_waitcnt lgkmcnt(10)
    v_mfma_f32_16x16x32_bf16 v[124:127], a[32:35], a[0:3], 0
    s_waitcnt lgkmcnt(9)
    v_mfma_f32_16x16x32_bf16 v[128:131], a[64:67], a[0:3], 0
    s_waitcnt lgkmcnt(8)
    v_mfma_f32_16x16x32_bf16 v[132:135], a[96:99], a[0:3], 0
    ds_read_b128 a[12:15], v51 offset:20992
    ds_read_b128 a[44:47], v51 offset:0
    ds_read_b128 a[76:79], v51 offset:8192
    ds_read_b128 a[108:111], v51 offset:16384
    s_waitcnt lgkmcnt(10)
    v_mfma_f32_16x16x32_bf16 v[124:127], a[36:39], a[4:7], v[124:127]
    s_waitcnt lgkmcnt(9)
    v_mfma_f32_16x16x32_bf16 v[128:131], a[68:71], a[4:7], v[128:131]
    s_waitcnt lgkmcnt(8)
    v_mfma_f32_16x16x32_bf16 v[132:135], a[100:103], a[4:7], v[132:135]
    ds_read_b128 a[16:19], v48 offset:21248
    ds_read_b128 a[48:51], v48 offset:256
    ds_read_b128 a[80:83], v48 offset:8448
    ds_read_b128 a[112:115], v48 offset:16640
    s_waitcnt lgkmcnt(10)
    v_mfma_f32_16x16x32_bf16 v[124:127], a[40:43], a[8:11], v[124:127]
    s_waitcnt lgkmcnt(9)
    v_mfma_f32_16x16x32_bf16 v[128:131], a[72:75], a[8:11], v[128:131]
    s_waitcnt lgkmcnt(8)
    v_mfma_f32_16x16x32_bf16 v[132:135], a[104:107], a[8:11], v[132:135]
    ds_read_b128 a[20:23], v49 offset:21248
    ds_read_b128 a[52:55], v49 offset:256
    ds_read_b128 a[84:87], v49 offset:8448
    ds_read_b128 a[116:119], v49 offset:16640
    s_waitcnt lgkmcnt(10)
    v_mfma_f32_16x16x32_bf16 v[124:127], a[44:47], a[12:15], v[124:127]
    s_waitcnt lgkmcnt(9)
    v_mfma_f32_16x16x32_bf16 v[128:131], a[76:79], a[12:15], v[128:131]
    s_waitcnt lgkmcnt(8)
    v_mfma_f32_16x16x32_bf16 v[132:135], a[108:111], a[12:15], v[132:135]
    ds_read_b128 a[24:27], v50 offset:21248
    ds_read_b128 a[56:59], v50 offset:256
    ds_read_b128 a[88:91], v50 offset:8448
    ds_read_b128 a[120:123], v50 offset:16640
    s_waitcnt lgkmcnt(10)
    v_mfma_f32_16x16x32_bf16 v[124:127], a[48:51], a[16:19], v[124:127]
    s_waitcnt lgkmcnt(9)
    v_mfma_f32_16x16x32_bf16 v[128:131], a[80:83], a[16:19], v[128:131]
    s_waitcnt lgkmcnt(8)
    v_mfma_f32_16x16x32_bf16 v[132:135], a[112:115], a[16:19], v[132:135]
    ds_read_b128 a[28:31], v51 offset:21248
    ds_read_b128 a[60:63], v51 offset:256
    ds_read_b128 a[92:95], v51 offset:8448
    ds_read_b128 a[124:127], v51 offset:16640
    s_waitcnt lgkmcnt(10)
    v_mfma_f32_16x16x32_bf16 v[124:127], a[52:55], a[20:23], v[124:127]
    s_waitcnt lgkmcnt(9)
    v_mfma_f32_16x16x32_bf16 v[128:131], a[84:87], a[20:23], v[128:131]
    s_waitcnt lgkmcnt(8)
    v_mfma_f32_16x16x32_bf16 v[132:135], a[116:119], a[20:23], v[132:135]
    s_waitcnt lgkmcnt(6)
    v_mfma_f32_16x16x32_bf16 v[124:127], a[56:59], a[24:27], v[124:127]
    s_waitcnt lgkmcnt(5)
    v_mfma_f32_16x16x32_bf16 v[128:131], a[88:91], a[24:27], v[128:131]
    s_waitcnt lgkmcnt(4)
    v_mfma_f32_16x16x32_bf16 v[132:135], a[120:123], a[24:27], v[132:135]
    s_waitcnt lgkmcnt(2)
    v_mfma_f32_16x16x32_bf16 v[124:127], a[60:63], a[28:31], v[124:127]
    s_waitcnt lgkmcnt(1)
    v_mfma_f32_16x16x32_bf16 v[128:131], a[92:95], a[28:31], v[128:131]
    s_waitcnt lgkmcnt(0)
    v_mfma_f32_16x16x32_bf16 v[132:135], a[124:127], a[28:31], v[132:135]
    s_cmp_eq_u32 s66, 2
    s_cbranch_scc0 L_kc_nchk
    s_waitcnt vmcnt(0)
    v_min_u32 v20, v20, v21
    v_min3_u32 v20, v20, v22, v23
    v_cmp_gt_u32 vcc, 1, v20
    v_cmp_gt_u32 s[76:77], v26, v24
    s_or_b64 vcc, vcc, s[76:77]
    s_cbranch_scc1 L_kc_nchk
    s_mov_b32 s66, 1
    s_add_u32 s43, s56, s36
    s_mul_i32 s43, s43, 4224
    s_add_u32 s43, s43, 18874368
    v_min_u32 v20, 32, v1
    v_lshlrev_b32 v20, 7, v20
    buffer_load_dword a197, v20, s[12:15], s43 offen sc1
L_kc_nchk:
    v_mov_b32 v236, 0
    v_writelane_b32 v236, s59, 0
    v_mov_b32 v240, 0
    v_mov_b32 v241, 0
    v_mov_b32 v242, 0
    v_mov_b32 v243, 0
    v_add_u32 v238, s64, v7
    v_add_u32 v239, s64, v8
    v_add_f32 v124, v124, v236
    ds_write_b32 v52, v124
    ds_write_b32 v53, v125
    ds_write_b32 v54, v126
    ds_write_b32 v55, v127
    ds_write_b32 v56, v128
    ds_write_b32 v57, v129
    ds_write_b32 v58, v130
    ds_write_b32 v59, v131
    ds_write_b32 v60, v132
    ds_write_b32 v61, v133
    ds_write_b32 v62, v134
    ds_write_b32 v63, v135
    ds_write_b32 v9, v240
    ds_write_b128 v239, v[240:243]
    ds_read_b32 v136, v64
    ds_read_b32 v137, v65
    ds_read_b32 v138, v66
    ds_read_b32 v139, v67
    ds_read_b32 v140, v68
    ds_read_b32 v141, v69
    ds_read_b32 v142, v70
    ds_read_b32 v143, v71
    ds_read_b32 v144, v72
    ds_read_b32 v145, v73
    ds_read_b32 v146, v74
    ds_read_b32 v147, v75
    ds_read_b32 v148, v76
    ds_read_b32 v149, v77
    ds_read_b32 v150, v78
    ds_read_b32 v151, v79
    ds_read_b32 v152, v80
    ds_read_b32 v153, v81
    ds_read_b32 v154, v82
    ds_read_b32 v155, v83
    ds_read_b32 v156, v84
    ds_read_b32 v157, v85
    ds_read_b32 v158, v86
    ds_read_b32 v159, v87
    ds_read_b32 v160, v88
    ds_read_b32 v161, v89
    ds_read_b32 v162, v90
    ds_read_b32 v163, v91
    ds_read_b32 v164, v92
    ds_read_b32 v165, v93
    ds_read_b32 v166, v94
    ds_read_b32 v167, v95
    ds_read_b32 v168, v96
    ds_read_b32 v169, v97
    ds_read_b32 v170, v98
    ds_read_b32 v171, v99
    s_waitcnt lgkmcnt(15)
    v_cvt_pk_bf16_f32 v180, v137, v138
    v_cvt_pk_bf16_f32 v181, v139, v140
    v_cvt_pk_bf16_f32 v182, v141, v142
    v_cvt_pk_bf16_f32 v183, v143, v144
    v_cvt_pk_bf16_f32 v184, v136, v137
    v_cvt_pk_bf16_f32 v185, v138, v139
    v_cvt_pk_bf16_f32 v186, v140, v141
    v_cvt_pk_bf16_f32 v187, v142, v143
    v_cvt_pk_bf16_f32 v188, v146, v147
    v_cvt_pk_bf16_f32 v189, v148, v149
    v_cvt_pk_bf16_f32 v190, v150, v151
    v_cvt_pk_bf16_f32 v191, v152, v153
    v_cvt_pk_bf16_f32 v192, v145, v146
    v_cvt_pk_bf16_f32 v193, v147, v148
    v_cvt_pk_bf16_f32 v194, v149, v150
    v_cvt_pk_bf16_f32 v195, v151, v152
    s_waitcnt lgkmcnt(9)
    v_cvt_pk_bf16_f32 v196, v155, v156
    v_cvt_pk_bf16_f32 v197, v157, v158
    v_cvt_pk_bf16_f32 v198, v159, v160
    v_cvt_pk_bf16_f32 v199, v161, v162
    v_cvt_pk_bf16_f32 v200, v154, v155
    v_cvt_pk_bf16_f32 v201, v156, v157
    v_cvt_pk_bf16_f32 v202, v158, v159
    v_cvt_pk_bf16_f32 v203, v160, v161
    s_waitcnt lgkmcnt(0)
    v_cvt_pk_bf16_f32 v204, v164, v165
    v_cvt_pk_bf16_f32 v205, v166, v167
    v_cvt_pk_bf16_f32 v206, v168, v169
    v_cvt_pk_bf16_f32 v207, v170, v171
    v_cvt_pk_bf16_f32 v208, v163, v164
    v_cvt_pk_bf16_f32 v209, v165, v166
    v_cvt_pk_bf16_f32 v210, v167, v168
    v_cvt_pk_bf16_f32 v211, v169, v170
    ds_write_b128 v238, v[180:183] offset:0
    ds_write_b128 v238, v[184:187] offset:4480
    ds_write_b128 v238, v[188:191] offset:1024
    ds_write_b128 v238, v[192:195] offset:5504
    ds_write_b128 v238, v[196:199] offset:2048
    ds_write_b128 v238, v[200:203] offset:6528
    ds_write_b128 v238, v[204:207] offset:3072
    ds_write_b128 v238, v[208:211] offset:7552
    s_setpc_b64 s[54:55]
L_poll:
    s_mov_b32 s43, 0x20000
    v_and_b32 v4, 3, v1
    v_lshlrev_b32 v4, 4, v4
L_poll_loop:
    s_sleep 2
    s_and_b32 s85, s42, 0xffffffcf
    s_add_u32 s85, s85, s83
    buffer_load_dword v5, v4, s[12:15], s85 offen sc1
    s_waitcnt vmcnt(0)
    v_readlane_b32 s85, v5, s84
    s_sub_u32 s43, s43, 1
    s_cbranch_scc1 L_poll_out
    s_cmp_eq_u32 s85, 0
    s_cbranch_scc1 L_poll_loop
L_poll_out:
    s_setpc_b64 s[54:55]
L_pollc:
    s_mov_b32 s43, 0x20000
L_pollc_loop:
    s_sleep 2
    buffer_load_dword v5, off, s[28:31], 0 sc1
    s_waitcnt vmcnt(0)
    v_readfirstlane_b32 s85, v5
    s_sub_u32 s43, s43, 1
    s_cbranch_scc1 L_pollc_out
    s_cmp_lt_u32 s85, 64
    s_cbranch_scc1 L_pollc_loop
L_pollc_out:
    s_setpc_b64 s[54:55]
.p2align 4
L_atab:
.long 0, 1, 2, 3, 4, 5, 6, 7, 128, 129, 130, 131, 132, 133, 134, 135, 256, 258, 260, 262, 384, 386, 388, 390, 512, 516, 640, 644, 768, 772, 896, 900, 1024, 1152, 1280, 1408, 1536, 1664, 1792, 1920, 2048, 2100, 2100, 2100, 2100, 2100, 2100, 2100
L_codeend:
.section .rodata,"a"
.p2align 6
.amdhsa_kernel gated_mix__ssm_conv_s4d__dense_activation_mish__prompt_kernel
  .amdhsa_next_free_vgpr 512
  .amdhsa_next_free_sgpr 102
  .amdhsa_accum_offset 256
  .amdhsa_group_segment_fixed_size 0
  .amdhsa_kernarg_size 120
  .amdhsa_user_sgpr_count 2
  .amdhsa_user_sgpr_kernarg_segment_ptr 1
  .amdhsa_system_sgpr_workgroup_id_x 1
.end_amdhsa_kernel
```
